```python
import torch

def _softmax(x, axis=-1):
    return torch.softmax(x, dim=axis)
def _gelu(x):
    return torch.nn.functional.gelu(x, approximate="tanh")
def _silu(x):
    return torch.nn.functional.silu(x)
def _sigmoid(x):
    return torch.sigmoid(x)
def _layernorm(x, axis=-1, eps=1e-5):
    m = x.mean(dim=axis, keepdim=True)
    v = x.var(dim=axis, keepdim=True, unbiased=False)
    return (x - m) / torch.sqrt(v + eps)
def _scatter_add(tgt, idx, src, axis=0):
    return tgt.clone().index_add_(axis, idx, src)
def _segment_sum(src, seg, n):
    out = torch.zeros((n,) + src.shape[1:], dtype=src.dtype)
    return out.index_add_(0, seg, src)
def _pad(x, pw):
    flat = tuple(v for pair in reversed(pw) for v in pair)
    return torch.nn.functional.pad(x, flat)

kernel_name = 'sequential_preLN__ssm_conv_s4__dense_activation_relu__prompt'

def setup_inputs():

    _w = (lambda a: (lambda t: t.to(torch.bfloat16) if t.is_floating_point() else t)(torch.as_tensor(a)))
    def _A_setup():
        B, L, D, N = 1, 2048, 640, 128
        A_re = -(lambda _x: torch.exp(torch.as_tensor(_x)))((lambda *s: torch.randn(*s, dtype=torch.bfloat16) * 3.2)(D, N))
        A_im = torch.pi * (lambda *s: torch.randn(*s, dtype=torch.bfloat16) * 0.05)(D, N)
        B_re = (lambda *s: torch.randn(*s, dtype=torch.bfloat16) * 0.1)(D, N)
        B_im = (lambda *s: torch.randn(*s, dtype=torch.bfloat16) * 0.1)(D, N)
        C_re = (lambda *s: torch.randn(*s, dtype=torch.bfloat16) * 0.1)(D, N)
        C_im = (lambda *s: torch.randn(*s, dtype=torch.bfloat16) * 0.1)(D, N)
        log_dt = (lambda *s: torch.randn(*s, dtype=torch.bfloat16) * 0.05)(D) * 0.5 - 4.0
        Dskip = (lambda *s: torch.randn(*s, dtype=torch.bfloat16) * 0.05)(D)
        return {
            "u": _w((lambda *s: torch.randn(*s, dtype=torch.bfloat16) * 0.05)(B, L, D)),
            "A_re": _w(A_re),
            "A_im": _w(A_im),
            "B_re": _w(B_re),
            "B_im": _w(B_im),
            "C_re": _w(C_re),
            "C_im": _w(C_im),
            "log_dt": _w(log_dt),
            "Dskip": _w(Dskip),
        }
    _A_in = _A_setup()

    def _B_setup():
        B, S, D, Dff = 1, 2048, 640, 1728
        return {
            "x": _w((lambda *s: torch.randn(*s, dtype=torch.bfloat16) * 0.05)(B, S, D)),
            "w1": _w((lambda *s: torch.randn(*s, dtype=torch.bfloat16) * 0.05)(D, Dff)),
            "w2": _w((lambda *s: torch.randn(*s, dtype=torch.bfloat16) * 0.05)(Dff, D)),
        }
    _B_in = _B_setup()

    return {
        "A_u": _A_in["u"],
        "A_A_re": _A_in["A_re"],
        "A_A_im": _A_in["A_im"],
        "A_B_re": _A_in["B_re"],
        "A_B_im": _A_in["B_im"],
        "A_C_re": _A_in["C_re"],
        "A_C_im": _A_in["C_im"],
        "A_log_dt": _A_in["log_dt"],
        "A_Dskip": _A_in["Dskip"],
        "B_x": _B_in["x"],
        "B_w1": _B_in["w1"],
        "B_w2": _B_in["w2"],
    }

def reference(A_u, A_A_re, A_A_im, A_B_re, A_B_im, A_C_re, A_C_im, A_log_dt, A_Dskip, B_x, B_w1, B_w2):
    def _A_ref(u, A_re, A_im, B_re, B_im, C_re, C_im, log_dt, Dskip):
        Bsz, L, D = u.shape
        dt = torch.exp(log_dt)[:, None]
        A = A_re + 1j * A_im
        Bc = B_re + 1j * B_im
        Cc = C_re + 1j * C_im
        logdA = dt * A
        dB = dt * Bc
        l = (lambda x, dt: x.to(dt))(torch.arange(L), A_re.dtype)
        P = torch.exp(logdA[:, :, None] * l[None, None, :])
        K = torch.einsum("dn,dnl,dn->dl", Cc, P, dB).real
        L2 = 2 * L
        Kp = _pad(K, ((0, 0), (0, L)))
        up = (lambda x, *d: x.permute(*d))(u, 0, 2, 1)
        up = _pad(up, ((0, 0), (0, 0), (0, L)))
        Kf = (lambda x, axes=(-2,-1): torch.fft.rfft2(x.float(), dim=axes))(Kp[:, None, :], axes=(-2, -1))
        Uf = (lambda x, axes=(-2,-1): torch.fft.rfft2(x.float(), dim=axes))(up[:, :, None, :], axes=(-2, -1))
        Yf = Uf * Kf[None, :, :, :]
        y = (lambda x, s, axes=(-2,-1): torch.fft.irfft2(x, s=s, dim=axes).to(torch.bfloat16))(Yf, (1, L2), axes=(-2, -1))[:, :, 0, :L]
        y = (lambda x, *d: x.permute(*d))(y, 0, 2, 1) + u * Dskip[None, None, :]
        return y

    def _B_ref(x, w1, w2):
        h = torch.einsum("bsd,df->bsf", x, w1)
        zero = torch.zeros_like(h)
        h = torch.maximum(h, zero)
        return torch.einsum("bsf,fd->bsd", h, w2)

    x = A_u
    h = x + _A_ref(_layernorm(x, axis=-1), A_A_re, A_A_im, A_B_re, A_B_im, A_C_re, A_C_im, A_log_dt, A_Dskip)
    h2 = h + _B_ref(_layernorm(h, axis=-1), B_w1, B_w2)
    return h2
```

```asm
; @launch grid=(256,1,1) block=(256,1,1) lds=160896
.amdgcn_target "amdgcn-amd-amdhsa--gfx950"
.text
.globl sequential_preLN__ssm_conv_s4__dense_activation_relu__prompt_kernel
.p2align 8
.type sequential_preLN__ssm_conv_s4__dense_activation_relu__prompt_kernel,@function
sequential_preLN__ssm_conv_s4__dense_activation_relu__prompt_kernel:
L_start:
    s_cmp_ge_u32 s2, 256
    s_cbranch_scc1 L_m_end
    s_getpc_b64 s[60:61]
    s_load_dwordx16 s[32:47], s[0:1], 0
    s_load_dwordx2 s[14:15], s[0:1], 112
    s_load_dwordx2 s[50:51], s[0:1], 64
    s_load_dwordx4 s[52:55], s[0:1], 80
    s_load_dwordx2 s[16:17], s[0:1], 96
    v_lshrrev_b32 v1, 6, v0
    s_bfe_u32 s18, s2, 0x20003
    v_readfirstlane_b32 s3, v1
    v_lshl_add_u32 v2, s18, 2, v1
    v_and_b32 v3, 31, v0
    v_min_u32 v3, 23, v3
    v_mul_u32_u24 v2, 24, v2
    v_add_lshl_u32 v2, v2, v3, 7
    v_min_u32 v2, L_m_end-L_start-64, v2
    global_load_dword v255, v2, s[60:61]
    v_mov_b32 v13, v0
    v_and_b32 v14, 127, v0
    v_lshlrev_b32 v14, 2, v14
    v_and_b32 v0, 63, v0
    v_lshlrev_b32 v15, 4, v0
    s_and_b32 s18, s2, 3
    s_bfe_u32 s19, s2, 0x20003
    s_lshl_b32 s21, s18, 2
    s_add_u32 s21, s21, s19
    s_bfe_u32 s29, s2, 0x10002
    s_cmp_lt_u32 s2, 160
    s_cselect_b32 s20, 5, 3
    s_cselect_b32 s30, 0, 5
    s_mul_i32 s20, s20, s29
    s_add_u32 s20, s20, s30
    s_lshr_b32 s30, s2, 5
    s_add_u32 s20, s20, s30
    s_lshl_b32 s22, s20, 1
    s_and_b32 s29, s18, 1
    s_add_u32 s22, s22, s29
    s_lshr_b32 s23, s18, 1
    s_lshl_b32 s23, s23, 2
    s_add_u32 s23, s23, s19
    s_mul_i32 s24, s21, 143360
    s_add_u32 s24, s24, 5279744
    s_lshl_b32 s25, s3, 12
    s_add_u32 s26, s24, s25
    s_lshl_b32 s27, s23, 2
    s_add_u32 s27, s27, s3
    s_mul_i32 s27, s27, 71680
    s_add_u32 s27, s27, 7573504
    s_lshl_b32 s28, s21, 9
    s_add_u32 s28, s28, 9867264
    s_cmp_ge_u32 s2, 160
    s_cbranch_scc1 L_idle
    s_and_b32 s18, s2, 7
    s_mul_i32 s12, s18, 20
    s_lshr_b32 s19, s2, 3
    s_add_u32 s12, s12, s19
    s_lshl_b32 s29, s12, 2
    s_add_u32 s29, s29, s3
    s_lshl_b32 s30, s29, 8
    v_lshl_add_u32 v1, v0, 2, s30
    s_lshl_b32 s30, s29, 1
    v_mov_b32 v2, s30
    s_waitcnt lgkmcnt(0)
    global_load_ushort v10, v2, s[46:47]
    global_load_dword v4, v1, s[34:35]
    global_load_dword v5, v1, s[36:37]
    global_load_dword v6, v1, s[38:39]
    global_load_dword v7, v1, s[40:41]
    global_load_dword v8, v1, s[42:43]
    global_load_dword v9, v1, s[44:45]
    global_load_ushort v11, v2, s[50:51]
    s_load_dword s48, s[14:15], 0
    s_mov_b32 s8, s32
    s_and_b32 s9, s33, 0xffff
    s_mov_b32 s10, 0x280000
    s_mov_b32 s11, 0x20000
    s_mov_b32 s4, s14
    s_and_b32 s5, s15, 0xffff
    s_mov_b32 s6, 0x10000000
    s_mov_b32 s7, 0x20000
    s_lshl_b32 s31, s19, 2
    s_add_u32 s31, s31, s3
    v_lshrrev_b32 v101, 1, v0
    v_mul_u32_u24 v101, 1280, v101
    v_and_b32 v100, 1, v0
    v_lshl_add_u32 v100, v100, 7, v101
    v_mov_b32 v102, 0x7fffff00
    v_cmp_gt_u32 vcc, 26, v0
    s_mul_i32 s30, s18, 160
    s_and_b32 s30, s30, 0xffffff80
    s_mul_i32 s33, s31, 16640
    s_add_u32 s38, s30, s33
    v_cndmask_b32 v99, v102, v100, vcc
    v_mul_u32_u24 v92, 2560, v13
    s_lshl_b32 s39, s12, 3
    s_barrier
    buffer_load_dword v12, v99, s[8:11], s38 offen
    s_add_u32 s38, s38, 1310720
    v_cmp_lt_u32 vcc, 13, v0
    v_lshlrev_b32 v100, 7, v0
    v_add_u32 v101, 1664, v100
    s_and_b32 s33, s18, 3
    s_mul_i32 s33, s33, 80
    v_cndmask_b32 v100, v100, v101, vcc
    v_cmp_gt_u32 vcc, 28, v0
    s_add_u32 s33, s33, s31
    s_mul_i32 s33, s33, 6912
    s_lshr_b32 s34, s18, 2
    s_mul_i32 s34, s34, 1664
    s_add_u32 s33, s33, s34
    v_cndmask_b32 v100, v102, v100, vcc
    s_mov_b32 s40, s52
    s_and_b32 s41, s53, 0xffff
    s_mov_b32 s42, 0x21c000
    s_mov_b32 s43, 0x20000
    buffer_load_dword v12, v100, s[40:43], s33 offen
    s_mul_i32 s30, s3, 33792
    v_lshl_add_u32 v3, v0, 3, s30
    v_and_b32 v60, 31, v0
    v_mul_u32_u24 v60, 528, v60
    v_lshrrev_b32 v61, 5, v0
    v_lshl_add_u32 v60, v61, 4, v60
    v_add_u32 v60, s30, v60
    v_lshrrev_b32 v93, 2, v13
    v_lshlrev_b32 v93, 7, v93
    v_and_b32 v61, 3, v13
    v_lshl_add_u32 v93, v61, 4, v93
    s_mul_i32 s13, s3, 12960
    s_add_u32 s13, s13, 81920
    v_and_b32 v100, 31, v0
    v_lshrrev_b32 v101, 5, v0
    v_lshlrev_b32 v102, 4, v100
    v_sub_u32 v102, s13, v102
    v_lshlrev_b32 v160, 3, v101
    v_sub_u32 v160, v102, v160
    v_add_u32 v160, 3576, v160
    v_lshlrev_b32 v161, 9, v101
    v_sub_u32 v161, v102, v161
    v_add_u32 v161, 3056, v161
    v_lshlrev_b32 v162, 10, v101
    v_sub_u32 v162, v102, v162
    v_add_u32 v162, 1520, v162
    v_lshl_add_u32 v163, v0, 2, s13
    v_add_u32 v100, 8256, v163
    v_add_u32 v101, 4032, v163
    v_add_u32 v102, 8320, v163
    v_cmp_gt_u32 vcc, 16, v0
    v_mov_b32 v166, 0
    v_mov_b32 v167, 0
    v_cndmask_b32 v101, v101, v100, vcc
    v_cmp_gt_u32 vcc, 32, v0
    v_lshl_add_u32 v164, v0, 3, s13
    v_lshlrev_b32 v193, 2, v13
    v_cndmask_b32 v163, v102, v101, vcc
    v_add_u32 v192, 144384, v193
    v_add_u32 v193, 90752, v193
    v_and_b32 v100, 15, v0
    v_lshrrev_b32 v101, 4, v0
    v_lshlrev_b32 v102, 4, v101
    v_and_b32 v103, 1, v0
    v_cmp_eq_u32 s[44:45], 1, v103
    v_mov_b32 v103, 8272
    v_mov_b32 v104, 4108
    v_cndmask_b32 v103, v103, v104, s[44:45]
    v_lshrrev_b32 v104, 1, v100
    v_lshlrev_b32 v104, 2, v104
    v_sub_u32 v103, v103, v104
    v_sub_u32 v103, v103, v102
    v_add_u32 v103, s13, v103
    v_subrev_u32 v194, 960, v103
    v_subrev_u32 v195, 1984, v103
    v_subrev_u32 v196, 3008, v103
    v_subrev_u32 v197, 4032, v103
    v_lshlrev_b32 v104, 5, v100
    v_sub_u32 v198, v104, v102
    s_add_u32 s30, s13, 8400
    v_add_u32 v198, s30, v198
    s_mul_i32 s30, s3, 4128
    s_add_u32 s30, s30, 144384
    v_and_b32 v222, 1, v101
    v_lshl_add_u32 v222, v222, 4, v104
    v_add_u32 v222, s30, v222
    v_lshl_add_u32 v199, v101, 3, v104
    v_add_u32 v199, s30, v199
    v_lshlrev_b32 v105, 3, v101
    v_sub_u32 v105, v100, v105
    v_and_b32 v106, 1, v105
    v_lshlrev_b32 v106, 4, v106
    v_mov_b32 v107, 0x3f80
    v_lshlrev_b32 v106, v106, v107
    v_ashrrev_i32 v105, 1, v105
    v_bfe_u32 v223, v0, 2, 2
    v_mul_u32_u24 v223, 4128, v223
    v_and_b32 v107, 3, v0
    v_lshl_add_u32 v223, v107, 3, v223
    v_lshl_add_u32 v223, v101, 6, v223
    s_lshl_b32 s30, s3, 8
    s_add_u32 s30, s30, 144384
    v_add_u32 v223, s30, v223
    v_cmp_eq_u32 s[46:47], 0, v0
    v_cmp_eq_u32 vcc, 0, v105
    s_nop 1
    v_cndmask_b32 v200, 0, v106, vcc
    v_cmp_eq_u32 vcc, 1, v105
    s_nop 1
    v_cndmask_b32 v201, 0, v106, vcc
    v_cmp_eq_u32 vcc, 2, v105
    s_nop 1
    v_cndmask_b32 v202, 0, v106, vcc
    v_cmp_eq_u32 vcc, 3, v105
    s_nop 1
    v_cndmask_b32 v203, 0, v106, vcc
    s_lshl_b32 s61, s21, 10
    s_add_u32 s61, s61, 17240064
    s_lshr_b32 s60, s23, 1
    s_lshl_b32 s60, s60, 2
    s_add_u32 s60, s60, s3
    s_mul_i32 s60, s60, 1792
    s_add_u32 s60, s60, 17256448
    v_min_u32 v13, 13, v0
    v_lshlrev_b32 v13, 7, v13
    v_and_b32 v1, 7, v0
    v_lshlrev_b32 v1, 7, v1
    s_mov_b32 s62, 0x3fb8aa3b
    s_mov_b32 s63, 0x3fb8aa3b
    s_mov_b32 s64, 0x3e22f983
    s_mov_b32 s65, 0x3e22f983
    s_waitcnt vmcnt(9)
    v_lshlrev_b32 v10, 16, v10
    v_mul_f32 v10, s62, v10
    v_exp_f32 v10, v10
    s_nop 0
    v_cvt_pk_bf16_f32 v10, v10, v10
    v_lshlrev_b32 v62, 16, v10
    v_lshlrev_b32 v63, 16, v10
    s_waitcnt vmcnt(7)
    v_lshlrev_b32 v94, 16, v4
    v_and_b32 v95, 0xffff0000, v4
    v_lshlrev_b32 v96, 16, v5
    v_and_b32 v97, 0xffff0000, v5
    v_pk_mul_f32 v[94:95], v[94:95], v[62:63]
    v_pk_mul_f32 v[96:97], v[96:97], v[62:63]
    v_pk_mul_f32 v[94:95], v[94:95], s[62:63]
    v_pk_mul_f32 v[96:97], v[96:97], s[64:65]
    v_mul_f32 v48, 0x41000000, v94
    v_mul_f32 v50, 0x41000000, v96
    v_exp_f32 v48, v48
    v_fract_f32 v50, v50
    v_mul_f32 v49, 0x41000000, v95
    v_mul_f32 v51, 0x41000000, v97
    v_exp_f32 v49, v49
    v_fract_f32 v51, v51
    v_cos_f32 v52, v50
    v_sin_f32 v50, v50
    v_cos_f32 v53, v51
    v_sin_f32 v51, v51
    v_pk_mul_f32 v[32:33], v[48:49], v[52:53]
    v_pk_mul_f32 v[34:35], v[48:49], v[50:51]
    v_exp_f32 v54, v94
    v_fract_f32 v56, v96
    v_exp_f32 v55, v95
    v_fract_f32 v57, v97
    v_cos_f32 v58, v56
    v_sin_f32 v56, v56
    v_cos_f32 v59, v57
    v_sin_f32 v57, v57
    v_pk_mul_f32 v[20:21], v[54:55], v[58:59]
    v_pk_mul_f32 v[22:23], v[54:55], v[56:57]
    v_mul_f32 v48, 0x43800000, v94
    v_mul_f32 v50, 0x43800000, v96
    v_exp_f32 v48, v48
    v_fract_f32 v50, v50
    v_mul_f32 v49, 0x43800000, v95
    v_mul_f32 v51, 0x43800000, v97
    v_exp_f32 v49, v49
    v_fract_f32 v51, v51
    v_cos_f32 v52, v50
    v_sin_f32 v50, v50
    v_cos_f32 v53, v51
    v_sin_f32 v51, v51
    v_pk_mul_f32 v[36:37], v[48:49], v[52:53]
    v_pk_mul_f32 v[38:39], v[48:49], v[50:51]
    v_mul_f32 v54, 0x44800000, v94
    v_mul_f32 v56, 0x44800000, v96
    v_exp_f32 v54, v54
    v_fract_f32 v56, v56
    v_mul_f32 v55, 0x44800000, v95
    v_mul_f32 v57, 0x44800000, v97
    v_exp_f32 v55, v55
    v_fract_f32 v57, v57
    v_cos_f32 v58, v56
    v_sin_f32 v56, v56
    v_cos_f32 v59, v57
    v_sin_f32 v57, v57
    v_pk_mul_f32 v[44:45], v[54:55], v[58:59]
    v_pk_mul_f32 v[46:47], v[54:55], v[56:57]
    s_waitcnt vmcnt(2) lgkmcnt(0)
    s_mul_i32 s49, s48, 0x9e3779b1
    s_add_u32 s48, s48, 1
    s_xor_b32 s49, s49, 0x5bd1e995
    v_lshlrev_b32 v48, 16, v6
    v_and_b32 v49, 0xffff0000, v6
    v_lshlrev_b32 v50, 16, v7
    v_and_b32 v51, 0xffff0000, v7
    v_lshlrev_b32 v52, 16, v8
    v_and_b32 v53, 0xffff0000, v8
    v_lshlrev_b32 v54, 16, v9
    v_and_b32 v55, 0xffff0000, v9
    v_pk_mul_f32 v[48:49], v[48:49], v[62:63]
    v_pk_mul_f32 v[50:51], v[50:51], v[62:63]
    v_pk_mul_f32 v[56:57], v[52:53], v[48:49]
    v_pk_mul_f32 v[58:59], v[52:53], v[50:51]
    v_pk_fma_f32 v[16:17], v[54:55], v[50:51], v[56:57] neg_lo:[1,0,0] neg_hi:[1,0,0]
    v_pk_fma_f32 v[18:19], v[54:55], v[48:49], v[58:59]
    v_pk_mul_f32 v[48:49], v[20:21], v[20:21]
    v_pk_mul_f32 v[50:51], v[20:21], v[22:23]
    v_pk_fma_f32 v[24:25], v[22:23], v[22:23], v[48:49] neg_lo:[1,0,0] neg_hi:[1,0,0]
    v_pk_fma_f32 v[26:27], v[22:23], v[20:21], v[50:51]
    v_pk_mul_f32 v[52:53], v[36:37], v[36:37]
    v_pk_mul_f32 v[54:55], v[36:37], v[38:39]
    v_pk_fma_f32 v[40:41], v[38:39], v[38:39], v[52:53] neg_lo:[1,0,0] neg_hi:[1,0,0]
    v_pk_fma_f32 v[42:43], v[38:39], v[36:37], v[54:55]
    v_pk_mul_f32 v[48:49], v[24:25], v[24:25]
    v_pk_mul_f32 v[50:51], v[24:25], v[26:27]
    v_pk_fma_f32 v[28:29], v[26:27], v[26:27], v[48:49] neg_lo:[1,0,0] neg_hi:[1,0,0]
    v_pk_fma_f32 v[30:31], v[26:27], v[24:25], v[50:51]
    v_mov_b32 v72, 0x3f803f80
    v_cvt_pk_bf16_f32 v88, v16, v17
    v_mov_b32 v73, 0
    v_cvt_pk_bf16_f32 v89, -v18, -v19
    ds_write_b64 v3, v[72:73] offset:16896
    ds_write_b64 v3, v[88:89] offset:0
    v_cvt_pk_bf16_f32 v74, v32, v33
    v_pk_mul_f32 v[84:85], v[16:17], v[20:21]
    v_cvt_pk_bf16_f32 v75, v34, v35
    v_pk_mul_f32 v[86:87], v[16:17], v[22:23]
    ds_write_b64 v3, v[74:75] offset:17424
    v_pk_fma_f32 v[76:77], v[18:19], v[22:23], v[84:85] neg_lo:[1,0,0] neg_hi:[1,0,0]
    v_pk_mul_f32 v[68:69], v[32:33], v[32:33]
    v_pk_fma_f32 v[78:79], v[18:19], v[20:21], v[86:87]
    v_pk_mul_f32 v[70:71], v[32:33], v[34:35]
    v_cvt_pk_bf16_f32 v90, v76, v77
    v_pk_fma_f32 v[64:65], v[34:35], v[34:35], v[68:69] neg_lo:[1,0,0] neg_hi:[1,0,0]
    v_cvt_pk_bf16_f32 v91, -v78, -v79
    v_pk_fma_f32 v[66:67], v[34:35], v[32:33], v[70:71]
    v_cvt_pk_bf16_f32 v72, v64, v65
    buffer_load_dwordx2 v[224:225], v92, s[8:11], s39 offen offset:0
    ds_write_b64 v3, v[90:91] offset:528
    v_cvt_pk_bf16_f32 v73, v66, v67
    v_pk_mul_f32 v[84:85], v[76:77], v[20:21]
    ds_write_b64 v3, v[72:73] offset:17952
    v_pk_mul_f32 v[86:87], v[76:77], v[22:23]
    v_pk_mul_f32 v[68:69], v[64:65], v[32:33]
    v_pk_fma_f32 v[76:77], v[78:79], v[22:23], v[84:85] neg_lo:[1,0,0] neg_hi:[1,0,0]
    v_pk_mul_f32 v[70:71], v[64:65], v[34:35]
    v_pk_fma_f32 v[78:79], v[78:79], v[20:21], v[86:87]
    v_pk_fma_f32 v[64:65], v[66:67], v[34:35], v[68:69] neg_lo:[1,0,0] neg_hi:[1,0,0]
    v_cvt_pk_bf16_f32 v88, v76, v77
    v_pk_fma_f32 v[66:67], v[66:67], v[32:33], v[70:71]
    v_cvt_pk_bf16_f32 v89, -v78, -v79
    v_cvt_pk_bf16_f32 v74, v64, v65
    ds_write_b64 v3, v[88:89] offset:1056
    v_cvt_pk_bf16_f32 v75, v66, v67
    v_pk_mul_f32 v[84:85], v[76:77], v[20:21]
    ds_write_b64 v3, v[74:75] offset:18480
    v_pk_mul_f32 v[68:69], v[64:65], v[32:33]
    v_pk_mul_f32 v[86:87], v[76:77], v[22:23]
    v_pk_mul_f32 v[70:71], v[64:65], v[34:35]
    v_pk_fma_f32 v[76:77], v[78:79], v[22:23], v[84:85] neg_lo:[1,0,0] neg_hi:[1,0,0]
    v_pk_fma_f32 v[64:65], v[66:67], v[34:35], v[68:69] neg_lo:[1,0,0] neg_hi:[1,0,0]
    v_pk_fma_f32 v[78:79], v[78:79], v[20:21], v[86:87]
    v_pk_fma_f32 v[66:67], v[66:67], v[32:33], v[70:71]
    v_cvt_pk_bf16_f32 v90, v76, v77
    v_cvt_pk_bf16_f32 v72, v64, v65
    v_cvt_pk_bf16_f32 v91, -v78, -v79
    v_cvt_pk_bf16_f32 v73, v66, v67
    ds_write_b64 v3, v[90:91] offset:1584
    ds_write_b64 v3, v[72:73] offset:19008
    v_pk_mul_f32 v[84:85], v[76:77], v[20:21]
    v_pk_mul_f32 v[68:69], v[64:65], v[32:33]
    v_pk_mul_f32 v[86:87], v[76:77], v[22:23]
    v_pk_mul_f32 v[70:71], v[64:65], v[34:35]
    v_pk_fma_f32 v[64:65], v[66:67], v[34:35], v[68:69] neg_lo:[1,0,0] neg_hi:[1,0,0]
    v_pk_fma_f32 v[76:77], v[78:79], v[22:23], v[84:85] neg_lo:[1,0,0] neg_hi:[1,0,0]
    v_pk_fma_f32 v[66:67], v[66:67], v[32:33], v[70:71]
    v_pk_fma_f32 v[78:79], v[78:79], v[20:21], v[86:87]
    v_cvt_pk_bf16_f32 v74, v64, v65
    v_cvt_pk_bf16_f32 v88, v76, v77
    v_cvt_pk_bf16_f32 v75, v66, v67
    v_cvt_pk_bf16_f32 v89, -v78, -v79
    ds_write_b64 v3, v[74:75] offset:19536
    ds_write_b64 v3, v[88:89] offset:2112
    v_pk_mul_f32 v[68:69], v[64:65], v[32:33]
    ds_write_b64 v3, v[88:89] offset:4224
    v_pk_mul_f32 v[70:71], v[64:65], v[34:35]
    v_pk_mul_f32 v[84:85], v[76:77], v[20:21]
    v_pk_fma_f32 v[64:65], v[66:67], v[34:35], v[68:69] neg_lo:[1,0,0] neg_hi:[1,0,0]
    v_pk_mul_f32 v[86:87], v[76:77], v[22:23]
    v_pk_fma_f32 v[66:67], v[66:67], v[32:33], v[70:71]
    v_pk_fma_f32 v[76:77], v[78:79], v[22:23], v[84:85] neg_lo:[1,0,0] neg_hi:[1,0,0]
    v_cvt_pk_bf16_f32 v72, v64, v65
    v_cvt_pk_bf16_f32 v73, v66, v67
    v_pk_fma_f32 v[78:79], v[78:79], v[20:21], v[86:87]
    ds_write_b64 v3, v[72:73] offset:20064
    v_cvt_pk_bf16_f32 v90, v76, v77
    v_pk_mul_f32 v[68:69], v[64:65], v[32:33]
    v_cvt_pk_bf16_f32 v91, -v78, -v79
    v_pk_mul_f32 v[70:71], v[64:65], v[34:35]
    ds_write_b64 v3, v[90:91] offset:2640
    v_pk_fma_f32 v[64:65], v[66:67], v[34:35], v[68:69] neg_lo:[1,0,0] neg_hi:[1,0,0]
    v_pk_mul_f32 v[84:85], v[76:77], v[20:21]
    v_pk_fma_f32 v[66:67], v[66:67], v[32:33], v[70:71]
    v_pk_mul_f32 v[86:87], v[76:77], v[22:23]
    v_cvt_pk_bf16_f32 v74, v64, v65
    v_pk_fma_f32 v[76:77], v[78:79], v[22:23], v[84:85] neg_lo:[1,0,0] neg_hi:[1,0,0]
    v_cvt_pk_bf16_f32 v75, v66, v67
    v_pk_fma_f32 v[78:79], v[78:79], v[20:21], v[86:87]
    buffer_load_dwordx2 v[226:227], v92, s[8:11], s39 offen offset:1280
    s_add_u32 s39, s39, 655360
    ds_write_b64 v3, v[74:75] offset:20592
    v_cvt_pk_bf16_f32 v88, v76, v77
    v_pk_mul_f32 v[68:69], v[64:65], v[32:33]
    v_pk_mul_f32 v[70:71], v[64:65], v[34:35]
    v_cvt_pk_bf16_f32 v89, -v78, -v79
    v_pk_fma_f32 v[64:65], v[66:67], v[34:35], v[68:69] neg_lo:[1,0,0] neg_hi:[1,0,0]
    ds_write_b64 v3, v[88:89] offset:3168
    v_pk_fma_f32 v[66:67], v[66:67], v[32:33], v[70:71]
    v_pk_mul_f32 v[84:85], v[76:77], v[20:21]
    v_cvt_pk_bf16_f32 v72, v64, v65
    v_pk_mul_f32 v[86:87], v[76:77], v[22:23]
    v_cvt_pk_bf16_f32 v73, v66, v67
    v_pk_fma_f32 v[76:77], v[78:79], v[22:23], v[84:85] neg_lo:[1,0,0] neg_hi:[1,0,0]
    ds_write_b64 v3, v[72:73] offset:21120
    v_pk_fma_f32 v[78:79], v[78:79], v[20:21], v[86:87]
    v_pk_mul_f32 v[68:69], v[64:65], v[32:33]
    v_cvt_pk_bf16_f32 v90, v76, v77
    v_pk_mul_f32 v[70:71], v[64:65], v[34:35]
    v_cvt_pk_bf16_f32 v91, -v78, -v79
    v_pk_fma_f32 v[64:65], v[66:67], v[34:35], v[68:69] neg_lo:[1,0,0] neg_hi:[1,0,0]
    ds_write_b64 v3, v[90:91] offset:3696
    v_pk_fma_f32 v[66:67], v[66:67], v[32:33], v[70:71]
    v_cvt_pk_bf16_f32 v74, v64, v65
    v_pk_mul_f32 v[84:85], v[76:77], v[20:21]
    v_cvt_pk_bf16_f32 v75, v66, v67
    v_pk_mul_f32 v[86:87], v[76:77], v[22:23]
    ds_write_b64 v3, v[74:75] offset:21648
    v_pk_fma_f32 v[76:77], v[78:79], v[22:23], v[84:85] neg_lo:[1,0,0] neg_hi:[1,0,0]
    v_pk_mul_f32 v[68:69], v[64:65], v[32:33]
    v_pk_fma_f32 v[78:79], v[78:79], v[20:21], v[86:87]
    v_pk_mul_f32 v[70:71], v[64:65], v[34:35]
    v_cvt_pk_bf16_f32 v88, v76, v77
    v_pk_fma_f32 v[64:65], v[66:67], v[34:35], v[68:69] neg_lo:[1,0,0] neg_hi:[1,0,0]
    v_cvt_pk_bf16_f32 v89, -v78, -v79
    v_pk_fma_f32 v[66:67], v[66:67], v[32:33], v[70:71]
    ds_write_b64 v3, v[88:89] offset:6336
    v_cvt_pk_bf16_f32 v72, v64, v65
    v_pk_mul_f32 v[84:85], v[16:17], v[36:37]
    v_cvt_pk_bf16_f32 v73, v66, v67
    v_pk_mul_f32 v[86:87], v[16:17], v[38:39]
    ds_write_b64 v3, v[72:73] offset:22176
    v_pk_mul_f32 v[68:69], v[64:65], v[32:33]
    v_pk_fma_f32 v[76:77], v[18:19], v[38:39], v[84:85] neg_lo:[1,0,0] neg_hi:[1,0,0]
    v_pk_mul_f32 v[70:71], v[64:65], v[34:35]
    v_pk_fma_f32 v[78:79], v[18:19], v[36:37], v[86:87]
    v_pk_fma_f32 v[64:65], v[66:67], v[34:35], v[68:69] neg_lo:[1,0,0] neg_hi:[1,0,0]
    v_cvt_pk_bf16_f32 v90, v76, v77
    v_pk_fma_f32 v[66:67], v[66:67], v[32:33], v[70:71]
    v_cvt_pk_bf16_f32 v91, -v78, -v79
    v_cvt_pk_bf16_f32 v74, v64, v65
    ds_write_b64 v3, v[90:91] offset:4752
    v_cvt_pk_bf16_f32 v75, v66, v67
    v_pk_mul_f32 v[84:85], v[76:77], v[24:25]
    ds_write_b64 v3, v[74:75] offset:22704
    v_pk_mul_f32 v[86:87], v[76:77], v[26:27]
    v_pk_mul_f32 v[68:69], v[64:65], v[32:33]
    v_pk_fma_f32 v[76:77], v[78:79], v[26:27], v[84:85] neg_lo:[1,0,0] neg_hi:[1,0,0]
    v_pk_mul_f32 v[70:71], v[64:65], v[34:35]
    v_pk_fma_f32 v[78:79], v[78:79], v[24:25], v[86:87]
    v_pk_fma_f32 v[64:65], v[66:67], v[34:35], v[68:69] neg_lo:[1,0,0] neg_hi:[1,0,0]
    v_pk_fma_f32 v[66:67], v[66:67], v[32:33], v[70:71]
    v_cvt_pk_bf16_f32 v88, v76, v77
    v_cvt_pk_bf16_f32 v72, v64, v65
    v_cvt_pk_bf16_f32 v89, -v78, -v79
    v_cvt_pk_bf16_f32 v73, v66, v67
    ds_write_b64 v3, v[88:89] offset:5280
    ds_write_b64 v3, v[72:73] offset:23232
    v_pk_mul_f32 v[84:85], v[76:77], v[24:25]
    v_pk_mul_f32 v[68:69], v[64:65], v[32:33]
    buffer_load_dwordx2 v[228:229], v92, s[8:11], s39 offen offset:0
    v_pk_mul_f32 v[86:87], v[76:77], v[26:27]
    v_pk_mul_f32 v[70:71], v[64:65], v[34:35]
    v_pk_fma_f32 v[76:77], v[78:79], v[26:27], v[84:85] neg_lo:[1,0,0] neg_hi:[1,0,0]
    v_pk_fma_f32 v[64:65], v[66:67], v[34:35], v[68:69] neg_lo:[1,0,0] neg_hi:[1,0,0]
    v_pk_fma_f32 v[78:79], v[78:79], v[24:25], v[86:87]
    v_pk_fma_f32 v[66:67], v[66:67], v[32:33], v[70:71]
    v_cvt_pk_bf16_f32 v90, v76, v77
    v_cvt_pk_bf16_f32 v74, v64, v65
    v_cvt_pk_bf16_f32 v75, v66, v67
    v_cvt_pk_bf16_f32 v91, -v78, -v79
    ds_write_b64 v3, v[74:75] offset:23760
    ds_write_b64 v3, v[90:91] offset:6864
    v_pk_mul_f32 v[68:69], v[64:65], v[32:33]
    ds_write_b64 v3, v[90:91] offset:5808
    v_pk_mul_f32 v[70:71], v[64:65], v[34:35]
    v_pk_mul_f32 v[84:85], v[76:77], v[24:25]
    v_pk_fma_f32 v[64:65], v[66:67], v[34:35], v[68:69] neg_lo:[1,0,0] neg_hi:[1,0,0]
    v_pk_mul_f32 v[86:87], v[76:77], v[26:27]
    v_pk_fma_f32 v[66:67], v[66:67], v[32:33], v[70:71]
    v_pk_fma_f32 v[76:77], v[78:79], v[26:27], v[84:85] neg_lo:[1,0,0] neg_hi:[1,0,0]
    v_cvt_pk_bf16_f32 v72, v64, v65
    v_pk_fma_f32 v[78:79], v[78:79], v[24:25], v[86:87]
    v_cvt_pk_bf16_f32 v73, v66, v67
    v_cvt_pk_bf16_f32 v88, v76, v77
    ds_write_b64 v3, v[72:73] offset:24288
    v_cvt_pk_bf16_f32 v89, -v78, -v79
    v_pk_mul_f32 v[68:69], v[64:65], v[32:33]
    v_pk_mul_f32 v[70:71], v[64:65], v[34:35]
    ds_write_b64 v3, v[88:89] offset:7392
    v_pk_fma_f32 v[64:65], v[66:67], v[34:35], v[68:69] neg_lo:[1,0,0] neg_hi:[1,0,0]
    v_pk_mul_f32 v[84:85], v[76:77], v[24:25]
    v_pk_fma_f32 v[66:67], v[66:67], v[32:33], v[70:71]
    v_pk_mul_f32 v[86:87], v[76:77], v[26:27]
    v_cvt_pk_bf16_f32 v74, v64, v65
    v_pk_fma_f32 v[76:77], v[78:79], v[26:27], v[84:85] neg_lo:[1,0,0] neg_hi:[1,0,0]
    v_cvt_pk_bf16_f32 v75, v66, v67
    v_pk_fma_f32 v[78:79], v[78:79], v[24:25], v[86:87]
    ds_write_b64 v3, v[74:75] offset:24816
    v_cvt_pk_bf16_f32 v90, v76, v77
    v_pk_mul_f32 v[68:69], v[64:65], v[32:33]
    v_cvt_pk_bf16_f32 v91, -v78, -v79
    v_pk_mul_f32 v[70:71], v[64:65], v[34:35]
    ds_write_b64 v3, v[90:91] offset:7920
    v_pk_fma_f32 v[64:65], v[66:67], v[34:35], v[68:69] neg_lo:[1,0,0] neg_hi:[1,0,0]
    v_pk_mul_f32 v[84:85], v[16:17], v[40:41]
    v_pk_fma_f32 v[66:67], v[66:67], v[32:33], v[70:71]
    v_cvt_pk_bf16_f32 v72, v64, v65
    v_pk_mul_f32 v[86:87], v[16:17], v[42:43]
    v_cvt_pk_bf16_f32 v73, v66, v67
    v_pk_fma_f32 v[80:81], v[18:19], v[42:43], v[84:85] neg_lo:[1,0,0] neg_hi:[1,0,0]
    ds_write_b64 v3, v[72:73] offset:25344
    v_pk_fma_f32 v[82:83], v[18:19], v[40:41], v[86:87]
    v_pk_mul_f32 v[68:69], v[64:65], v[32:33]
    v_cvt_pk_bf16_f32 v88, v80, v81
    v_pk_mul_f32 v[70:71], v[64:65], v[34:35]
    v_cvt_pk_bf16_f32 v89, -v82, -v83
    v_pk_fma_f32 v[64:65], v[66:67], v[34:35], v[68:69] neg_lo:[1,0,0] neg_hi:[1,0,0]
    ds_write_b64 v3, v[88:89] offset:8448
    v_pk_fma_f32 v[66:67], v[66:67], v[32:33], v[70:71]
    v_pk_mul_f32 v[84:85], v[80:81], v[28:29]
    v_cvt_pk_bf16_f32 v74, v64, v65
    v_pk_mul_f32 v[86:87], v[80:81], v[30:31]
    v_cvt_pk_bf16_f32 v75, v66, v67
    v_pk_fma_f32 v[76:77], v[82:83], v[30:31], v[84:85] neg_lo:[1,0,0] neg_hi:[1,0,0]
    ds_write_b64 v3, v[74:75] offset:25872
    v_pk_mul_f32 v[68:69], v[64:65], v[32:33]
    v_pk_fma_f32 v[78:79], v[82:83], v[28:29], v[86:87]
    v_pk_mul_f32 v[70:71], v[64:65], v[34:35]
    v_cvt_pk_bf16_f32 v90, v76, v77
    v_pk_fma_f32 v[64:65], v[66:67], v[34:35], v[68:69] neg_lo:[1,0,0] neg_hi:[1,0,0]
    buffer_load_dwordx2 v[230:231], v92, s[8:11], s39 offen offset:1280
    s_add_u32 s39, s39, 655360
    v_cvt_pk_bf16_f32 v91, -v78, -v79
    v_pk_fma_f32 v[66:67], v[66:67], v[32:33], v[70:71]
    ds_write_b64 v3, v[90:91] offset:8976
    v_cvt_pk_bf16_f32 v72, v64, v65
    v_pk_mul_f32 v[84:85], v[76:77], v[28:29]
    v_cvt_pk_bf16_f32 v73, v66, v67
    v_pk_mul_f32 v[86:87], v[76:77], v[30:31]
    ds_write_b64 v3, v[72:73] offset:26400
    v_pk_fma_f32 v[76:77], v[78:79], v[30:31], v[84:85] neg_lo:[1,0,0] neg_hi:[1,0,0]
    v_pk_mul_f32 v[68:69], v[64:65], v[32:33]
    v_pk_fma_f32 v[78:79], v[78:79], v[28:29], v[86:87]
    v_pk_mul_f32 v[70:71], v[64:65], v[34:35]
    v_cvt_pk_bf16_f32 v88, v76, v77
    v_pk_fma_f32 v[64:65], v[66:67], v[34:35], v[68:69] neg_lo:[1,0,0] neg_hi:[1,0,0]
    v_pk_fma_f32 v[66:67], v[66:67], v[32:33], v[70:71]
    v_cvt_pk_bf16_f32 v89, -v78, -v79
    v_cvt_pk_bf16_f32 v74, v64, v65
    ds_write_b64 v3, v[88:89] offset:9504
    v_cvt_pk_bf16_f32 v75, v66, v67
    v_pk_mul_f32 v[84:85], v[80:81], v[36:37]
    ds_write_b64 v3, v[74:75] offset:26928
    v_pk_mul_f32 v[86:87], v[80:81], v[38:39]
    v_pk_mul_f32 v[68:69], v[64:65], v[32:33]
    v_pk_fma_f32 v[80:81], v[82:83], v[38:39], v[84:85] neg_lo:[1,0,0] neg_hi:[1,0,0]
    v_pk_mul_f32 v[70:71], v[64:65], v[34:35]
    v_pk_fma_f32 v[82:83], v[82:83], v[36:37], v[86:87]
    v_pk_fma_f32 v[64:65], v[66:67], v[34:35], v[68:69] neg_lo:[1,0,0] neg_hi:[1,0,0]
    v_cvt_pk_bf16_f32 v90, v80, v81
    v_pk_fma_f32 v[66:67], v[66:67], v[32:33], v[70:71]
    v_cvt_pk_bf16_f32 v91, -v82, -v83
    v_cvt_pk_bf16_f32 v72, v64, v65
    v_cvt_pk_bf16_f32 v73, v66, v67
    ds_write_b64 v3, v[90:91] offset:10560
    ds_write_b64 v3, v[72:73] offset:27456
    v_pk_mul_f32 v[84:85], v[80:81], v[28:29]
    v_pk_mul_f32 v[68:69], v[64:65], v[32:33]
    v_pk_mul_f32 v[86:87], v[80:81], v[30:31]
    v_pk_mul_f32 v[70:71], v[64:65], v[34:35]
    v_pk_fma_f32 v[76:77], v[82:83], v[30:31], v[84:85] neg_lo:[1,0,0] neg_hi:[1,0,0]
    v_pk_fma_f32 v[64:65], v[66:67], v[34:35], v[68:69] neg_lo:[1,0,0] neg_hi:[1,0,0]
    v_pk_fma_f32 v[78:79], v[82:83], v[28:29], v[86:87]
    v_pk_fma_f32 v[66:67], v[66:67], v[32:33], v[70:71]
    v_cvt_pk_bf16_f32 v88, v76, v77
    v_cvt_pk_bf16_f32 v74, v64, v65
    v_cvt_pk_bf16_f32 v89, -v78, -v79
    v_cvt_pk_bf16_f32 v75, v66, v67
    ds_write_b64 v3, v[88:89] offset:11088
    ds_write_b64 v3, v[74:75] offset:27984
    v_pk_mul_f32 v[84:85], v[76:77], v[28:29]
    v_pk_mul_f32 v[68:69], v[64:65], v[32:33]
    v_pk_mul_f32 v[70:71], v[64:65], v[34:35]
    v_pk_mul_f32 v[86:87], v[76:77], v[30:31]
    v_pk_fma_f32 v[64:65], v[66:67], v[34:35], v[68:69] neg_lo:[1,0,0] neg_hi:[1,0,0]
    v_pk_fma_f32 v[76:77], v[78:79], v[30:31], v[84:85] neg_lo:[1,0,0] neg_hi:[1,0,0]
    v_pk_fma_f32 v[66:67], v[66:67], v[32:33], v[70:71]
    v_pk_fma_f32 v[78:79], v[78:79], v[28:29], v[86:87]
    v_cvt_pk_bf16_f32 v72, v64, v65
    v_cvt_pk_bf16_f32 v90, v76, v77
    v_cvt_pk_bf16_f32 v73, v66, v67
    v_cvt_pk_bf16_f32 v91, -v78, -v79
    ds_write_b64 v3, v[72:73] offset:28512
    ds_write_b64 v3, v[90:91] offset:11616
    v_pk_mul_f32 v[68:69], v[64:65], v[32:33]
    v_pk_mul_f32 v[84:85], v[16:17], v[44:45]
    v_pk_mul_f32 v[70:71], v[64:65], v[34:35]
    v_pk_mul_f32 v[86:87], v[16:17], v[46:47]
    v_pk_fma_f32 v[64:65], v[66:67], v[34:35], v[68:69] neg_lo:[1,0,0] neg_hi:[1,0,0]
    v_pk_fma_f32 v[80:81], v[18:19], v[46:47], v[84:85] neg_lo:[1,0,0] neg_hi:[1,0,0]
    v_pk_fma_f32 v[66:67], v[66:67], v[32:33], v[70:71]
    v_cvt_pk_bf16_f32 v74, v64, v65
    v_pk_fma_f32 v[82:83], v[18:19], v[44:45], v[86:87]
    v_cvt_pk_bf16_f32 v75, v66, v67
    v_cvt_pk_bf16_f32 v88, v80, v81
    ds_write_b64 v3, v[74:75] offset:29040
    v_cvt_pk_bf16_f32 v89, -v82, -v83
    v_pk_mul_f32 v[68:69], v[64:65], v[32:33]
    ds_write_b64 v3, v[88:89] offset:12672
    v_pk_mul_f32 v[70:71], v[64:65], v[34:35]
    v_pk_mul_f32 v[84:85], v[80:81], v[32:33]
    v_pk_fma_f32 v[64:65], v[66:67], v[34:35], v[68:69] neg_lo:[1,0,0] neg_hi:[1,0,0]
    v_pk_mul_f32 v[86:87], v[80:81], v[34:35]
    v_pk_fma_f32 v[66:67], v[66:67], v[32:33], v[70:71]
    v_pk_fma_f32 v[76:77], v[82:83], v[34:35], v[84:85] neg_lo:[1,0,0] neg_hi:[1,0,0]
    v_cvt_pk_bf16_f32 v72, v64, v65
    v_pk_fma_f32 v[78:79], v[82:83], v[32:33], v[86:87]
    v_cvt_pk_bf16_f32 v73, v66, v67
    v_cvt_pk_bf16_f32 v90, v76, v77
    ds_write_b64 v3, v[72:73] offset:29568
    v_pk_mul_f32 v[68:69], v[64:65], v[32:33]
    v_cvt_pk_bf16_f32 v91, -v78, -v79
    v_pk_mul_f32 v[70:71], v[64:65], v[34:35]
    ds_write_b64 v3, v[90:91] offset:13200
    v_pk_fma_f32 v[64:65], v[66:67], v[34:35], v[68:69] neg_lo:[1,0,0] neg_hi:[1,0,0]
    v_pk_mul_f32 v[84:85], v[80:81], v[36:37]
    v_pk_fma_f32 v[66:67], v[66:67], v[32:33], v[70:71]
    v_pk_mul_f32 v[86:87], v[80:81], v[38:39]
    v_cvt_pk_bf16_f32 v74, v64, v65
    v_pk_fma_f32 v[80:81], v[82:83], v[38:39], v[84:85] neg_lo:[1,0,0] neg_hi:[1,0,0]
    v_cvt_pk_bf16_f32 v75, v66, v67
    buffer_load_dword v12, v99, s[8:11], s38 offen
    v_pk_fma_f32 v[82:83], v[82:83], v[36:37], v[86:87]
    ds_write_b64 v3, v[74:75] offset:30096
    v_cvt_pk_bf16_f32 v88, v80, v81
    v_pk_mul_f32 v[68:69], v[64:65], v[32:33]
    v_cvt_pk_bf16_f32 v89, -v82, -v83
    v_pk_mul_f32 v[70:71], v[64:65], v[34:35]
    ds_write_b64 v3, v[88:89] offset:13728
    v_pk_fma_f32 v[64:65], v[66:67], v[34:35], v[68:69] neg_lo:[1,0,0] neg_hi:[1,0,0]
    v_pk_fma_f32 v[66:67], v[66:67], v[32:33], v[70:71]
    v_pk_mul_f32 v[84:85], v[80:81], v[32:33]
    v_cvt_pk_bf16_f32 v72, v64, v65
    v_pk_mul_f32 v[86:87], v[80:81], v[34:35]
    v_cvt_pk_bf16_f32 v73, v66, v67
    v_pk_fma_f32 v[76:77], v[82:83], v[34:35], v[84:85] neg_lo:[1,0,0] neg_hi:[1,0,0]
    ds_write_b64 v3, v[72:73] offset:30624
    v_pk_fma_f32 v[78:79], v[82:83], v[32:33], v[86:87]
    v_pk_mul_f32 v[68:69], v[64:65], v[32:33]
    v_cvt_pk_bf16_f32 v90, v76, v77
    v_pk_mul_f32 v[70:71], v[64:65], v[34:35]
    v_cvt_pk_bf16_f32 v91, -v78, -v79
    v_pk_fma_f32 v[64:65], v[66:67], v[34:35], v[68:69] neg_lo:[1,0,0] neg_hi:[1,0,0]
    ds_write_b64 v3, v[90:91] offset:14256
    v_pk_fma_f32 v[66:67], v[66:67], v[32:33], v[70:71]
    v_pk_mul_f32 v[84:85], v[80:81], v[36:37]
    v_cvt_pk_bf16_f32 v74, v64, v65
    v_pk_mul_f32 v[86:87], v[80:81], v[38:39]
    v_cvt_pk_bf16_f32 v75, v66, v67
    ds_write_b64 v3, v[74:75] offset:31152
    v_pk_fma_f32 v[80:81], v[82:83], v[38:39], v[84:85] neg_lo:[1,0,0] neg_hi:[1,0,0]
    v_pk_mul_f32 v[68:69], v[64:65], v[32:33]
    v_pk_fma_f32 v[82:83], v[82:83], v[36:37], v[86:87]
    v_pk_mul_f32 v[70:71], v[64:65], v[34:35]
    v_cvt_pk_bf16_f32 v88, v80, v81
    v_pk_fma_f32 v[64:65], v[66:67], v[34:35], v[68:69] neg_lo:[1,0,0] neg_hi:[1,0,0]
    v_cvt_pk_bf16_f32 v89, -v82, -v83
    v_pk_fma_f32 v[66:67], v[66:67], v[32:33], v[70:71]
    ds_write_b64 v3, v[88:89] offset:14784
    v_cvt_pk_bf16_f32 v72, v64, v65
    v_pk_mul_f32 v[84:85], v[80:81], v[32:33]
    v_cvt_pk_bf16_f32 v73, v66, v67
    v_pk_mul_f32 v[86:87], v[80:81], v[34:35]
    ds_write_b64 v3, v[72:73] offset:31680
    v_pk_fma_f32 v[76:77], v[82:83], v[34:35], v[84:85] neg_lo:[1,0,0] neg_hi:[1,0,0]
    v_pk_mul_f32 v[68:69], v[64:65], v[32:33]
    v_pk_mul_f32 v[70:71], v[64:65], v[34:35]
    v_pk_fma_f32 v[78:79], v[82:83], v[32:33], v[86:87]
    v_pk_fma_f32 v[64:65], v[66:67], v[34:35], v[68:69] neg_lo:[1,0,0] neg_hi:[1,0,0]
    v_cvt_pk_bf16_f32 v90, v76, v77
    v_pk_fma_f32 v[66:67], v[66:67], v[32:33], v[70:71]
    v_cvt_pk_bf16_f32 v91, -v78, -v79
    v_cvt_pk_bf16_f32 v74, v64, v65
    ds_write_b64 v3, v[90:91] offset:15312
    v_cvt_pk_bf16_f32 v75, v66, v67
    v_pk_mul_f32 v[84:85], v[80:81], v[36:37]
    ds_write_b64 v3, v[74:75] offset:32208
    v_pk_mul_f32 v[86:87], v[80:81], v[38:39]
    v_pk_mul_f32 v[68:69], v[64:65], v[32:33]
    v_pk_fma_f32 v[80:81], v[82:83], v[38:39], v[84:85] neg_lo:[1,0,0] neg_hi:[1,0,0]
    v_pk_mul_f32 v[70:71], v[64:65], v[34:35]
    v_pk_fma_f32 v[82:83], v[82:83], v[36:37], v[86:87]
    v_pk_fma_f32 v[64:65], v[66:67], v[34:35], v[68:69] neg_lo:[1,0,0] neg_hi:[1,0,0]
    v_cvt_pk_bf16_f32 v88, v80, v81
    v_pk_fma_f32 v[66:67], v[66:67], v[32:33], v[70:71]
    v_cvt_pk_bf16_f32 v72, v64, v65
    v_cvt_pk_bf16_f32 v89, -v82, -v83
    v_cvt_pk_bf16_f32 v73, v66, v67
    ds_write_b64 v3, v[88:89] offset:15840
    ds_write_b64 v3, v[72:73] offset:32736
    v_pk_mul_f32 v[84:85], v[80:81], v[32:33]
    v_pk_mul_f32 v[68:69], v[64:65], v[32:33]
    v_pk_mul_f32 v[86:87], v[80:81], v[34:35]
    v_pk_mul_f32 v[70:71], v[64:65], v[34:35]
    v_pk_fma_f32 v[76:77], v[82:83], v[34:35], v[84:85] neg_lo:[1,0,0] neg_hi:[1,0,0]
    v_pk_fma_f32 v[64:65], v[66:67], v[34:35], v[68:69] neg_lo:[1,0,0] neg_hi:[1,0,0]
    v_pk_fma_f32 v[78:79], v[82:83], v[32:33], v[86:87]
    v_pk_fma_f32 v[66:67], v[66:67], v[32:33], v[70:71]
    v_cvt_pk_bf16_f32 v90, v76, v77
    v_cvt_pk_bf16_f32 v74, v64, v65
    v_cvt_pk_bf16_f32 v91, -v78, -v79
    v_cvt_pk_bf16_f32 v75, v66, v67
    ds_write_b64 v3, v[90:91] offset:16368
    s_mov_b32 s30, 4096
    buffer_load_dwordx4 v[240:243], v93, s[4:7], s30 offen sc1
    s_mov_b32 s30, 12288
    buffer_load_dwordx4 v[244:247], v93, s[4:7], s30 offen sc1
    s_mov_b32 s30, 20480
    buffer_load_dwordx4 v[248:251], v93, s[4:7], s30 offen sc1
    s_mov_b32 s30, 28672
    buffer_load_dwordx4 v[252:255], v93, s[4:7], s30 offen sc1
    ds_write_b64 v3, v[74:75] offset:33264
    buffer_load_dwordx2 v[232:233], v92, s[8:11], s39 offen offset:0
    ds_read_b128 v[96:99], v60 offset:0
    ds_read_b128 v[100:103], v60 offset:16896
    ds_read_b128 v[104:107], v60 offset:32
    ds_read_b128 v[108:111], v60 offset:16928
    ds_read_b128 v[112:115], v60 offset:64
    ds_read_b128 v[116:119], v60 offset:16960
    ds_read_b128 v[120:123], v60 offset:96
    ds_read_b128 v[124:127], v60 offset:16992
    ds_read_b128 v[128:131], v60 offset:128
    ds_read_b128 v[132:135], v60 offset:17024
    s_waitcnt lgkmcnt(8)
    v_mfma_f32_32x32x16_bf16 v[64:79], v[96:99], v[100:103], 0
    s_mov_b32 s62, 0x05040100
    s_mov_b32 s63, 0x07060302
    v_lshlrev_b32 v11, 16, v11
    v_cndmask_b32 v11, 0, v11, s[46:47]
    ds_read_b128 v[136:139], v60 offset:160
    ds_read_b128 v[140:143], v60 offset:17056
    s_waitcnt lgkmcnt(8)
    v_mfma_f32_32x32x16_bf16 v[64:79], v[104:107], v[108:111], v[64:79]
    s_waitcnt vmcnt(6)
    v_perm_b32 v40, v226, v224, s62
    v_perm_b32 v41, v226, v224, s63
    v_perm_b32 v42, v227, v225, s62
    ds_read_b128 v[144:147], v60 offset:192
    ds_read_b128 v[148:151], v60 offset:17088
    s_waitcnt lgkmcnt(8)
    v_mfma_f32_32x32x16_bf16 v[64:79], v[112:115], v[116:119], v[64:79]
    v_perm_b32 v43, v227, v225, s63
    v_lshlrev_b32 v16, 16, v224
    v_and_b32 v17, 0xffff0000, v224
    v_lshlrev_b32 v18, 16, v225
    ds_read_b128 v[152:155], v60 offset:224
    ds_read_b128 v[156:159], v60 offset:17120
    s_waitcnt lgkmcnt(8)
    v_mfma_f32_32x32x16_bf16 v[64:79], v[120:123], v[124:127], v[64:79]
    v_and_b32 v19, 0xffff0000, v225
    v_lshlrev_b32 v20, 16, v226
    v_and_b32 v21, 0xffff0000, v226
    v_lshlrev_b32 v22, 16, v227
    ds_read_b128 v[96:99], v60 offset:256
    ds_read_b128 v[100:103], v60 offset:17152
    s_waitcnt lgkmcnt(8)
    v_mfma_f32_32x32x16_bf16 v[64:79], v[128:131], v[132:135], v[64:79]
    v_and_b32 v23, 0xffff0000, v227
    v_perm_b32 v44, v230, v228, s62
    v_perm_b32 v45, v230, v228, s63
    v_perm_b32 v46, v231, v229, s62
    ds_read_b128 v[104:107], v60 offset:288
    ds_read_b128 v[108:111], v60 offset:17184
    s_waitcnt lgkmcnt(8)
    v_mfma_f32_32x32x16_bf16 v[64:79], v[136:139], v[140:143], v[64:79]
    v_perm_b32 v47, v231, v229, s63
    v_lshlrev_b32 v24, 16, v228
    v_and_b32 v25, 0xffff0000, v228
    v_lshlrev_b32 v26, 16, v229
    ds_read_b128 v[112:115], v60 offset:320
    ds_read_b128 v[116:119], v60 offset:17216
    s_waitcnt lgkmcnt(8)
    v_mfma_f32_32x32x16_bf16 v[64:79], v[144:147], v[148:151], v[64:79]
    v_and_b32 v27, 0xffff0000, v229
    v_lshlrev_b32 v28, 16, v230
    v_and_b32 v29, 0xffff0000, v230
    v_lshlrev_b32 v30, 16, v231
    ds_read_b128 v[120:123], v60 offset:352
    ds_read_b128 v[124:127], v60 offset:17248
    s_waitcnt lgkmcnt(8)
    v_mfma_f32_32x32x16_bf16 v[64:79], v[152:155], v[156:159], v[64:79]
    v_and_b32 v31, 0xffff0000, v231
    ds_read_b128 v[128:131], v60 offset:384
    ds_read_b128 v[132:135], v60 offset:17280
    s_waitcnt lgkmcnt(8)
    v_mfma_f32_32x32x16_bf16 v[64:79], v[96:99], v[100:103], v[64:79]
    ds_read_b128 v[136:139], v60 offset:416
    ds_read_b128 v[140:143], v60 offset:17312
    s_waitcnt lgkmcnt(8)
    v_mfma_f32_32x32x16_bf16 v[64:79], v[104:107], v[108:111], v[64:79]
    ds_read_b128 v[144:147], v60 offset:448
    ds_read_b128 v[148:151], v60 offset:17344
    s_waitcnt lgkmcnt(8)
    v_mfma_f32_32x32x16_bf16 v[64:79], v[112:115], v[116:119], v[64:79]
    ds_read_b128 v[152:155], v60 offset:480
    ds_read_b128 v[156:159], v60 offset:17376
    s_waitcnt lgkmcnt(8)
    v_mfma_f32_32x32x16_bf16 v[64:79], v[120:123], v[124:127], v[64:79]
    s_waitcnt lgkmcnt(6)
    v_mfma_f32_32x32x16_bf16 v[64:79], v[128:131], v[132:135], v[64:79]
    s_waitcnt lgkmcnt(4)
    v_mfma_f32_32x32x16_bf16 v[64:79], v[136:139], v[140:143], v[64:79]
    s_waitcnt lgkmcnt(2)
    v_mfma_f32_32x32x16_bf16 v[64:79], v[144:147], v[148:151], v[64:79]
    s_waitcnt lgkmcnt(0)
    s_barrier
    v_mfma_f32_32x32x16_bf16 v[64:79], v[152:155], v[156:159], v[64:79]
    buffer_load_dwordx2 v[234:235], v92, s[8:11], s39 offen offset:1280
    s_add_u32 s39, s39, 655360
    ds_write_b32 v192, v40 offset:0
    ds_write_b32 v192, v41 offset:4128
    ds_write_b32 v192, v42 offset:8256
    ds_write_b32 v192, v43 offset:12384
    ds_write_b32 v192, v44 offset:1024
    ds_write_b32 v192, v45 offset:5152
    ds_write_b32 v192, v46 offset:9280
    ds_write_b32 v192, v47 offset:13408
    ds_write_b64 v164, v[166:167] offset:8320
    s_nop 0
    v_add_f32 v64, v64, v11
    v_cvt_pk_bf16_f32 v56, v64, v166
    v_cndmask_b32 v56, 0, v56, s[46:47]
    ds_write_b32 v163, v56
    v_cvt_pk_bf16_f32 v96, v67, v66
    v_cvt_pk_bf16_f32 v97, v65, v64
    v_cvt_pk_bf16_f32 v98, v68, v67
    v_cvt_pk_bf16_f32 v99, v66, v65
    ds_write_b64 v160, v[96:97] offset:512
    ds_write_b64 v160, v[98:99] offset:4672
    v_cvt_pk_bf16_f32 v100, v71, v70
    v_cvt_pk_bf16_f32 v101, v69, v69
    v_cvt_pk_bf16_f32 v102, v71, v71
    v_cvt_pk_bf16_f32 v103, v70, v69
    ds_write_b64 v160, v[100:101]
    ds_write_b64 v160, v[102:103] offset:4160
    v_cvt_pk_bf16_f32 v104, v74, v74
    v_cvt_pk_bf16_f32 v105, v73, v73
    v_cvt_pk_bf16_f32 v106, v73, v72
    v_cvt_pk_bf16_f32 v107, v72, v72
    v_cvt_pk_bf16_f32 v108, v74, v74
    v_cvt_pk_bf16_f32 v109, v74, v73
    v_mov_b32 v110, v105
    v_mov_b32 v111, v107
    ds_write_b128 v161, v[104:107]
    ds_write_b128 v161, v[108:111] offset:4160
    v_cndmask_b32 v57, v76, v77, s[44:45]
    v_cvt_pk_bf16_f32 v112, v77, v77
    v_cvt_pk_bf16_f32 v113, v77, v57
    v_cvt_pk_bf16_f32 v114, v76, v76
    v_mov_b32 v115, v114
    v_mov_b32 v116, v112
    v_mov_b32 v117, v112
    v_cvt_pk_bf16_f32 v118, v57, v76
    v_mov_b32 v119, v114
    ds_write_b128 v162, v[112:115] offset:512
    ds_write_b128 v162, v[116:119] offset:4672
    v_cndmask_b32 v57, v78, v79, s[44:45]
    v_cvt_pk_bf16_f32 v120, v79, v79
    v_cvt_pk_bf16_f32 v121, v79, v57
    v_cvt_pk_bf16_f32 v122, v78, v78
    v_mov_b32 v123, v122
    v_mov_b32 v124, v120
    v_mov_b32 v125, v120
    v_cvt_pk_bf16_f32 v126, v57, v78
    v_mov_b32 v127, v122
    ds_write_b128 v162, v[120:123] offset:0
    ds_write_b128 v162, v[124:127] offset:4160
    buffer_load_dwordx2 v[236:237], v92, s[8:11], s39 offen offset:0
    s_mov_b32 s58, 0
    s_waitcnt vmcnt(3)
L_sp1:
    v_xor_b32 v176, s48, v241
    v_xor_b32 v177, s48, v243
    v_xor_b32 v178, s48, v245
    v_xor_b32 v179, s48, v247
    v_xor_b32 v180, s48, v249
    v_xor_b32 v181, s48, v251
    v_xor_b32 v182, s48, v253
    v_xor_b32 v183, s48, v255
    v_or3_b32 v176, v176, v177, v178
    v_or3_b32 v179, v179, v180, v181
    v_or3_b32 v176, v176, v182, v183
    v_or_b32 v176, v176, v179
    v_cmp_eq_u32 vcc, 0, v176
    s_cmp_eq_u64 vcc, exec
    s_cbranch_scc1 L_sp1_out
    s_sleep 1
    s_mov_b32 s30, 4096
    buffer_load_dwordx4 v[240:243], v93, s[4:7], s30 offen sc1
    s_mov_b32 s30, 12288
    buffer_load_dwordx4 v[244:247], v93, s[4:7], s30 offen sc1
    s_mov_b32 s30, 20480
    buffer_load_dwordx4 v[248:251], v93, s[4:7], s30 offen sc1
    s_mov_b32 s30, 28672
    buffer_load_dwordx4 v[252:255], v93, s[4:7], s30 offen sc1
    s_add_u32 s58, s58, 1
    s_cmp_le_u32 s58, 200000
    s_waitcnt vmcnt(0)
    s_cbranch_scc1 L_sp1
L_sp1_out:
    v_and_b32 v241, 0xffff0000, v240
    v_and_b32 v245, 0xffff0000, v244
    v_lshlrev_b32 v240, 16, v240
    v_lshlrev_b32 v244, 16, v244
    v_rcp_f32 v241, v241
    v_rcp_f32 v245, v245
    v_and_b32 v243, 0xffff0000, v242
    v_and_b32 v247, 0xffff0000, v246
    v_lshlrev_b32 v242, 16, v242
    v_lshlrev_b32 v246, 16, v246
    v_rcp_f32 v243, v243
    v_rcp_f32 v247, v247
    v_sub_f32 v16, v16, v240
    v_sub_f32 v24, v24, v244
    v_sub_f32 v17, v17, v240
    v_sub_f32 v25, v25, v244
    v_sub_f32 v18, v18, v240
    v_sub_f32 v26, v26, v244
    v_sub_f32 v19, v19, v240
    v_sub_f32 v27, v27, v244
    v_sub_f32 v20, v20, v242
    v_sub_f32 v28, v28, v246
    v_sub_f32 v21, v21, v242
    v_sub_f32 v29, v29, v246
    v_sub_f32 v22, v22, v242
    v_sub_f32 v30, v30, v246
    v_sub_f32 v23, v23, v242
    v_sub_f32 v31, v31, v246
    v_mul_f32 v16, v16, v241
    v_mul_f32 v24, v24, v245
    v_mul_f32 v17, v17, v241
    v_mul_f32 v25, v25, v245
    v_mul_f32 v18, v18, v241
    v_mul_f32 v26, v26, v245
    v_mul_f32 v19, v19, v241
    v_mul_f32 v27, v27, v245
    v_mul_f32 v20, v20, v243
    v_mul_f32 v28, v28, v247
    v_mul_f32 v21, v21, v243
    v_mul_f32 v29, v29, v247
    v_mul_f32 v22, v22, v243
    v_mul_f32 v30, v30, v247
    v_mul_f32 v23, v23, v243
    v_mul_f32 v31, v31, v247
    v_cvt_pk_bf16_f32 v224, v16, v20
    v_cvt_pk_bf16_f32 v228, v24, v28
    v_cvt_pk_bf16_f32 v225, v17, v21
    v_cvt_pk_bf16_f32 v229, v25, v29
    v_cvt_pk_bf16_f32 v226, v18, v22
    v_cvt_pk_bf16_f32 v230, v26, v30
    v_cvt_pk_bf16_f32 v227, v19, v23
    v_cvt_pk_bf16_f32 v231, v27, v31
    ds_write_b32 v193, v224 offset:0
    ds_write_b32 v193, v225 offset:12960
    ds_write_b32 v193, v226 offset:25920
    ds_write_b32 v193, v227 offset:38880
    ds_write_b32 v193, v228 offset:1024
    ds_write_b32 v193, v229 offset:13984
    ds_write_b32 v193, v230 offset:26944
    ds_write_b32 v193, v231 offset:39904
    buffer_load_dwordx2 v[238:239], v92, s[8:11], s39 offen offset:1280
    s_waitcnt lgkmcnt(0)
    s_barrier
    ds_read_b128 v[80:83], v198 offset:448
    ds_read2_b32 a[128:129], v194 offset0:240 offset1:241
    ds_read2_b32 a[130:131], v194 offset0:242 offset1:243
    ds_read_b128 v[84:87], v198 offset:960
    ds_read2_b32 a[132:133], v194 offset0:112 offset1:113
    ds_read2_b32 a[134:135], v194 offset0:114 offset1:115
    ds_read_b128 v[88:91], v198 offset:1472
    ds_read2_b32 a[136:137], v195 offset0:240 offset1:241
    ds_read2_b32 a[138:139], v195 offset0:242 offset1:243
    ds_read_b128 v[92:95], v198 offset:1984
    ds_read2_b32 a[140:141], v195 offset0:112 offset1:113
    ds_read2_b32 a[142:143], v195 offset0:114 offset1:115
    ds_read2_b32 v[64:65], v196 offset0:240 offset1:241
    ds_read2_b32 v[66:67], v196 offset0:242 offset1:243
    ds_read2_b32 v[68:69], v196 offset0:112 offset1:113
    ds_read2_b32 v[70:71], v196 offset0:114 offset1:115
    ds_read2_b32 v[72:73], v197 offset0:240 offset1:241
    ds_read2_b32 v[74:75], v197 offset0:242 offset1:243
    ds_read2_b32 v[76:77], v197 offset0:112 offset1:113
    ds_read2_b32 v[78:79], v197 offset0:114 offset1:115
    s_waitcnt lgkmcnt(15)
    v_mfma_f32_16x16x32_bf16 v[16:19], a[128:131], v[80:83], 0
    ds_read_b128 v[144:147], v198 offset:384
    ds_read_b128 v[204:207], v222 offset:0
    s_waitcnt lgkmcnt(15)
    v_mfma_f32_16x16x32_bf16 v[20:23], a[128:131], v[84:87], 0
    ds_read2_b32 a[144:145], v194 offset0:224 offset1:225
    ds_read_b128 v[208:211], v222 offset:512
    s_waitcnt lgkmcnt(15)
    v_mfma_f32_16x16x32_bf16 v[20:23], a[132:135], v[80:83], v[20:23]
    ds_read2_b32 a[146:147], v194 offset0:226 offset1:227
    ds_read_b128 v[212:215], v222 offset:1024
    v_mfma_f32_16x16x32_bf16 v[24:27], a[132:135], v[84:87], 0
    ds_read_b128 v[148:151], v198 offset:896
    ds_read_b128 v[216:219], v222 offset:1536
    s_waitcnt lgkmcnt(15)
    v_mfma_f32_16x16x32_bf16 v[24:27], a[128:131], v[88:91], v[24:27]
    ds_read2_b32 a[148:149], v194 offset0:96 offset1:97
    s_waitcnt lgkmcnt(15)
    v_mfma_f32_16x16x32_bf16 v[24:27], a[136:139], v[80:83], v[24:27]
    ds_read2_b32 a[150:151], v194 offset0:98 offset1:99
    v_mfma_f32_16x16x32_bf16 v[28:31], a[132:135], v[88:91], 0
    ds_read_b128 v[152:155], v198 offset:1408
    v_mfma_f32_16x16x32_bf16 v[28:31], a[136:139], v[84:87], v[28:31]
    ds_read2_b32 a[152:153], v195 offset0:224 offset1:225
    v_mfma_f32_16x16x32_bf16 v[32:35], a[136:139], v[88:91], 0
    ds_read2_b32 a[154:155], v195 offset0:226 offset1:227
    s_waitcnt lgkmcnt(15)
    v_mfma_f32_16x16x32_bf16 v[28:31], a[128:131], v[92:95], v[28:31]
    ds_read_b128 v[156:159], v198 offset:1920
    s_waitcnt lgkmcnt(15)
    v_mfma_f32_16x16x32_bf16 v[28:31], a[140:143], v[80:83], v[28:31]
    ds_read2_b32 a[156:157], v195 offset0:96 offset1:97
    v_mfma_f32_16x16x32_bf16 v[32:35], a[132:135], v[92:95], v[32:35]
    ds_read2_b32 a[158:159], v195 offset0:98 offset1:99
    v_mfma_f32_16x16x32_bf16 v[32:35], a[140:143], v[84:87], v[32:35]
    ds_read2_b32 v[128:129], v196 offset0:224 offset1:225
    v_mfma_f32_16x16x32_bf16 v[36:39], a[136:139], v[92:95], 0
    ds_read2_b32 v[130:131], v196 offset0:226 offset1:227
    v_mfma_f32_16x16x32_bf16 v[36:39], a[140:143], v[88:91], v[36:39]
    ds_read2_b32 v[132:133], v196 offset0:96 offset1:97
    v_mfma_f32_16x16x32_bf16 v[40:43], a[140:143], v[92:95], 0
    ds_read2_b32 v[134:135], v196 offset0:98 offset1:99
    s_waitcnt lgkmcnt(15)
    v_mfma_f32_16x16x32_bf16 v[32:35], v[64:67], v[80:83], v[32:35]
    ds_read2_b32 v[136:137], v197 offset0:224 offset1:225
    v_mfma_f32_16x16x32_bf16 v[36:39], v[64:67], v[84:87], v[36:39]
    ds_read2_b32 v[138:139], v197 offset0:226 offset1:227
    v_mfma_f32_16x16x32_bf16 v[40:43], v[64:67], v[88:91], v[40:43]
    ds_read2_b32 v[140:141], v197 offset0:96 offset1:97
    v_mfma_f32_16x16x32_bf16 v[44:47], v[64:67], v[92:95], 0
    ds_read2_b32 v[142:143], v197 offset0:98 offset1:99
    s_waitcnt lgkmcnt(15)
    v_mfma_f32_16x16x32_bf16 v[36:39], v[68:71], v[80:83], v[36:39]
    v_mfma_f32_16x16x32_bf16 v[40:43], v[68:71], v[84:87], v[40:43]
    v_mfma_f32_16x16x32_bf16 v[44:47], v[68:71], v[88:91], v[44:47]
    s_waitcnt lgkmcnt(15)
    v_mfma_f32_16x16x32_bf16 v[40:43], v[72:75], v[80:83], v[40:43]
    v_mfma_f32_16x16x32_bf16 v[44:47], v[72:75], v[84:87], v[44:47]
    s_waitcnt lgkmcnt(15)
    v_mfma_f32_16x16x32_bf16 v[44:47], v[76:79], v[80:83], v[44:47]
    s_waitcnt lgkmcnt(0)
    v_mfma_f32_16x16x32_bf16 v[16:19], a[144:147], v[144:147], v[16:19]
    ds_read_b128 v[80:83], v198 offset:320
    v_mfma_f32_16x16x32_bf16 v[20:23], a[144:147], v[148:151], v[20:23]
    ds_read2_b32 a[160:161], v194 offset0:208 offset1:209
    v_mfma_f32_16x16x32_bf16 v[20:23], a[148:151], v[144:147], v[20:23]
    ds_read2_b32 a[162:163], v194 offset0:210 offset1:211
    v_mfma_f32_16x16x32_bf16 v[24:27], a[148:151], v[148:151], v[24:27]
    ds_read_b128 v[84:87], v198 offset:832
    v_mfma_f32_16x16x32_bf16 v[24:27], a[144:147], v[152:155], v[24:27]
    ds_read2_b32 a[164:165], v194 offset0:80 offset1:81
    v_mfma_f32_16x16x32_bf16 v[24:27], a[152:155], v[144:147], v[24:27]
    ds_read2_b32 a[166:167], v194 offset0:82 offset1:83
    v_mfma_f32_16x16x32_bf16 v[28:31], a[148:151], v[152:155], v[28:31]
    ds_read_b128 v[88:91], v198 offset:1344
    v_mfma_f32_16x16x32_bf16 v[28:31], a[152:155], v[148:151], v[28:31]
    ds_read2_b32 a[168:169], v195 offset0:208 offset1:209
    v_mfma_f32_16x16x32_bf16 v[32:35], a[152:155], v[152:155], v[32:35]
    ds_read2_b32 a[170:171], v195 offset0:210 offset1:211
    v_mfma_f32_16x16x32_bf16 v[28:31], a[144:147], v[156:159], v[28:31]
    ds_read_b128 v[92:95], v198 offset:1856
    v_mfma_f32_16x16x32_bf16 v[28:31], a[156:159], v[144:147], v[28:31]
    ds_read2_b32 a[172:173], v195 offset0:80 offset1:81
    v_mfma_f32_16x16x32_bf16 v[32:35], a[148:151], v[156:159], v[32:35]
    ds_read2_b32 a[174:175], v195 offset0:82 offset1:83
    v_mfma_f32_16x16x32_bf16 v[32:35], a[156:159], v[148:151], v[32:35]
    ds_read2_b32 v[64:65], v196 offset0:208 offset1:209
    v_mfma_f32_16x16x32_bf16 v[36:39], a[152:155], v[156:159], v[36:39]
    ds_read2_b32 v[66:67], v196 offset0:210 offset1:211
    v_mfma_f32_16x16x32_bf16 v[36:39], a[156:159], v[152:155], v[36:39]
    ds_read2_b32 v[68:69], v196 offset0:80 offset1:81
    v_mfma_f32_16x16x32_bf16 v[40:43], a[156:159], v[156:159], v[40:43]
    ds_read2_b32 v[70:71], v196 offset0:82 offset1:83
    v_mfma_f32_16x16x32_bf16 v[32:35], v[128:131], v[144:147], v[32:35]
    ds_read2_b32 v[72:73], v197 offset0:208 offset1:209
    v_mfma_f32_16x16x32_bf16 v[36:39], v[128:131], v[148:151], v[36:39]
    ds_read2_b32 v[74:75], v197 offset0:210 offset1:211
    v_mfma_f32_16x16x32_bf16 v[40:43], v[128:131], v[152:155], v[40:43]
    ds_read2_b32 v[76:77], v197 offset0:80 offset1:81
    v_mfma_f32_16x16x32_bf16 v[44:47], v[128:131], v[156:159], v[44:47]
    ds_read2_b32 v[78:79], v197 offset0:82 offset1:83
    v_mfma_f32_16x16x32_bf16 v[36:39], v[132:135], v[144:147], v[36:39]
    v_mfma_f32_16x16x32_bf16 v[40:43], v[132:135], v[148:151], v[40:43]
    v_mfma_f32_16x16x32_bf16 v[44:47], v[132:135], v[152:155], v[44:47]
    v_mfma_f32_16x16x32_bf16 v[40:43], v[136:139], v[144:147], v[40:43]
    v_mfma_f32_16x16x32_bf16 v[44:47], v[136:139], v[148:151], v[44:47]
    v_mfma_f32_16x16x32_bf16 v[44:47], v[140:143], v[144:147], v[44:47]
    s_waitcnt lgkmcnt(0)
    v_mfma_f32_16x16x32_bf16 v[16:19], a[160:163], v[80:83], v[16:19]
    ds_read_b128 v[144:147], v198 offset:256
    v_mfma_f32_16x16x32_bf16 v[20:23], a[160:163], v[84:87], v[20:23]
    ds_read2_b32 a[176:177], v194 offset0:192 offset1:193
    v_mfma_f32_16x16x32_bf16 v[20:23], a[164:167], v[80:83], v[20:23]
    ds_read2_b32 a[178:179], v194 offset0:194 offset1:195
    v_mfma_f32_16x16x32_bf16 v[24:27], a[164:167], v[84:87], v[24:27]
    ds_read_b128 v[148:151], v198 offset:768
    v_mfma_f32_16x16x32_bf16 v[24:27], a[160:163], v[88:91], v[24:27]
    ds_read2_b32 a[180:181], v194 offset0:64 offset1:65
    v_mfma_f32_16x16x32_bf16 v[24:27], a[168:171], v[80:83], v[24:27]
    ds_read2_b32 a[182:183], v194 offset0:66 offset1:67
    v_mfma_f32_16x16x32_bf16 v[28:31], a[164:167], v[88:91], v[28:31]
    ds_read_b128 v[152:155], v198 offset:1280
    v_mfma_f32_16x16x32_bf16 v[28:31], a[168:171], v[84:87], v[28:31]
    ds_read2_b32 a[184:185], v195 offset0:192 offset1:193
    v_mfma_f32_16x16x32_bf16 v[32:35], a[168:171], v[88:91], v[32:35]
    ds_read2_b32 a[186:187], v195 offset0:194 offset1:195
    v_mfma_f32_16x16x32_bf16 v[28:31], a[160:163], v[92:95], v[28:31]
    ds_read_b128 v[156:159], v198 offset:1792
    v_mfma_f32_16x16x32_bf16 v[28:31], a[172:175], v[80:83], v[28:31]
    ds_read2_b32 a[188:189], v195 offset0:64 offset1:65
    v_mfma_f32_16x16x32_bf16 v[32:35], a[164:167], v[92:95], v[32:35]
    ds_read2_b32 a[190:191], v195 offset0:66 offset1:67
    v_mfma_f32_16x16x32_bf16 v[32:35], a[172:175], v[84:87], v[32:35]
    ds_read2_b32 v[128:129], v196 offset0:192 offset1:193
    v_mfma_f32_16x16x32_bf16 v[36:39], a[168:171], v[92:95], v[36:39]
    ds_read2_b32 v[130:131], v196 offset0:194 offset1:195
    s_waitcnt vmcnt(0)
    v_mfma_f32_16x16x32_bf16 v[36:39], a[172:175], v[88:91], v[36:39]
    ds_read2_b32 v[132:133], v196 offset0:64 offset1:65
    v_perm_b32 v176, v234, v232, s62
    v_mfma_f32_16x16x32_bf16 v[40:43], a[172:175], v[92:95], v[40:43]
    ds_read2_b32 v[134:135], v196 offset0:66 offset1:67
    v_perm_b32 v184, v238, v236, s62
    v_mfma_f32_16x16x32_bf16 v[32:35], v[64:67], v[80:83], v[32:35]
    ds_read2_b32 v[136:137], v197 offset0:192 offset1:193
    v_perm_b32 v177, v234, v232, s63
    v_mfma_f32_16x16x32_bf16 v[36:39], v[64:67], v[84:87], v[36:39]
    ds_read2_b32 v[138:139], v197 offset0:194 offset1:195
    buffer_load_dwordx2 v[230:231], v1, s[4:7], s61 offen sc1
    v_mfma_f32_16x16x32_bf16 v[40:43], v[64:67], v[88:91], v[40:43]
    ds_read2_b32 v[140:141], v197 offset0:64 offset1:65
    v_perm_b32 v185, v238, v236, s63
    v_mfma_f32_16x16x32_bf16 v[44:47], v[64:67], v[92:95], v[44:47]
    ds_read2_b32 v[142:143], v197 offset0:66 offset1:67
    v_perm_b32 v178, v235, v233, s62
    v_mfma_f32_16x16x32_bf16 v[36:39], v[68:71], v[80:83], v[36:39]
    v_perm_b32 v186, v239, v237, s62
    v_perm_b32 v179, v235, v233, s63
    v_mfma_f32_16x16x32_bf16 v[40:43], v[68:71], v[84:87], v[40:43]
    v_perm_b32 v187, v239, v237, s63
    ds_write_b32 v192, v176 offset:2048
    v_mfma_f32_16x16x32_bf16 v[44:47], v[68:71], v[88:91], v[44:47]
    ds_write_b32 v192, v184 offset:3072
    ds_write_b32 v192, v177 offset:6176
    v_mfma_f32_16x16x32_bf16 v[40:43], v[72:75], v[80:83], v[40:43]
    ds_write_b32 v192, v185 offset:7200
    ds_write_b32 v192, v178 offset:10304
    v_mfma_f32_16x16x32_bf16 v[44:47], v[72:75], v[84:87], v[44:47]
    ds_write_b32 v192, v186 offset:11328
    ds_write_b32 v192, v179 offset:14432
    v_mfma_f32_16x16x32_bf16 v[44:47], v[76:79], v[80:83], v[44:47]
    ds_write_b32 v192, v187 offset:15456
    v_lshlrev_b32 v176, 16, v232
    s_waitcnt lgkmcnt(0)
    v_mfma_f32_16x16x32_bf16 v[16:19], a[176:179], v[144:147], v[16:19]
    ds_read_b128 v[80:83], v198 offset:192
    v_lshlrev_b32 v184, 16, v236
    v_mfma_f32_16x16x32_bf16 v[20:23], a[176:179], v[148:151], v[20:23]
    ds_read2_b32 a[192:193], v194 offset0:176 offset1:177
    v_and_b32 v177, 0xffff0000, v232
    v_mfma_f32_16x16x32_bf16 v[20:23], a[180:183], v[144:147], v[20:23]
    ds_read2_b32 a[194:195], v194 offset0:178 offset1:179
    v_and_b32 v185, 0xffff0000, v236
    v_mfma_f32_16x16x32_bf16 v[24:27], a[180:183], v[148:151], v[24:27]
    ds_read_b128 v[84:87], v198 offset:704
    v_lshlrev_b32 v178, 16, v233
    v_mfma_f32_16x16x32_bf16 v[24:27], a[176:179], v[152:155], v[24:27]
    ds_read2_b32 a[196:197], v194 offset0:48 offset1:49
    v_lshlrev_b32 v186, 16, v237
    v_mfma_f32_16x16x32_bf16 v[24:27], a[184:187], v[144:147], v[24:27]
    ds_read2_b32 a[198:199], v194 offset0:50 offset1:51
    v_and_b32 v179, 0xffff0000, v233
    v_mfma_f32_16x16x32_bf16 v[28:31], a[180:183], v[152:155], v[28:31]
    ds_read_b128 v[88:91], v198 offset:1216
    v_and_b32 v187, 0xffff0000, v237
    v_mfma_f32_16x16x32_bf16 v[28:31], a[184:187], v[148:151], v[28:31]
    ds_read2_b32 a[200:201], v195 offset0:176 offset1:177
    v_lshlrev_b32 v180, 16, v234
    v_mfma_f32_16x16x32_bf16 v[32:35], a[184:187], v[152:155], v[32:35]
    ds_read2_b32 a[202:203], v195 offset0:178 offset1:179
    v_lshlrev_b32 v188, 16, v238
    v_mfma_f32_16x16x32_bf16 v[28:31], a[176:179], v[156:159], v[28:31]
    ds_read_b128 v[92:95], v198 offset:1728
    v_and_b32 v181, 0xffff0000, v234
    v_mfma_f32_16x16x32_bf16 v[28:31], a[188:191], v[144:147], v[28:31]
    ds_read2_b32 a[204:205], v195 offset0:48 offset1:49
    v_and_b32 v189, 0xffff0000, v238
    v_mfma_f32_16x16x32_bf16 v[32:35], a[180:183], v[156:159], v[32:35]
    ds_read2_b32 a[206:207], v195 offset0:50 offset1:51
    v_lshlrev_b32 v182, 16, v235
    v_mfma_f32_16x16x32_bf16 v[32:35], a[188:191], v[148:151], v[32:35]
    ds_read2_b32 v[64:65], v196 offset0:176 offset1:177
    v_lshlrev_b32 v190, 16, v239
    v_mfma_f32_16x16x32_bf16 v[36:39], a[184:187], v[156:159], v[36:39]
    ds_read2_b32 v[66:67], v196 offset0:178 offset1:179
    v_and_b32 v183, 0xffff0000, v235
    v_mfma_f32_16x16x32_bf16 v[36:39], a[188:191], v[152:155], v[36:39]
    ds_read2_b32 v[68:69], v196 offset0:48 offset1:49
    v_and_b32 v191, 0xffff0000, v239
    v_mfma_f32_16x16x32_bf16 v[40:43], a[188:191], v[156:159], v[40:43]
    ds_read2_b32 v[70:71], v196 offset0:50 offset1:51
    v_and_b32 v249, 0xffff0000, v248
    v_mfma_f32_16x16x32_bf16 v[32:35], v[128:131], v[144:147], v[32:35]
    ds_read2_b32 v[72:73], v197 offset0:176 offset1:177
    v_and_b32 v253, 0xffff0000, v252
    v_mfma_f32_16x16x32_bf16 v[36:39], v[128:131], v[148:151], v[36:39]
    ds_read2_b32 v[74:75], v197 offset0:178 offset1:179
    v_lshlrev_b32 v248, 16, v248
    v_mfma_f32_16x16x32_bf16 v[40:43], v[128:131], v[152:155], v[40:43]
    ds_read2_b32 v[76:77], v197 offset0:48 offset1:49
    v_lshlrev_b32 v252, 16, v252
    v_mfma_f32_16x16x32_bf16 v[44:47], v[128:131], v[156:159], v[44:47]
    ds_read2_b32 v[78:79], v197 offset0:50 offset1:51
    v_rcp_f32 v249, v249
    v_mfma_f32_16x16x32_bf16 v[36:39], v[132:135], v[144:147], v[36:39]
    v_rcp_f32 v253, v253
    v_and_b32 v251, 0xffff0000, v250
    v_mfma_f32_16x16x32_bf16 v[40:43], v[132:135], v[148:151], v[40:43]
    v_and_b32 v255, 0xffff0000, v254
    v_lshlrev_b32 v250, 16, v250
    v_mfma_f32_16x16x32_bf16 v[44:47], v[132:135], v[152:155], v[44:47]
    v_lshlrev_b32 v254, 16, v254
    v_rcp_f32 v251, v251
    v_mfma_f32_16x16x32_bf16 v[40:43], v[136:139], v[144:147], v[40:43]
    v_rcp_f32 v255, v255
    v_sub_f32 v176, v176, v248
    v_mfma_f32_16x16x32_bf16 v[44:47], v[136:139], v[148:151], v[44:47]
    v_sub_f32 v184, v184, v252
    v_sub_f32 v177, v177, v248
    v_mfma_f32_16x16x32_bf16 v[44:47], v[140:143], v[144:147], v[44:47]
    v_sub_f32 v185, v185, v252
    v_sub_f32 v178, v178, v248
    s_waitcnt lgkmcnt(0)
    v_mfma_f32_16x16x32_bf16 v[16:19], a[192:195], v[80:83], v[16:19]
    ds_read_b128 v[144:147], v198 offset:128
    v_sub_f32 v186, v186, v252
    v_mfma_f32_16x16x32_bf16 v[20:23], a[192:195], v[84:87], v[20:23]
    ds_read2_b32 a[208:209], v194 offset0:160 offset1:161
    v_sub_f32 v179, v179, v248
    v_mfma_f32_16x16x32_bf16 v[20:23], a[196:199], v[80:83], v[20:23]
    ds_read2_b32 a[210:211], v194 offset0:162 offset1:163
    v_sub_f32 v187, v187, v252
    v_mfma_f32_16x16x32_bf16 v[24:27], a[196:199], v[84:87], v[24:27]
    ds_read_b128 v[148:151], v198 offset:640
    v_sub_f32 v180, v180, v250
    v_mfma_f32_16x16x32_bf16 v[24:27], a[192:195], v[88:91], v[24:27]
    ds_read2_b32 a[212:213], v194 offset0:32 offset1:33
    v_sub_f32 v188, v188, v254
    v_mfma_f32_16x16x32_bf16 v[24:27], a[200:203], v[80:83], v[24:27]
    ds_read2_b32 a[214:215], v194 offset0:34 offset1:35
    buffer_load_dwordx2 v[228:229], v13, s[4:7], s60 offen sc1
    s_waitcnt vmcnt(1)
    v_cmp_eq_u64 vcc, s[48:49], v[230:231]
    s_cmp_eq_u64 vcc, exec
    s_cbranch_scc1 L_sp1d_out
    s_mov_b32 s58, 0
L_sp1d:
    buffer_load_dwordx2 v[230:231], v1, s[4:7], s61 offen sc1
    s_add_u32 s58, s58, 1
    s_waitcnt vmcnt(0)
    v_cmp_eq_u64 vcc, s[48:49], v[230:231]
    s_cmp_eq_u64 vcc, exec
    s_cbranch_scc1 L_sp1d_out
    s_sleep 1
    s_cmp_le_u32 s58, 200000
    s_cbranch_scc1 L_sp1d
L_sp1d_out:
    v_mfma_f32_16x16x32_bf16 v[28:31], a[196:199], v[88:91], v[28:31]
    ds_read_b128 v[152:155], v198 offset:1152
    buffer_load_dword v224, v14, s[4:7], s28 offen sc1
    s_add_u32 s28, s28, 8192
    v_mfma_f32_16x16x32_bf16 v[28:31], a[200:203], v[84:87], v[28:31]
    ds_read2_b32 a[216:217], v195 offset0:160 offset1:161
    v_sub_f32 v181, v181, v250
    v_mfma_f32_16x16x32_bf16 v[32:35], a[200:203], v[88:91], v[32:35]
    ds_read2_b32 a[218:219], v195 offset0:162 offset1:163
    v_sub_f32 v189, v189, v254
    v_mfma_f32_16x16x32_bf16 v[28:31], a[192:195], v[92:95], v[28:31]
    ds_read_b128 v[156:159], v198 offset:1664
    v_sub_f32 v182, v182, v250
    v_mfma_f32_16x16x32_bf16 v[28:31], a[204:207], v[80:83], v[28:31]
    ds_read2_b32 a[220:221], v195 offset0:32 offset1:33
    buffer_load_dword v225, v14, s[4:7], s28 offen sc1
    s_add_u32 s28, s28, 8192
    v_mfma_f32_16x16x32_bf16 v[32:35], a[196:199], v[92:95], v[32:35]
    ds_read2_b32 a[222:223], v195 offset0:34 offset1:35
    v_sub_f32 v190, v190, v254
    v_mfma_f32_16x16x32_bf16 v[32:35], a[204:207], v[84:87], v[32:35]
    ds_read2_b32 v[128:129], v196 offset0:160 offset1:161
    v_sub_f32 v183, v183, v250
    v_mfma_f32_16x16x32_bf16 v[36:39], a[200:203], v[92:95], v[36:39]
    ds_read2_b32 v[130:131], v196 offset0:162 offset1:163
    v_sub_f32 v191, v191, v254
    v_mfma_f32_16x16x32_bf16 v[36:39], a[204:207], v[88:91], v[36:39]
    ds_read2_b32 v[132:133], v196 offset0:32 offset1:33
    buffer_load_dword v226, v14, s[4:7], s28 offen sc1
    s_add_u32 s28, s28, 8192
    v_mfma_f32_16x16x32_bf16 v[40:43], a[204:207], v[92:95], v[40:43]
    ds_read2_b32 v[134:135], v196 offset0:34 offset1:35
    v_mul_f32 v176, v176, v249
    v_mfma_f32_16x16x32_bf16 v[32:35], v[64:67], v[80:83], v[32:35]
    ds_read2_b32 v[136:137], v197 offset0:160 offset1:161
    v_mul_f32 v184, v184, v253
    v_mfma_f32_16x16x32_bf16 v[36:39], v[64:67], v[84:87], v[36:39]
    ds_read2_b32 v[138:139], v197 offset0:162 offset1:163
    v_mul_f32 v177, v177, v249
    v_mfma_f32_16x16x32_bf16 v[40:43], v[64:67], v[88:91], v[40:43]
    ds_read2_b32 v[140:141], v197 offset0:32 offset1:33
    buffer_load_dword v227, v14, s[4:7], s28 offen sc1
    v_mfma_f32_16x16x32_bf16 v[44:47], v[64:67], v[92:95], v[44:47]
    ds_read2_b32 v[142:143], v197 offset0:34 offset1:35
    v_mul_f32 v185, v185, v253
    v_mfma_f32_16x16x32_bf16 v[36:39], v[68:71], v[80:83], v[36:39]
    v_mul_f32 v178, v178, v249
    v_mul_f32 v186, v186, v253
    v_mfma_f32_16x16x32_bf16 v[40:43], v[68:71], v[84:87], v[40:43]
    v_mul_f32 v179, v179, v249
    v_mul_f32 v187, v187, v253
    v_mfma_f32_16x16x32_bf16 v[44:47], v[68:71], v[88:91], v[44:47]
    s_mov_b32 m0, s25
    s_nop 0
    buffer_load_dwordx4 v15, s[4:7], s26 offen offset:0 sc1 lds
    v_mfma_f32_16x16x32_bf16 v[40:43], v[72:75], v[80:83], v[40:43]
    v_mul_f32 v180, v180, v251
    v_mul_f32 v188, v188, v255
    v_mfma_f32_16x16x32_bf16 v[44:47], v[72:75], v[84:87], v[44:47]
    v_mul_f32 v181, v181, v251
    v_mul_f32 v189, v189, v255
    v_mfma_f32_16x16x32_bf16 v[44:47], v[76:79], v[80:83], v[44:47]
    v_mul_f32 v182, v182, v251
    v_mul_f32 v190, v190, v255
    s_waitcnt lgkmcnt(0)
    v_mfma_f32_16x16x32_bf16 v[16:19], a[208:211], v[144:147], v[16:19]
    ds_read_b128 v[80:83], v198 offset:64
    buffer_load_dwordx4 v15, s[4:7], s26 offen offset:1024 sc1 lds
    v_mfma_f32_16x16x32_bf16 v[20:23], a[208:211], v[148:151], v[20:23]
    ds_read2_b32 a[224:225], v194 offset0:144 offset1:145
    v_mul_f32 v183, v183, v251
    v_mfma_f32_16x16x32_bf16 v[20:23], a[212:215], v[144:147], v[20:23]
    ds_read2_b32 a[226:227], v194 offset0:146 offset1:147
    v_mul_f32 v191, v191, v255
    v_mfma_f32_16x16x32_bf16 v[24:27], a[212:215], v[148:151], v[24:27]
    ds_read_b128 v[84:87], v198 offset:576
    v_cvt_pk_bf16_f32 v232, v176, v180
    v_mfma_f32_16x16x32_bf16 v[24:27], a[208:211], v[152:155], v[24:27]
    ds_read2_b32 a[228:229], v194 offset0:16 offset1:17
    buffer_load_dwordx4 v15, s[4:7], s26 offen offset:2048 sc1 lds
    v_mfma_f32_16x16x32_bf16 v[24:27], a[216:219], v[144:147], v[24:27]
    ds_read2_b32 a[230:231], v194 offset0:18 offset1:19
    v_cvt_pk_bf16_f32 v236, v184, v188
    v_mfma_f32_16x16x32_bf16 v[28:31], a[212:215], v[152:155], v[28:31]
    ds_read_b128 v[88:91], v198 offset:1088
    v_cvt_pk_bf16_f32 v233, v177, v181
    v_mfma_f32_16x16x32_bf16 v[28:31], a[216:219], v[148:151], v[28:31]
    ds_read2_b32 a[232:233], v195 offset0:144 offset1:145
    v_cvt_pk_bf16_f32 v237, v185, v189
    v_mfma_f32_16x16x32_bf16 v[32:35], a[216:219], v[152:155], v[32:35]
    ds_read2_b32 a[234:235], v195 offset0:146 offset1:147
    buffer_load_dwordx4 v15, s[4:7], s26 offen offset:3072 sc1 lds
    s_add_u32 s25, s25, 16384
    s_add_u32 s26, s26, 16384
    v_mfma_f32_16x16x32_bf16 v[28:31], a[208:211], v[156:159], v[28:31]
    ds_read_b128 v[92:95], v198 offset:1600
    v_cvt_pk_bf16_f32 v234, v178, v182
    v_mfma_f32_16x16x32_bf16 v[28:31], a[220:223], v[144:147], v[28:31]
    ds_read2_b32 a[236:237], v195 offset0:16 offset1:17
    v_cvt_pk_bf16_f32 v238, v186, v190
    v_mfma_f32_16x16x32_bf16 v[32:35], a[212:215], v[156:159], v[32:35]
    ds_read2_b32 a[238:239], v195 offset0:18 offset1:19
    v_cvt_pk_bf16_f32 v235, v179, v183
    v_mfma_f32_16x16x32_bf16 v[32:35], a[220:223], v[148:151], v[32:35]
    ds_read2_b32 v[64:65], v196 offset0:144 offset1:145
    s_mov_b32 m0, s25
    s_nop 0
    buffer_load_dwordx4 v15, s[4:7], s26 offen offset:0 sc1 lds
    v_mfma_f32_16x16x32_bf16 v[36:39], a[216:219], v[156:159], v[36:39]
    ds_read2_b32 v[66:67], v196 offset0:146 offset1:147
    v_cvt_pk_bf16_f32 v239, v187, v191
    v_mfma_f32_16x16x32_bf16 v[36:39], a[220:223], v[152:155], v[36:39]
    ds_read2_b32 v[68:69], v196 offset0:16 offset1:17
    ds_write_b32 v193, v232 offset:2048
    v_mfma_f32_16x16x32_bf16 v[40:43], a[220:223], v[156:159], v[40:43]
    ds_read2_b32 v[70:71], v196 offset0:18 offset1:19
    ds_write_b32 v193, v236 offset:3072
    v_mfma_f32_16x16x32_bf16 v[32:35], v[128:131], v[144:147], v[32:35]
    ds_read2_b32 v[72:73], v197 offset0:144 offset1:145
    buffer_load_dwordx4 v15, s[4:7], s26 offen offset:1024 sc1 lds
    v_mfma_f32_16x16x32_bf16 v[36:39], v[128:131], v[148:151], v[36:39]
    ds_read2_b32 v[74:75], v197 offset0:146 offset1:147
    ds_write_b32 v193, v233 offset:15008
    v_mfma_f32_16x16x32_bf16 v[40:43], v[128:131], v[152:155], v[40:43]
    ds_read2_b32 v[76:77], v197 offset0:16 offset1:17
    ds_write_b32 v193, v237 offset:16032
    v_mfma_f32_16x16x32_bf16 v[44:47], v[128:131], v[156:159], v[44:47]
    ds_read2_b32 v[78:79], v197 offset0:18 offset1:19
    ds_write_b32 v193, v234 offset:27968
    v_mfma_f32_16x16x32_bf16 v[36:39], v[132:135], v[144:147], v[36:39]
    buffer_load_dwordx4 v15, s[4:7], s26 offen offset:2048 sc1 lds
    ds_write_b32 v193, v238 offset:28992
    v_mfma_f32_16x16x32_bf16 v[40:43], v[132:135], v[148:151], v[40:43]
    ds_write_b32 v193, v235 offset:40928
    ds_write_b32 v193, v239 offset:41952
    v_mfma_f32_16x16x32_bf16 v[44:47], v[132:135], v[152:155], v[44:47]
    v_mfma_f32_16x16x32_bf16 v[40:43], v[136:139], v[144:147], v[40:43]
    v_mfma_f32_16x16x32_bf16 v[44:47], v[136:139], v[148:151], v[44:47]
    buffer_load_dwordx4 v15, s[4:7], s26 offen offset:3072 sc1 lds
    s_add_u32 s25, s25, 16384
    s_add_u32 s26, s26, 16384
    v_mfma_f32_16x16x32_bf16 v[44:47], v[140:143], v[144:147], v[44:47]
    s_waitcnt lgkmcnt(0)
    v_mfma_f32_16x16x32_bf16 v[16:19], a[224:227], v[80:83], v[16:19]
    ds_read_b128 v[144:147], v198 offset:0
    s_mul_i32 s18, s12, 16768
    v_mfma_f32_16x16x32_bf16 v[20:23], a[224:227], v[84:87], v[20:23]
    ds_read2_b32 a[240:241], v194 offset0:128 offset1:129
    s_lshl_b32 s19, s3, 10
    v_mfma_f32_16x16x32_bf16 v[20:23], a[228:231], v[80:83], v[20:23]
    ds_read2_b32 a[242:243], v194 offset0:130 offset1:131
    s_mov_b32 m0, s25
    s_nop 0
    buffer_load_dwordx4 v15, s[4:7], s26 offen offset:0 sc1 lds
    v_mfma_f32_16x16x32_bf16 v[24:27], a[228:231], v[84:87], v[24:27]
    ds_read_b128 v[148:151], v198 offset:512
    s_add_u32 s18, s18, s19
    v_mfma_f32_16x16x32_bf16 v[24:27], a[224:227], v[88:91], v[24:27]
    ds_read2_b32 a[244:245], v194 offset0:0 offset1:1
    s_add_u32 s18, s18, 36864
    v_mfma_f32_16x16x32_bf16 v[24:27], a[232:235], v[80:83], v[24:27]
    ds_read2_b32 a[246:247], v194 offset0:2 offset1:3
    s_add_u32 s30, s18, 4096
    v_mfma_f32_16x16x32_bf16 v[28:31], a[228:231], v[88:91], v[28:31]
    ds_read_b128 v[152:155], v198 offset:1024
    buffer_load_dwordx4 v15, s[4:7], s26 offen offset:1024 sc1 lds
    v_mfma_f32_16x16x32_bf16 v[28:31], a[232:235], v[84:87], v[28:31]
    ds_read2_b32 a[248:249], v195 offset0:128 offset1:129
    s_add_u32 s31, s18, 8192
    v_mfma_f32_16x16x32_bf16 v[32:35], a[232:235], v[88:91], v[32:35]
    ds_read2_b32 a[250:251], v195 offset0:130 offset1:131
    s_add_u32 s32, s18, 10240
    v_mfma_f32_16x16x32_bf16 v[28:31], a[224:227], v[92:95], v[28:31]
    ds_read_b128 v[156:159], v198 offset:1536
    s_add_u32 s33, s18, 14336
    v_mfma_f32_16x16x32_bf16 v[28:31], a[236:239], v[80:83], v[28:31]
    ds_read2_b32 a[252:253], v195 offset0:0 offset1:1
    buffer_load_dwordx4 v15, s[4:7], s26 offen offset:2048 sc1 lds
    v_mfma_f32_16x16x32_bf16 v[32:35], a[228:231], v[92:95], v[32:35]
    ds_read2_b32 a[254:255], v195 offset0:2 offset1:3
    s_lshr_b32 s19, s3, 1
    v_mfma_f32_16x16x32_bf16 v[32:35], a[236:239], v[84:87], v[32:35]
    ds_read2_b32 v[128:129], v196 offset0:128 offset1:129
    s_lshl_b32 s19, s19, 30
    v_mfma_f32_16x16x32_bf16 v[36:39], a[232:235], v[92:95], v[36:39]
    ds_read2_b32 v[130:131], v196 offset0:130 offset1:131
    s_waitcnt vmcnt(15)
    v_cmp_eq_u64 vcc, s[48:49], v[228:229]
    s_cmp_eq_u64 vcc, exec
    s_cbranch_scc1 L_sp1b_out
    s_mov_b32 s58, 0
L_sp1b:
    buffer_load_dwordx2 v[228:229], v13, s[4:7], s60 offen sc1
    s_add_u32 s58, s58, 1
    s_waitcnt vmcnt(0)
    v_cmp_eq_u64 vcc, s[48:49], v[228:229]
    s_cmp_eq_u64 vcc, exec
    s_cbranch_scc1 L_sp1b_out
    s_sleep 1
    s_cmp_le_u32 s58, 200000
    s_cbranch_scc1 L_sp1b
L_sp1b_out:
    s_add_u32 s31, s31, s19
    v_mfma_f32_16x16x32_bf16 v[36:39], a[236:239], v[88:91], v[36:39]
    ds_read2_b32 v[132:133], v196 offset0:0 offset1:1
    buffer_load_dwordx4 v15, s[4:7], s26 offen offset:3072 sc1 lds
    s_add_u32 s25, s25, 16384
    s_add_u32 s26, s26, 16384
    v_mfma_f32_16x16x32_bf16 v[40:43], a[236:239], v[92:95], v[40:43]
    ds_read2_b32 v[134:135], v196 offset0:2 offset1:3
    s_add_u32 s33, s33, s19
    v_mfma_f32_16x16x32_bf16 v[32:35], v[64:67], v[80:83], v[32:35]
    ds_read2_b32 v[136:137], v197 offset0:128 offset1:129
    s_lshl_b32 s19, s29, 8
    v_mfma_f32_16x16x32_bf16 v[36:39], v[64:67], v[84:87], v[36:39]
    ds_read2_b32 v[138:139], v197 offset0:130 offset1:131
    s_add_u32 s19, s19, 17313792
    v_mfma_f32_16x16x32_bf16 v[40:43], v[64:67], v[88:91], v[40:43]
    ds_read2_b32 v[140:141], v197 offset0:0 offset1:1
    s_mov_b32 m0, s25
    s_nop 0
    buffer_load_dwordx4 v15, s[4:7], s26 offen offset:0 sc1 lds
    v_mfma_f32_16x16x32_bf16 v[44:47], v[64:67], v[92:95], v[44:47]
    ds_read2_b32 v[142:143], v197 offset0:2 offset1:3
    v_mfma_f32_16x16x32_bf16 v[36:39], v[68:71], v[80:83], v[36:39]
    v_mfma_f32_16x16x32_bf16 v[40:43], v[68:71], v[84:87], v[40:43]
    v_mfma_f32_16x16x32_bf16 v[44:47], v[68:71], v[88:91], v[44:47]
    buffer_load_dwordx4 v15, s[4:7], s26 offen offset:1024 sc1 lds
    v_mfma_f32_16x16x32_bf16 v[40:43], v[72:75], v[80:83], v[40:43]
    v_mfma_f32_16x16x32_bf16 v[44:47], v[72:75], v[84:87], v[44:47]
    v_mfma_f32_16x16x32_bf16 v[44:47], v[76:79], v[80:83], v[44:47]
    s_waitcnt lgkmcnt(0)
    v_mfma_f32_16x16x32_bf16 v[16:19], v[200:203], v[204:207], v[16:19]
    buffer_load_dwordx4 v15, s[4:7], s26 offen offset:2048 sc1 lds
    v_mfma_f32_16x16x32_bf16 v[20:23], v[200:203], v[208:211], v[20:23]
    v_mfma_f32_16x16x32_bf16 v[24:27], v[200:203], v[212:215], v[24:27]
    v_mfma_f32_16x16x32_bf16 v[28:31], v[200:203], v[216:219], v[28:31]
    v_mfma_f32_16x16x32_bf16 v[16:19], a[240:243], v[144:147], v[16:19]
    buffer_load_dwordx4 v15, s[4:7], s26 offen offset:3072 sc1 lds
    s_add_u32 s25, s25, 16384
    s_add_u32 s26, s26, 16384
    v_mfma_f32_16x16x32_bf16 v[20:23], a[240:243], v[148:151], v[20:23]
    v_mfma_f32_16x16x32_bf16 v[20:23], a[244:247], v[144:147], v[20:23]
    v_mfma_f32_16x16x32_bf16 v[24:27], a[244:247], v[148:151], v[24:27]
    v_mfma_f32_16x16x32_bf16 v[24:27], a[240:243], v[152:155], v[24:27]
    s_mov_b32 m0, s25
    s_nop 0
    buffer_load_dwordx4 v15, s[4:7], s26 offen offset:0 sc1 lds
    v_mfma_f32_16x16x32_bf16 v[24:27], a[248:251], v[144:147], v[24:27]
    v_mfma_f32_16x16x32_bf16 v[28:31], a[244:247], v[152:155], v[28:31]
    v_mfma_f32_16x16x32_bf16 v[28:31], a[248:251], v[148:151], v[28:31]
    v_mfma_f32_16x16x32_bf16 v[28:31], a[240:243], v[156:159], v[28:31]
    buffer_load_dwordx4 v15, s[4:7], s26 offen offset:1024 sc1 lds
    v_mfma_f32_16x16x32_bf16 v[28:31], a[252:255], v[144:147], v[28:31]
    v_mfma_f32_16x16x32_bf16 v[32:35], a[248:251], v[152:155], v[32:35]
    v_mfma_f32_16x16x32_bf16 v[32:35], a[244:247], v[156:159], v[32:35]
    v_mfma_f32_16x16x32_bf16 v[32:35], a[252:255], v[148:151], v[32:35]
    s_waitcnt lgkmcnt(0)
    s_barrier
    ds_read_b128 v[48:51], v198 offset:2496
    ds_read_b128 v[52:55], v198 offset:2432
    v_mfma_f32_16x16x32_bf16 v[36:39], a[248:251], v[156:159], v[36:39]
    ds_read_b128 v[56:59], v198 offset:2368
    buffer_load_dwordx4 v15, s[4:7], s26 offen offset:2048 sc1 lds
    v_mfma_f32_16x16x32_bf16 v[36:39], a[252:255], v[152:155], v[36:39]
    ds_read_b128 v[60:63], v198 offset:2304
    v_mfma_f32_16x16x32_bf16 v[40:43], a[252:255], v[156:159], v[40:43]
    ds_read_b128 v[64:67], v198 offset:2240
    v_mfma_f32_16x16x32_bf16 v[32:35], v[128:131], v[144:147], v[32:35]
    ds_read_b128 v[68:71], v198 offset:2176
    v_mfma_f32_16x16x32_bf16 v[36:39], v[128:131], v[148:151], v[36:39]
    ds_read_b128 v[72:75], v198 offset:2112
    buffer_load_dwordx4 v15, s[4:7], s26 offen offset:3072 sc1 lds
    v_mfma_f32_16x16x32_bf16 v[40:43], v[128:131], v[152:155], v[40:43]
    ds_read_b128 v[76:79], v198 offset:2048
    v_cvt_pk_bf16_f32 v176, v16, v17
    v_mfma_f32_16x16x32_bf16 v[44:47], v[128:131], v[156:159], v[44:47]
    ds_read_b128 v[204:207], v222 offset:2048
    v_cvt_pk_bf16_f32 v177, v18, v19
    v_mfma_f32_16x16x32_bf16 v[36:39], v[132:135], v[144:147], v[36:39]
    ds_read_b128 v[208:211], v222 offset:2560
    ds_write_b64 v199, v[176:177] offset:0
    v_mfma_f32_16x16x32_bf16 v[40:43], v[132:135], v[148:151], v[40:43]
    ds_read_b128 v[212:215], v222 offset:3072
    buffer_load_dwordx4 a[0:3], v15, s[4:7], s27 offen offset:0 sc1
    v_mfma_f32_16x16x32_bf16 v[44:47], v[132:135], v[152:155], v[44:47]
    ds_read_b128 v[216:219], v222 offset:3584
    v_cvt_pk_bf16_f32 v178, v20, v21
    v_mfma_f32_16x16x32_bf16 v[40:43], v[136:139], v[144:147], v[40:43]
    v_cvt_pk_bf16_f32 v179, v22, v23
    ds_write_b64 v199, v[178:179] offset:512
    v_mfma_f32_16x16x32_bf16 v[44:47], v[136:139], v[148:151], v[44:47]
    v_cvt_pk_bf16_f32 v180, v24, v25
    v_cvt_pk_bf16_f32 v181, v26, v27
    v_mfma_f32_16x16x32_bf16 v[44:47], v[140:143], v[144:147], v[44:47]
    buffer_load_dwordx4 a[4:7], v15, s[4:7], s27 offen offset:1024 sc1
    ds_write_b64 v199, v[180:181] offset:1024
    s_waitcnt lgkmcnt(0)
    v_mfma_f32_16x16x32_bf16 v[32:35], v[200:203], v[204:207], v[32:35]
    ds_read_b128 v[112:115], v198 offset:3008
    v_cvt_pk_bf16_f32 v182, v28, v29
    v_mfma_f32_16x16x32_bf16 v[32:35], a[128:131], v[48:51], v[32:35]
    ds_read_b128 v[116:119], v198 offset:2944
    v_cvt_pk_bf16_f32 v183, v30, v31
    v_mfma_f32_16x16x32_bf16 v[32:35], a[144:147], v[52:55], v[32:35]
    ds_read_b128 v[120:123], v198 offset:2880
    ds_write_b64 v199, v[182:183] offset:1536
    v_mfma_f32_16x16x32_bf16 v[32:35], a[160:163], v[56:59], v[32:35]
    ds_read_b128 v[124:127], v198 offset:2816
    buffer_load_dwordx4 a[8:11], v15, s[4:7], s27 offen offset:2048 sc1
    v_mfma_f32_16x16x32_bf16 v[32:35], a[176:179], v[60:63], v[32:35]
    ds_read_b128 v[128:131], v198 offset:2752
    v_mfma_f32_16x16x32_bf16 v[32:35], a[192:195], v[64:67], v[32:35]
    ds_read_b128 v[132:135], v198 offset:2688
    v_mfma_f32_16x16x32_bf16 v[32:35], a[208:211], v[68:71], v[32:35]
    ds_read_b128 v[136:139], v198 offset:2624
    v_mfma_f32_16x16x32_bf16 v[32:35], a[224:227], v[72:75], v[32:35]
    ds_read_b128 v[140:143], v198 offset:2560
    buffer_load_dwordx4 a[12:15], v15, s[4:7], s27 offen offset:3072 sc1
    s_add_u32 s27, s27, 4096
    v_mfma_f32_16x16x32_bf16 v[32:35], a[240:243], v[76:79], v[32:35]
    v_mfma_f32_16x16x32_bf16 v[36:39], a[132:135], v[48:51], v[36:39]
    v_mfma_f32_16x16x32_bf16 v[36:39], a[148:151], v[52:55], v[36:39]
    v_mfma_f32_16x16x32_bf16 v[36:39], a[164:167], v[56:59], v[36:39]
    v_mfma_f32_16x16x32_bf16 v[36:39], a[180:183], v[60:63], v[36:39]
    s_nop 3
    v_cvt_pk_bf16_f32 v184, v32, v33
    v_cvt_pk_bf16_f32 v185, v34, v35
    v_mfma_f32_16x16x32_bf16 v[36:39], a[196:199], v[64:67], v[36:39]
    ds_write_b64 v199, v[184:185] offset:2048
    v_mov_b32 v252, s48
    v_mfma_f32_16x16x32_bf16 v[36:39], a[212:215], v[68:71], v[36:39]
    v_mov_b32 v253, s49
    v_lshlrev_b32 v254, 3, v0
    v_mfma_f32_16x16x32_bf16 v[36:39], a[228:231], v[72:75], v[36:39]
    v_mfma_f32_16x16x32_bf16 v[36:39], a[244:247], v[76:79], v[36:39]
    v_mfma_f32_16x16x32_bf16 v[40:43], a[136:139], v[48:51], v[40:43]
    s_waitcnt lgkmcnt(0)
    s_barrier
    ds_read_b64_tr_b16 v[232:233], v223 offset:0
    v_mfma_f32_16x16x32_bf16 v[40:43], a[152:155], v[52:55], v[40:43]
    ds_read_b64_tr_b16 v[234:235], v223 offset:32
    ds_read_b64_tr_b16 v[236:237], v223 offset:1024
    v_mfma_f32_16x16x32_bf16 v[40:43], a[168:171], v[56:59], v[40:43]
    ds_read_b64_tr_b16 v[238:239], v223 offset:1056
    ds_read_b64_tr_b16 v[240:241], v223 offset:2048
    v_mfma_f32_16x16x32_bf16 v[40:43], a[184:187], v[60:63], v[40:43]
    ds_read_b64_tr_b16 v[242:243], v223 offset:2080
    v_mfma_f32_16x16x32_bf16 v[40:43], a[200:203], v[64:67], v[40:43]
    v_mfma_f32_16x16x32_bf16 v[40:43], a[216:219], v[68:71], v[40:43]
    v_mfma_f32_16x16x32_bf16 v[40:43], a[232:235], v[72:75], v[40:43]
    v_mfma_f32_16x16x32_bf16 v[40:43], a[248:251], v[76:79], v[40:43]
    v_mfma_f32_16x16x32_bf16 v[44:47], a[140:143], v[48:51], v[44:47]
    v_mfma_f32_16x16x32_bf16 v[44:47], a[156:159], v[52:55], v[44:47]
    s_waitcnt lgkmcnt(0)
    buffer_store_dwordx4 v[232:235], v15, s[4:7], s18 offen sc1
    v_mfma_f32_16x16x32_bf16 v[44:47], a[172:175], v[56:59], v[44:47]
    buffer_store_dwordx4 v[236:239], v15, s[4:7], s30 offen sc1
    buffer_store_dwordx4 v[240:243], v15, s[4:7], s31 offen sc1
    v_mfma_f32_16x16x32_bf16 v[44:47], a[188:191], v[60:63], v[44:47]
    v_mfma_f32_16x16x32_bf16 v[44:47], a[204:207], v[64:67], v[44:47]
    buffer_load_dwordx4 a[16:19], v15, s[4:7], s27 offen offset:0 sc1
    v_mfma_f32_16x16x32_bf16 v[44:47], a[220:223], v[68:71], v[44:47]
    v_mfma_f32_16x16x32_bf16 v[44:47], a[236:239], v[72:75], v[44:47]
    v_mfma_f32_16x16x32_bf16 v[44:47], a[252:255], v[76:79], v[44:47]
    v_mfma_f32_16x16x32_bf16 v[36:39], v[200:203], v[208:211], v[36:39]
    buffer_load_dwordx4 a[20:23], v15, s[4:7], s27 offen offset:1024 sc1
    v_mfma_f32_16x16x32_bf16 v[40:43], v[200:203], v[212:215], v[40:43]
    v_mfma_f32_16x16x32_bf16 v[44:47], v[200:203], v[216:219], v[44:47]
    s_waitcnt lgkmcnt(0)
    v_mfma_f32_16x16x32_bf16 v[36:39], a[128:131], v[112:115], v[36:39]
    ds_read_b128 v[48:51], v198 offset:3520
    v_mfma_f32_16x16x32_bf16 v[36:39], a[144:147], v[116:119], v[36:39]
    ds_read_b128 v[52:55], v198 offset:3456
    buffer_load_dwordx4 a[24:27], v15, s[4:7], s27 offen offset:2048 sc1
    v_mfma_f32_16x16x32_bf16 v[36:39], a[160:163], v[120:123], v[36:39]
    ds_read_b128 v[56:59], v198 offset:3392
    v_mfma_f32_16x16x32_bf16 v[36:39], a[176:179], v[124:127], v[36:39]
    ds_read_b128 v[60:63], v198 offset:3328
    v_mfma_f32_16x16x32_bf16 v[36:39], a[192:195], v[128:131], v[36:39]
    ds_read_b128 v[64:67], v198 offset:3264
    v_mfma_f32_16x16x32_bf16 v[36:39], a[208:211], v[132:135], v[36:39]
    ds_read_b128 v[68:71], v198 offset:3200
    buffer_load_dwordx4 a[28:31], v15, s[4:7], s27 offen offset:3072 sc1
    s_add_u32 s27, s27, 4096
    v_mfma_f32_16x16x32_bf16 v[36:39], a[224:227], v[136:139], v[36:39]
    ds_read_b128 v[72:75], v198 offset:3136
    v_mfma_f32_16x16x32_bf16 v[36:39], a[240:243], v[140:143], v[36:39]
    ds_read_b128 v[76:79], v198 offset:3072
    v_mfma_f32_16x16x32_bf16 v[40:43], a[132:135], v[112:115], v[40:43]
    ds_read_b128 v[80:83], v198 offset:4032
    v_mfma_f32_16x16x32_bf16 v[40:43], a[148:151], v[116:119], v[40:43]
    ds_read_b128 v[84:87], v198 offset:3968
    buffer_load_dwordx4 a[32:35], v15, s[4:7], s27 offen offset:0 sc1
    v_mfma_f32_16x16x32_bf16 v[40:43], a[164:167], v[120:123], v[40:43]
    ds_read_b128 v[88:91], v198 offset:3904
    v_mfma_f32_16x16x32_bf16 v[40:43], a[180:183], v[124:127], v[40:43]
    ds_read_b128 v[92:95], v198 offset:3840
    v_mfma_f32_16x16x32_bf16 v[40:43], a[196:199], v[128:131], v[40:43]
    ds_read_b128 v[96:99], v198 offset:3776
    v_mfma_f32_16x16x32_bf16 v[40:43], a[212:215], v[132:135], v[40:43]
    ds_read_b128 v[100:103], v198 offset:3712
    buffer_load_dwordx4 a[36:39], v15, s[4:7], s27 offen offset:1024 sc1
    v_mfma_f32_16x16x32_bf16 v[40:43], a[228:231], v[136:139], v[40:43]
    ds_read_b128 v[104:107], v198 offset:3648
    v_mfma_f32_16x16x32_bf16 v[40:43], a[244:247], v[140:143], v[40:43]
    ds_read_b128 v[108:111], v198 offset:3584
    v_mfma_f32_16x16x32_bf16 v[44:47], a[136:139], v[112:115], v[44:47]
    v_mfma_f32_16x16x32_bf16 v[44:47], a[152:155], v[116:119], v[44:47]
    buffer_load_dwordx4 a[40:43], v15, s[4:7], s27 offen offset:2048 sc1
    v_mfma_f32_16x16x32_bf16 v[44:47], a[168:171], v[120:123], v[44:47]
    v_mfma_f32_16x16x32_bf16 v[44:47], a[184:187], v[124:127], v[44:47]
    v_mfma_f32_16x16x32_bf16 v[44:47], a[200:203], v[128:131], v[44:47]
    v_mfma_f32_16x16x32_bf16 v[44:47], a[216:219], v[132:135], v[44:47]
    buffer_load_dwordx4 a[44:47], v15, s[4:7], s27 offen offset:3072 sc1
    s_add_u32 s27, s27, 4096
    v_mfma_f32_16x16x32_bf16 v[44:47], a[232:235], v[136:139], v[44:47]
    v_mfma_f32_16x16x32_bf16 v[44:47], a[248:251], v[140:143], v[44:47]
    s_waitcnt lgkmcnt(0)
    v_mfma_f32_16x16x32_bf16 v[40:43], a[128:131], v[48:51], v[40:43]
    v_mfma_f32_16x16x32_bf16 v[40:43], a[144:147], v[52:55], v[40:43]
    v_mfma_f32_16x16x32_bf16 v[40:43], a[160:163], v[56:59], v[40:43]
    v_mfma_f32_16x16x32_bf16 v[40:43], a[176:179], v[60:63], v[40:43]
    v_mfma_f32_16x16x32_bf16 v[40:43], a[192:195], v[64:67], v[40:43]
    v_mfma_f32_16x16x32_bf16 v[40:43], a[208:211], v[68:71], v[40:43]
    v_mfma_f32_16x16x32_bf16 v[40:43], a[224:227], v[72:75], v[40:43]
    v_mfma_f32_16x16x32_bf16 v[40:43], a[240:243], v[76:79], v[40:43]
    v_mfma_f32_16x16x32_bf16 v[44:47], a[132:135], v[48:51], v[44:47]
    v_mfma_f32_16x16x32_bf16 v[44:47], a[148:151], v[52:55], v[44:47]
    v_mfma_f32_16x16x32_bf16 v[44:47], a[164:167], v[56:59], v[44:47]
    v_mfma_f32_16x16x32_bf16 v[44:47], a[180:183], v[60:63], v[44:47]
    v_mfma_f32_16x16x32_bf16 v[44:47], a[196:199], v[64:67], v[44:47]
    v_mfma_f32_16x16x32_bf16 v[44:47], a[212:215], v[68:71], v[44:47]
    v_mfma_f32_16x16x32_bf16 v[44:47], a[228:231], v[72:75], v[44:47]
    v_mfma_f32_16x16x32_bf16 v[44:47], a[244:247], v[76:79], v[44:47]
    v_mfma_f32_16x16x32_bf16 v[44:47], a[128:131], v[80:83], v[44:47]
    v_mfma_f32_16x16x32_bf16 v[44:47], a[144:147], v[84:87], v[44:47]
    s_waitcnt vmcnt(8)
    s_mov_b64 exec, 0xffff
    buffer_store_dwordx2 v[252:253], v254, s[4:7], s19 offen offset:0 sc1
    s_mov_b64 exec, -1
    v_mfma_f32_16x16x32_bf16 v[44:47], a[160:163], v[88:91], v[44:47]
    v_mfma_f32_16x16x32_bf16 v[44:47], a[176:179], v[92:95], v[44:47]
    v_mfma_f32_16x16x32_bf16 v[44:47], a[192:195], v[96:99], v[44:47]
    v_mfma_f32_16x16x32_bf16 v[44:47], a[208:211], v[100:103], v[44:47]
    v_mfma_f32_16x16x32_bf16 v[44:47], a[224:227], v[104:107], v[44:47]
    v_mfma_f32_16x16x32_bf16 v[44:47], a[240:243], v[108:111], v[44:47]
    v_cvt_pk_bf16_f32 v186, v36, v37
    v_cvt_pk_bf16_f32 v187, v38, v39
    ds_write_b64 v199, v[186:187] offset:2560
    v_cvt_pk_bf16_f32 v188, v40, v41
    v_cvt_pk_bf16_f32 v189, v42, v43
    ds_write_b64 v199, v[188:189] offset:3072
    s_nop 1
    v_cvt_pk_bf16_f32 v190, v44, v45
    v_cvt_pk_bf16_f32 v191, v46, v47
    ds_write_b64 v199, v[190:191] offset:3584
    s_waitcnt lgkmcnt(0)
    s_barrier
    ds_read_b64_tr_b16 v[232:233], v223 offset:2560
    ds_read_b64_tr_b16 v[234:235], v223 offset:2592
    ds_read_b64_tr_b16 v[236:237], v223 offset:3584
    ds_read_b64_tr_b16 v[238:239], v223 offset:3616
    s_waitcnt lgkmcnt(2)
    buffer_store_dwordx4 v[232:235], v15, s[4:7], s32 offen sc1
    s_waitcnt lgkmcnt(0)
    buffer_store_dwordx4 v[236:239], v15, s[4:7], s33 offen sc1
    s_mul_i32 s25, s3, 3072
    s_add_u32 s25, s25, 81920
    s_add_u32 s26, s24, s25
    s_mov_b32 m0, s25
    s_nop 0
    buffer_load_dwordx4 v15, s[4:7], s26 offen offset:0 sc1 lds
    buffer_load_dwordx4 v15, s[4:7], s26 offen offset:1024 sc1 lds
    buffer_load_dwordx4 v15, s[4:7], s26 offen offset:2048 sc1 lds
    s_add_u32 s25, s25, 12288
    s_add_u32 s26, s26, 12288
    s_mov_b32 m0, s25
    s_nop 0
    buffer_load_dwordx4 v15, s[4:7], s26 offen offset:0 sc1 lds
    buffer_load_dwordx4 v15, s[4:7], s26 offen offset:1024 sc1 lds
    buffer_load_dwordx4 v15, s[4:7], s26 offen offset:2048 sc1 lds
    s_add_u32 s25, s25, 12288
    s_add_u32 s26, s26, 12288
    s_mov_b32 m0, s25
    s_nop 0
    buffer_load_dwordx4 v15, s[4:7], s26 offen offset:0 sc1 lds
    buffer_load_dwordx4 v15, s[4:7], s26 offen offset:1024 sc1 lds
    s_waitcnt vmcnt(8)
    s_mov_b64 exec, 0xffff
    buffer_store_dwordx2 v[252:253], v254, s[4:7], s19 offen offset:128 sc1
    s_mov_b64 exec, -1
    buffer_load_dwordx4 v15, s[4:7], s26 offen offset:2048 sc1 lds
    s_add_u32 s25, s25, 12288
    s_add_u32 s26, s26, 12288
    s_mov_b32 m0, s25
    s_nop 0
    buffer_load_dwordx4 v15, s[4:7], s26 offen offset:0 sc1 lds
    buffer_load_dwordx4 v15, s[4:7], s26 offen offset:1024 sc1 lds
    buffer_load_dwordx4 v15, s[4:7], s26 offen offset:2048 sc1 lds
    s_add_u32 s25, s25, 12288
    s_add_u32 s26, s26, 12288
    s_mov_b32 m0, s25
    s_nop 0
    buffer_load_dwordx4 v15, s[4:7], s26 offen offset:0 sc1 lds
    buffer_load_dwordx4 v15, s[4:7], s26 offen offset:1024 sc1 lds
    buffer_load_dwordx4 v15, s[4:7], s26 offen offset:2048 sc1 lds
    buffer_load_dwordx4 a[48:51], v15, s[4:7], s27 offen offset:0 sc1
    buffer_load_dwordx4 a[52:55], v15, s[4:7], s27 offen offset:1024 sc1
    buffer_load_dwordx4 a[56:59], v15, s[4:7], s27 offen offset:2048 sc1
    buffer_load_dwordx4 a[60:63], v15, s[4:7], s27 offen offset:3072 sc1
    s_add_u32 s27, s27, 4096
    buffer_load_dwordx4 a[64:67], v15, s[4:7], s27 offen offset:0 sc1
    buffer_load_dwordx4 a[68:71], v15, s[4:7], s27 offen offset:1024 sc1
    buffer_load_dwordx4 a[72:75], v15, s[4:7], s27 offen offset:2048 sc1
    buffer_load_dwordx4 a[76:79], v15, s[4:7], s27 offen offset:3072 sc1
    s_add_u32 s27, s27, 4096
    buffer_load_dwordx4 a[80:83], v15, s[4:7], s27 offen offset:0 sc1
    buffer_load_dwordx4 a[84:87], v15, s[4:7], s27 offen offset:1024 sc1
    s_mov_b32 s8, s16
    s_and_b32 s9, s17, 0xffff
    s_mov_b32 s10, 0x280000
    s_mov_b32 s11, 0x20000
    v_min_u32 v1, 39, v0
    v_lshlrev_b32 v1, 10, v1
    s_mul_i32 s18, s3, 40960
    s_cmp_lt_u32 s20, 10
    s_cselect_b32 s19, 0, 2
    s_cselect_b32 s29, 0, 128
    s_add_u32 s19, s19, s20
    s_and_b32 s19, s19, 3
    s_lshl_b32 s19, s19, 8
    s_add_u32 s18, s18, s19
    s_add_u32 s18, s18, s29
    s_add_u32 s18, s18, 17313792
    v_and_b32 v3, 15, v0
    v_lshrrev_b32 v4, 4, v0
    v_mul_u32_u24 v5, 33536, v4
    v_lshl_add_u32 v5, v3, 4, v5
    v_add_u32 v6, 16768, v5
    v_add_u32 v7, 0x10000, v15
    v_add_u32 v8, 0x20000, v15
    s_lshl_b32 s30, s20, 2
    s_add_u32 s30, s30, s3
    s_lshl_b32 s31, s30, 8
    s_add_u32 s46, s31, 36864
    s_and_b32 s47, s21, 0
    s_and_b32 s29, s23, 0
    s_lshl_b32 s29, s29, 12
    s_mul_i32 s31, s47, 134144
    s_add_u32 s31, s31, s46
    s_lshr_b32 s32, s3, 1
    s_lshl_b32 s33, s20, 1
    s_add_u32 s32, s32, s33
    s_mul_i32 s32, s32, 56
    s_lshr_b32 s33, s21, 2
    s_mul_i32 s33, s33, 14
    s_add_u32 s32, s32, s33
    s_lshl_b32 s32, s32, 12
    s_and_b32 s33, s3, 1
    s_lshl_b32 s33, s33, 11
    s_add_u32 s32, s32, s33
    s_add_u32 s32, s32, 9900032
    s_and_b32 s33, s21, 3
    s_lshl_b32 s34, s33, 13
    s_add_u32 s34, s34, s32
    s_add_u32 s38, s34, 4096
    s_add_u32 s35, s33, 8
    s_lshl_b32 s35, s35, 12
    s_add_u32 s35, s35, s32
    s_lshr_b32 s37, s33, 1
    s_add_u32 s37, s37, 12
    s_lshl_b32 s37, s37, 12
    s_add_u32 s37, s37, s32
    s_and_b32 s36, s33, 1
    s_lshl_b32 s36, s36, 9
    s_add_u32 s37, s37, s36
    s_lshl_b32 s36, s20, 4
    s_add_u32 s36, s36, s21
    s_lshl_b32 s36, s36, 2
    s_add_u32 s36, s36, s3
    s_lshl_b32 s36, s36, 8
    s_add_u32 s36, s36, 17477632
    s_lshl_b32 s39, s20, 2
    s_add_u32 s39, s39, s3
    s_lshl_b32 s39, s39, 12
    s_and_b32 s40, s22, 1
    s_lshl_b32 s40, s40, 9
    s_add_u32 s39, s39, s40
    s_add_u32 s39, s39, 17477632
    s_mul_i32 s40, s22, 56
    s_mul_i32 s41, s3, 14
    s_add_u32 s40, s40, s41
    s_lshl_b32 s40, s40, 12
    s_add_u32 s40, s40, 9900032
    s_mov_b32 s45, s40
    s_add_u32 s40, s45, s29
    s_lshl_b32 s41, s22, 2
    s_add_u32 s41, s41, s3
    s_lshr_b32 s42, s41, 1
    s_lshl_b32 s42, s42, 8
    s_and_b32 s43, s41, 1
    s_lshl_b32 s43, s43, 3
    s_add_u32 s42, s42, s43
    s_mul_i32 s43, s23, 335360
    s_add_u32 s42, s42, s43
    s_add_u32 s42, s42, 36864
    s_mul_i32 s44, s41, 20480
    s_mul_i32 s43, s23, 160
    s_add_u32 s44, s44, s43
    v_lshlrev_b32 v10, 4, v4
    v_add_u32 v10, 143360, v10
    v_bfe_u32 v11, v0, 1, 2
    v_lshlrev_b32 v11, 10, v11
    v_and_b32 v12, 1, v0
    v_lshl_add_u32 v11, v12, 8, v11
    s_mov_b32 s58, 0
L_sp2c:
    buffer_load_dwordx2 v[228:229], v1, s[4:7], s18 offen sc1
    s_add_u32 s58, s58, 1
    s_waitcnt vmcnt(0)
    v_cmp_eq_u64 vcc, s[48:49], v[228:229]
    s_cmp_eq_u64 vcc, exec
    s_cbranch_scc1 L_sp2c_out
    s_sleep 1
    s_cmp_le_u32 s58, 200000
    s_cbranch_scc1 L_sp2c
L_sp2c_out:
    v_add_f32 v224, v224, v225
    v_add_f32 v224, v224, v226
    v_add_f32 v224, v224, v227
    v_add_u32 v14, 143360, v14
    ds_write_b32 v14, v224
    s_waitcnt lgkmcnt(0)
    s_barrier
    buffer_load_dwordx4 v[16:19], v5, s[4:7], s31 offen sc1
    buffer_load_dwordx4 v[20:23], v6, s[4:7], s31 offen sc1
    s_add_u32 s31, s31, 134144
    buffer_load_dwordx4 v[24:27], v5, s[4:7], s31 offen sc1
    buffer_load_dwordx4 v[28:31], v6, s[4:7], s31 offen sc1
    s_add_u32 s31, s31, 134144
    buffer_load_dwordx4 v[32:35], v5, s[4:7], s31 offen sc1
    buffer_load_dwordx4 v[36:39], v6, s[4:7], s31 offen sc1
    s_add_u32 s31, s31, 134144
    buffer_load_dwordx4 v[40:43], v5, s[4:7], s31 offen sc1
    buffer_load_dwordx4 v[44:47], v6, s[4:7], s31 offen sc1
    s_add_u32 s31, s31, 134144
    buffer_load_dwordx4 v[48:51], v5, s[4:7], s31 offen sc1
    buffer_load_dwordx4 v[52:55], v6, s[4:7], s31 offen sc1
    s_add_u32 s31, s31, 134144
    buffer_load_dwordx4 v[56:59], v5, s[4:7], s31 offen sc1
    buffer_load_dwordx4 v[60:63], v6, s[4:7], s31 offen sc1
    s_add_u32 s31, s31, 134144
    ds_read_b128 a[224:227], v15 offset:0
    ds_read_b128 a[228:231], v15 offset:1024
    ds_read_b128 a[232:235], v15 offset:2048
    ds_read_b128 a[236:239], v15 offset:3072
    s_waitcnt vmcnt(10)
    v_swap_b32 v18, v20
    v_swap_b32 v19, v21
    s_nop 1
    v_mfma_f32_16x16x32_bf16 v[232:235], v[16:19], v[16:19], 0
    buffer_load_dwordx4 v[64:67], v5, s[4:7], s31 offen sc1
    v_mfma_f32_16x16x32_bf16 v[236:239], v[20:23], v[20:23], 0
    s_waitcnt lgkmcnt(0)
    v_mfma_f32_16x16x32_bf16 v[176:179], a[224:227], v[16:19], 0
    ds_read_b128 a[240:243], v15 offset:4096
    v_mfma_f32_16x16x32_bf16 v[192:195], a[224:227], v[20:23], 0
    ds_read_b128 a[244:247], v15 offset:5120
    buffer_load_dwordx4 v[68:71], v6, s[4:7], s31 offen sc1
    s_add_u32 s31, s31, 134144
    v_mfma_f32_16x16x32_bf16 v[180:183], a[228:231], v[16:19], 0
    ds_read_b128 a[248:251], v15 offset:6144
    v_mfma_f32_16x16x32_bf16 v[196:199], a[228:231], v[20:23], 0
    ds_read_b128 a[252:255], v15 offset:7168
    v_mfma_f32_16x16x32_bf16 v[184:187], a[232:235], v[16:19], 0
    buffer_load_dwordx4 v[72:75], v5, s[4:7], s31 offen sc1
    v_mfma_f32_16x16x32_bf16 v[200:203], a[232:235], v[20:23], 0
    s_waitcnt vmcnt(11)
    v_swap_b32 v26, v28
    v_swap_b32 v27, v29
    v_mfma_f32_16x16x32_bf16 v[188:191], a[236:239], v[16:19], 0
    v_mfma_f32_16x16x32_bf16 v[204:207], a[236:239], v[20:23], 0
    v_mfma_f32_16x16x32_bf16 v[232:235], v[24:27], v[24:27], v[232:235]
    buffer_load_dwordx4 v[76:79], v6, s[4:7], s31 offen sc1
    s_add_u32 s31, s31, 134144
    v_mfma_f32_16x16x32_bf16 v[236:239], v[28:31], v[28:31], v[236:239]
    s_waitcnt lgkmcnt(0)
    v_mfma_f32_16x16x32_bf16 v[176:179], a[240:243], v[24:27], v[176:179]
    ds_read_b128 a[224:227], v15 offset:8192
    v_mfma_f32_16x16x32_bf16 v[192:195], a[240:243], v[28:31], v[192:195]
    ds_read_b128 a[228:231], v15 offset:9216
    buffer_load_dwordx4 v[80:83], v5, s[4:7], s31 offen sc1
    v_mfma_f32_16x16x32_bf16 v[180:183], a[244:247], v[24:27], v[180:183]
    ds_read_b128 a[232:235], v15 offset:10240
    v_mfma_f32_16x16x32_bf16 v[196:199], a[244:247], v[28:31], v[196:199]
    ds_read_b128 a[236:239], v15 offset:11264
    v_mfma_f32_16x16x32_bf16 v[184:187], a[248:251], v[24:27], v[184:187]
    buffer_load_dwordx4 v[84:87], v6, s[4:7], s31 offen sc1
    s_add_u32 s31, s31, 134144
    v_mfma_f32_16x16x32_bf16 v[200:203], a[248:251], v[28:31], v[200:203]
    s_waitcnt vmcnt(12)
    v_swap_b32 v34, v36
    v_swap_b32 v35, v37
    v_mfma_f32_16x16x32_bf16 v[188:191], a[252:255], v[24:27], v[188:191]
    v_mfma_f32_16x16x32_bf16 v[204:207], a[252:255], v[28:31], v[204:207]
    v_mfma_f32_16x16x32_bf16 v[232:235], v[32:35], v[32:35], v[232:235]
    buffer_load_dwordx4 v[88:91], v5, s[4:7], s31 offen sc1
    v_mfma_f32_16x16x32_bf16 v[236:239], v[36:39], v[36:39], v[236:239]
    s_waitcnt lgkmcnt(0)
    v_mfma_f32_16x16x32_bf16 v[176:179], a[224:227], v[32:35], v[176:179]
    ds_read_b128 a[240:243], v15 offset:12288
    v_mfma_f32_16x16x32_bf16 v[192:195], a[224:227], v[36:39], v[192:195]
    ds_read_b128 a[244:247], v15 offset:13312
    buffer_load_dwordx4 v[92:95], v6, s[4:7], s31 offen sc1
    s_add_u32 s31, s31, 134144
    v_mfma_f32_16x16x32_bf16 v[180:183], a[228:231], v[32:35], v[180:183]
    ds_read_b128 a[248:251], v15 offset:14336
    v_mfma_f32_16x16x32_bf16 v[196:199], a[228:231], v[36:39], v[196:199]
    ds_read_b128 a[252:255], v15 offset:15360
    v_mfma_f32_16x16x32_bf16 v[184:187], a[232:235], v[32:35], v[184:187]
    buffer_load_dwordx4 v[96:99], v5, s[4:7], s31 offen sc1
    v_mfma_f32_16x16x32_bf16 v[200:203], a[232:235], v[36:39], v[200:203]
    s_waitcnt vmcnt(13)
    v_swap_b32 v42, v44
    v_swap_b32 v43, v45
    v_mfma_f32_16x16x32_bf16 v[188:191], a[236:239], v[32:35], v[188:191]
    v_mfma_f32_16x16x32_bf16 v[204:207], a[236:239], v[36:39], v[204:207]
    v_mfma_f32_16x16x32_bf16 v[232:235], v[40:43], v[40:43], v[232:235]
    buffer_load_dwordx4 v[100:103], v6, s[4:7], s31 offen sc1
    s_add_u32 s31, s31, 134144
    v_mfma_f32_16x16x32_bf16 v[236:239], v[44:47], v[44:47], v[236:239]
    s_waitcnt lgkmcnt(0)
    v_mfma_f32_16x16x32_bf16 v[176:179], a[240:243], v[40:43], v[176:179]
    ds_read_b128 a[224:227], v15 offset:16384
    v_mfma_f32_16x16x32_bf16 v[192:195], a[240:243], v[44:47], v[192:195]
    ds_read_b128 a[228:231], v15 offset:17408
    buffer_load_dwordx4 v[104:107], v5, s[4:7], s31 offen sc1
    v_mfma_f32_16x16x32_bf16 v[180:183], a[244:247], v[40:43], v[180:183]
    ds_read_b128 a[232:235], v15 offset:18432
    v_mfma_f32_16x16x32_bf16 v[196:199], a[244:247], v[44:47], v[196:199]
    ds_read_b128 a[236:239], v15 offset:19456
    v_mfma_f32_16x16x32_bf16 v[184:187], a[248:251], v[40:43], v[184:187]
    buffer_load_dwordx4 v[108:111], v6, s[4:7], s31 offen sc1
    s_add_u32 s31, s31, 134144
    v_mfma_f32_16x16x32_bf16 v[200:203], a[248:251], v[44:47], v[200:203]
    s_waitcnt vmcnt(14)
    v_swap_b32 v50, v52
    v_swap_b32 v51, v53
    v_mfma_f32_16x16x32_bf16 v[188:191], a[252:255], v[40:43], v[188:191]
    v_mfma_f32_16x16x32_bf16 v[204:207], a[252:255], v[44:47], v[204:207]
    v_mfma_f32_16x16x32_bf16 v[232:235], v[48:51], v[48:51], v[232:235]
    buffer_load_dwordx4 v[112:115], v5, s[4:7], s31 offen sc1
    v_mfma_f32_16x16x32_bf16 v[236:239], v[52:55], v[52:55], v[236:239]
    s_waitcnt lgkmcnt(0)
    v_mfma_f32_16x16x32_bf16 v[176:179], a[224:227], v[48:51], v[176:179]
    ds_read_b128 a[240:243], v15 offset:20480
    v_mfma_f32_16x16x32_bf16 v[192:195], a[224:227], v[52:55], v[192:195]
    ds_read_b128 a[244:247], v15 offset:21504
    buffer_load_dwordx4 v[116:119], v6, s[4:7], s31 offen sc1
    s_add_u32 s31, s31, 134144
    v_mfma_f32_16x16x32_bf16 v[180:183], a[228:231], v[48:51], v[180:183]
    ds_read_b128 a[248:251], v15 offset:22528
    v_mfma_f32_16x16x32_bf16 v[196:199], a[228:231], v[52:55], v[196:199]
    ds_read_b128 a[252:255], v15 offset:23552
    v_mfma_f32_16x16x32_bf16 v[184:187], a[232:235], v[48:51], v[184:187]
    buffer_load_dwordx4 v[120:123], v5, s[4:7], s31 offen sc1
    v_mfma_f32_16x16x32_bf16 v[200:203], a[232:235], v[52:55], v[200:203]
    s_waitcnt vmcnt(15)
    v_swap_b32 v58, v60
    v_swap_b32 v59, v61
    v_mfma_f32_16x16x32_bf16 v[188:191], a[236:239], v[48:51], v[188:191]
    v_mfma_f32_16x16x32_bf16 v[204:207], a[236:239], v[52:55], v[204:207]
    v_mfma_f32_16x16x32_bf16 v[232:235], v[56:59], v[56:59], v[232:235]
    buffer_load_dwordx4 v[124:127], v6, s[4:7], s31 offen sc1
    s_add_u32 s31, s31, 134144
    v_mfma_f32_16x16x32_bf16 v[236:239], v[60:63], v[60:63], v[236:239]
    s_waitcnt lgkmcnt(0)
    v_mfma_f32_16x16x32_bf16 v[176:179], a[240:243], v[56:59], v[176:179]
    ds_read_b128 a[224:227], v15 offset:24576
    v_mfma_f32_16x16x32_bf16 v[192:195], a[240:243], v[60:63], v[192:195]
    ds_read_b128 a[228:231], v15 offset:25600
    buffer_load_dwordx4 v[128:131], v5, s[4:7], s31 offen sc1
    v_mfma_f32_16x16x32_bf16 v[180:183], a[244:247], v[56:59], v[180:183]
    ds_read_b128 a[232:235], v15 offset:26624
    v_mfma_f32_16x16x32_bf16 v[196:199], a[244:247], v[60:63], v[196:199]
    ds_read_b128 a[236:239], v15 offset:27648
    v_mfma_f32_16x16x32_bf16 v[184:187], a[248:251], v[56:59], v[184:187]
    buffer_load_dwordx4 v[132:135], v6, s[4:7], s31 offen sc1
    s_add_u32 s31, s31, 134144
    v_mfma_f32_16x16x32_bf16 v[200:203], a[248:251], v[60:63], v[200:203]
    s_waitcnt vmcnt(16)
    v_swap_b32 v66, v68
    v_swap_b32 v67, v69
    v_mfma_f32_16x16x32_bf16 v[188:191], a[252:255], v[56:59], v[188:191]
    v_mfma_f32_16x16x32_bf16 v[204:207], a[252:255], v[60:63], v[204:207]
    v_mfma_f32_16x16x32_bf16 v[232:235], v[64:67], v[64:67], v[232:235]
    buffer_load_dwordx4 v[136:139], v5, s[4:7], s31 offen sc1
    v_mfma_f32_16x16x32_bf16 v[236:239], v[68:71], v[68:71], v[236:239]
    s_waitcnt lgkmcnt(0)
    v_mfma_f32_16x16x32_bf16 v[176:179], a[224:227], v[64:67], v[176:179]
    ds_read_b128 a[240:243], v15 offset:28672
    v_mfma_f32_16x16x32_bf16 v[192:195], a[224:227], v[68:71], v[192:195]
    ds_read_b128 a[244:247], v15 offset:29696
    buffer_load_dwordx4 v[140:143], v6, s[4:7], s31 offen sc1
    s_add_u32 s31, s31, 134144
    v_mfma_f32_16x16x32_bf16 v[180:183], a[228:231], v[64:67], v[180:183]
    ds_read_b128 a[248:251], v15 offset:30720
    v_mfma_f32_16x16x32_bf16 v[196:199], a[228:231], v[68:71], v[196:199]
    ds_read_b128 a[252:255], v15 offset:31744
    v_mfma_f32_16x16x32_bf16 v[184:187], a[232:235], v[64:67], v[184:187]
    buffer_load_dwordx4 v[144:147], v5, s[4:7], s31 offen sc1
    v_mfma_f32_16x16x32_bf16 v[200:203], a[232:235], v[68:71], v[200:203]
    s_waitcnt vmcnt(17)
    v_swap_b32 v74, v76
    v_swap_b32 v75, v77
    v_mfma_f32_16x16x32_bf16 v[188:191], a[236:239], v[64:67], v[188:191]
    v_mfma_f32_16x16x32_bf16 v[204:207], a[236:239], v[68:71], v[204:207]
    v_mfma_f32_16x16x32_bf16 v[232:235], v[72:75], v[72:75], v[232:235]
    buffer_load_dwordx4 v[148:151], v6, s[4:7], s31 offen sc1
    s_add_u32 s31, s31, 134144
    v_mfma_f32_16x16x32_bf16 v[236:239], v[76:79], v[76:79], v[236:239]
    s_waitcnt lgkmcnt(0)
    v_mfma_f32_16x16x32_bf16 v[176:179], a[240:243], v[72:75], v[176:179]
    ds_read_b128 a[224:227], v15 offset:32768
    v_mfma_f32_16x16x32_bf16 v[192:195], a[240:243], v[76:79], v[192:195]
    ds_read_b128 a[228:231], v15 offset:33792
    buffer_load_dwordx4 v[152:155], v5, s[4:7], s31 offen sc1
    v_mfma_f32_16x16x32_bf16 v[180:183], a[244:247], v[72:75], v[180:183]
    ds_read_b128 a[232:235], v15 offset:34816
    v_mfma_f32_16x16x32_bf16 v[196:199], a[244:247], v[76:79], v[196:199]
    ds_read_b128 a[236:239], v15 offset:35840
    v_mfma_f32_16x16x32_bf16 v[184:187], a[248:251], v[72:75], v[184:187]
    buffer_load_dwordx4 v[156:159], v6, s[4:7], s31 offen sc1
    s_add_u32 s31, s31, 134144
    v_mfma_f32_16x16x32_bf16 v[200:203], a[248:251], v[76:79], v[200:203]
    s_waitcnt vmcnt(18)
    v_swap_b32 v82, v84
    v_swap_b32 v83, v85
    v_mfma_f32_16x16x32_bf16 v[188:191], a[252:255], v[72:75], v[188:191]
    v_mfma_f32_16x16x32_bf16 v[204:207], a[252:255], v[76:79], v[204:207]
    v_mfma_f32_16x16x32_bf16 v[232:235], v[80:83], v[80:83], v[232:235]
    buffer_load_dwordx4 v[160:163], v5, s[4:7], s31 offen sc1
    v_mfma_f32_16x16x32_bf16 v[236:239], v[84:87], v[84:87], v[236:239]
    s_waitcnt lgkmcnt(0)
    v_mfma_f32_16x16x32_bf16 v[176:179], a[224:227], v[80:83], v[176:179]
    ds_read_b128 a[240:243], v15 offset:36864
    v_mfma_f32_16x16x32_bf16 v[192:195], a[224:227], v[84:87], v[192:195]
    ds_read_b128 a[244:247], v15 offset:37888
    buffer_load_dwordx4 v[164:167], v6, s[4:7], s31 offen sc1
    s_add_u32 s31, s31, 134144
    v_mfma_f32_16x16x32_bf16 v[180:183], a[228:231], v[80:83], v[180:183]
    ds_read_b128 a[248:251], v15 offset:38912
    v_mfma_f32_16x16x32_bf16 v[196:199], a[228:231], v[84:87], v[196:199]
    ds_read_b128 a[252:255], v15 offset:39936
    v_mfma_f32_16x16x32_bf16 v[184:187], a[232:235], v[80:83], v[184:187]
    buffer_load_dwordx4 v[168:171], v5, s[4:7], s31 offen sc1
    v_mfma_f32_16x16x32_bf16 v[200:203], a[232:235], v[84:87], v[200:203]
    s_waitcnt vmcnt(19)
    v_swap_b32 v90, v92
    v_swap_b32 v91, v93
    v_mfma_f32_16x16x32_bf16 v[188:191], a[236:239], v[80:83], v[188:191]
    v_mfma_f32_16x16x32_bf16 v[204:207], a[236:239], v[84:87], v[204:207]
    v_mfma_f32_16x16x32_bf16 v[232:235], v[88:91], v[88:91], v[232:235]
    buffer_load_dwordx4 v[172:175], v6, s[4:7], s31 offen sc1
    v_mfma_f32_16x16x32_bf16 v[236:239], v[92:95], v[92:95], v[236:239]
    s_waitcnt lgkmcnt(0)
    v_mfma_f32_16x16x32_bf16 v[176:179], a[240:243], v[88:91], v[176:179]
    ds_read_b128 a[224:227], v15 offset:40960
    v_mfma_f32_16x16x32_bf16 v[192:195], a[240:243], v[92:95], v[192:195]
    ds_read_b128 a[228:231], v15 offset:41984
    v_mfma_f32_16x16x32_bf16 v[180:183], a[244:247], v[88:91], v[180:183]
    ds_read_b128 a[232:235], v15 offset:43008
    v_mfma_f32_16x16x32_bf16 v[196:199], a[244:247], v[92:95], v[196:199]
    ds_read_b128 a[236:239], v15 offset:44032
    v_mfma_f32_16x16x32_bf16 v[184:187], a[248:251], v[88:91], v[184:187]
    buffer_load_dwordx4 a[88:91], v15, s[4:7], s27 offen offset:2048 sc1
    v_mfma_f32_16x16x32_bf16 v[200:203], a[248:251], v[92:95], v[200:203]
    s_waitcnt vmcnt(19)
    v_swap_b32 v98, v100
    v_swap_b32 v99, v101
    v_mfma_f32_16x16x32_bf16 v[188:191], a[252:255], v[88:91], v[188:191]
    v_mfma_f32_16x16x32_bf16 v[204:207], a[252:255], v[92:95], v[204:207]
    v_mfma_f32_16x16x32_bf16 v[232:235], v[96:99], v[96:99], v[232:235]
    buffer_load_dwordx4 a[92:95], v15, s[4:7], s27 offen offset:3072 sc1
    s_add_u32 s27, s27, 4096
    v_mfma_f32_16x16x32_bf16 v[236:239], v[100:103], v[100:103], v[236:239]
    s_waitcnt lgkmcnt(0)
    v_mfma_f32_16x16x32_bf16 v[176:179], a[224:227], v[96:99], v[176:179]
    ds_read_b128 a[240:243], v15 offset:45056
    v_mfma_f32_16x16x32_bf16 v[192:195], a[224:227], v[100:103], v[192:195]
    ds_read_b128 a[244:247], v15 offset:46080
    v_mfma_f32_16x16x32_bf16 v[180:183], a[228:231], v[96:99], v[180:183]
    ds_read_b128 a[248:251], v15 offset:47104
    v_mfma_f32_16x16x32_bf16 v[196:199], a[228:231], v[100:103], v[196:199]
    ds_read_b128 a[252:255], v15 offset:48128
    v_mfma_f32_16x16x32_bf16 v[184:187], a[232:235], v[96:99], v[184:187]
    buffer_load_dwordx4 a[96:99], v15, s[4:7], s27 offen offset:0 sc1
    v_mfma_f32_16x16x32_bf16 v[200:203], a[232:235], v[100:103], v[200:203]
    s_waitcnt vmcnt(19)
    v_swap_b32 v106, v108
    v_swap_b32 v107, v109
    v_mfma_f32_16x16x32_bf16 v[188:191], a[236:239], v[96:99], v[188:191]
    v_mfma_f32_16x16x32_bf16 v[204:207], a[236:239], v[100:103], v[204:207]
    v_mfma_f32_16x16x32_bf16 v[232:235], v[104:107], v[104:107], v[232:235]
    buffer_load_dwordx4 a[100:103], v15, s[4:7], s27 offen offset:1024 sc1
    v_mfma_f32_16x16x32_bf16 v[236:239], v[108:111], v[108:111], v[236:239]
    s_waitcnt lgkmcnt(0)
    v_mfma_f32_16x16x32_bf16 v[176:179], a[240:243], v[104:107], v[176:179]
    ds_read_b128 a[224:227], v15 offset:49152
    v_mfma_f32_16x16x32_bf16 v[192:195], a[240:243], v[108:111], v[192:195]
    ds_read_b128 a[228:231], v15 offset:50176
    v_mfma_f32_16x16x32_bf16 v[180:183], a[244:247], v[104:107], v[180:183]
    ds_read_b128 a[232:235], v15 offset:51200
    v_mfma_f32_16x16x32_bf16 v[196:199], a[244:247], v[108:111], v[196:199]
    ds_read_b128 a[236:239], v15 offset:52224
    v_mfma_f32_16x16x32_bf16 v[184:187], a[248:251], v[104:107], v[184:187]
    buffer_load_dwordx4 a[104:107], v15, s[4:7], s27 offen offset:2048 sc1
    v_mfma_f32_16x16x32_bf16 v[200:203], a[248:251], v[108:111], v[200:203]
    s_waitcnt vmcnt(19)
    v_swap_b32 v114, v116
    v_swap_b32 v115, v117
    v_mfma_f32_16x16x32_bf16 v[188:191], a[252:255], v[104:107], v[188:191]
    v_mfma_f32_16x16x32_bf16 v[204:207], a[252:255], v[108:111], v[204:207]
    v_mfma_f32_16x16x32_bf16 v[232:235], v[112:115], v[112:115], v[232:235]
    buffer_load_dwordx4 a[108:111], v15, s[4:7], s27 offen offset:3072 sc1
    s_add_u32 s27, s27, 4096
    v_mfma_f32_16x16x32_bf16 v[236:239], v[116:119], v[116:119], v[236:239]
    s_waitcnt lgkmcnt(0)
    v_mfma_f32_16x16x32_bf16 v[176:179], a[224:227], v[112:115], v[176:179]
    ds_read_b128 a[240:243], v15 offset:53248
    v_mfma_f32_16x16x32_bf16 v[192:195], a[224:227], v[116:119], v[192:195]
    ds_read_b128 a[244:247], v15 offset:54272
    v_mfma_f32_16x16x32_bf16 v[180:183], a[228:231], v[112:115], v[180:183]
    ds_read_b128 a[248:251], v15 offset:55296
    v_mfma_f32_16x16x32_bf16 v[196:199], a[228:231], v[116:119], v[196:199]
    ds_read_b128 a[252:255], v15 offset:56320
    v_mfma_f32_16x16x32_bf16 v[184:187], a[232:235], v[112:115], v[184:187]
    buffer_load_dwordx4 a[112:115], v15, s[4:7], s27 offen offset:0 sc1
    v_mfma_f32_16x16x32_bf16 v[200:203], a[232:235], v[116:119], v[200:203]
    s_waitcnt vmcnt(19)
    v_swap_b32 v122, v124
    v_swap_b32 v123, v125
    v_mfma_f32_16x16x32_bf16 v[188:191], a[236:239], v[112:115], v[188:191]
    v_mfma_f32_16x16x32_bf16 v[204:207], a[236:239], v[116:119], v[204:207]
    v_mfma_f32_16x16x32_bf16 v[232:235], v[120:123], v[120:123], v[232:235]
    buffer_load_dwordx4 a[116:119], v15, s[4:7], s27 offen offset:1024 sc1
    v_mfma_f32_16x16x32_bf16 v[236:239], v[124:127], v[124:127], v[236:239]
    s_waitcnt lgkmcnt(0)
    v_mfma_f32_16x16x32_bf16 v[176:179], a[240:243], v[120:123], v[176:179]
    ds_read_b128 a[224:227], v15 offset:57344
    v_mfma_f32_16x16x32_bf16 v[192:195], a[240:243], v[124:127], v[192:195]
    ds_read_b128 a[228:231], v15 offset:58368
    v_mfma_f32_16x16x32_bf16 v[180:183], a[244:247], v[120:123], v[180:183]
    ds_read_b128 a[232:235], v15 offset:59392
    v_mfma_f32_16x16x32_bf16 v[196:199], a[244:247], v[124:127], v[196:199]
    ds_read_b128 a[236:239], v15 offset:60416
    v_mfma_f32_16x16x32_bf16 v[184:187], a[248:251], v[120:123], v[184:187]
    buffer_load_dwordx4 a[120:123], v15, s[4:7], s27 offen offset:2048 sc1
    v_mfma_f32_16x16x32_bf16 v[200:203], a[248:251], v[124:127], v[200:203]
    s_waitcnt vmcnt(19)
    v_swap_b32 v130, v132
    v_swap_b32 v131, v133
    v_mfma_f32_16x16x32_bf16 v[188:191], a[252:255], v[120:123], v[188:191]
    v_mfma_f32_16x16x32_bf16 v[204:207], a[252:255], v[124:127], v[204:207]
    v_mfma_f32_16x16x32_bf16 v[232:235], v[128:131], v[128:131], v[232:235]
    buffer_load_dwordx4 a[124:127], v15, s[4:7], s27 offen offset:3072 sc1
    s_add_u32 s27, s27, 4096
    v_mfma_f32_16x16x32_bf16 v[236:239], v[132:135], v[132:135], v[236:239]
    s_waitcnt lgkmcnt(0)
    v_mfma_f32_16x16x32_bf16 v[176:179], a[224:227], v[128:131], v[176:179]
    ds_read_b128 a[240:243], v15 offset:61440
    v_mfma_f32_16x16x32_bf16 v[192:195], a[224:227], v[132:135], v[192:195]
    ds_read_b128 a[244:247], v15 offset:62464
    v_mfma_f32_16x16x32_bf16 v[180:183], a[228:231], v[128:131], v[180:183]
    ds_read_b128 a[248:251], v15 offset:63488
    v_mfma_f32_16x16x32_bf16 v[196:199], a[228:231], v[132:135], v[196:199]
    ds_read_b128 a[252:255], v15 offset:64512
    v_mfma_f32_16x16x32_bf16 v[184:187], a[232:235], v[128:131], v[184:187]
    buffer_load_dwordx4 a[128:131], v15, s[4:7], s27 offen offset:0 sc1
    v_mfma_f32_16x16x32_bf16 v[200:203], a[232:235], v[132:135], v[200:203]
    s_waitcnt vmcnt(19)
    v_swap_b32 v138, v140
    v_swap_b32 v139, v141
    v_mfma_f32_16x16x32_bf16 v[188:191], a[236:239], v[128:131], v[188:191]
    v_mfma_f32_16x16x32_bf16 v[204:207], a[236:239], v[132:135], v[204:207]
    v_mfma_f32_16x16x32_bf16 v[232:235], v[136:139], v[136:139], v[232:235]
    buffer_load_dwordx4 a[132:135], v15, s[4:7], s27 offen offset:1024 sc1
    v_mfma_f32_16x16x32_bf16 v[236:239], v[140:143], v[140:143], v[236:239]
    s_waitcnt lgkmcnt(0)
    v_mfma_f32_16x16x32_bf16 v[176:179], a[240:243], v[136:139], v[176:179]
    ds_read_b128 a[224:227], v7 offset:0
    v_mfma_f32_16x16x32_bf16 v[192:195], a[240:243], v[140:143], v[192:195]
    ds_read_b128 a[228:231], v7 offset:1024
    v_mfma_f32_16x16x32_bf16 v[180:183], a[244:247], v[136:139], v[180:183]
    ds_read_b128 a[232:235], v7 offset:2048
    v_mfma_f32_16x16x32_bf16 v[196:199], a[244:247], v[140:143], v[196:199]
    ds_read_b128 a[236:239], v7 offset:3072
    v_mfma_f32_16x16x32_bf16 v[184:187], a[248:251], v[136:139], v[184:187]
    buffer_load_dwordx4 a[136:139], v15, s[4:7], s27 offen offset:2048 sc1
    v_mfma_f32_16x16x32_bf16 v[200:203], a[248:251], v[140:143], v[200:203]
    s_waitcnt vmcnt(19)
    v_swap_b32 v146, v148
    v_swap_b32 v147, v149
    v_mfma_f32_16x16x32_bf16 v[188:191], a[252:255], v[136:139], v[188:191]
    v_mfma_f32_16x16x32_bf16 v[204:207], a[252:255], v[140:143], v[204:207]
    v_mfma_f32_16x16x32_bf16 v[232:235], v[144:147], v[144:147], v[232:235]
    buffer_load_dwordx4 a[140:143], v15, s[4:7], s27 offen offset:3072 sc1
    s_add_u32 s27, s27, 4096
    v_mfma_f32_16x16x32_bf16 v[236:239], v[148:151], v[148:151], v[236:239]
    s_waitcnt lgkmcnt(0)
    v_mfma_f32_16x16x32_bf16 v[176:179], a[224:227], v[144:147], v[176:179]
    ds_read_b128 a[240:243], v7 offset:4096
    v_mfma_f32_16x16x32_bf16 v[192:195], a[224:227], v[148:151], v[192:195]
    ds_read_b128 a[244:247], v7 offset:5120
    v_mfma_f32_16x16x32_bf16 v[180:183], a[228:231], v[144:147], v[180:183]
    ds_read_b128 a[248:251], v7 offset:6144
    v_mfma_f32_16x16x32_bf16 v[196:199], a[228:231], v[148:151], v[196:199]
    ds_read_b128 a[252:255], v7 offset:7168
    v_mfma_f32_16x16x32_bf16 v[184:187], a[232:235], v[144:147], v[184:187]
    buffer_load_dwordx4 a[144:147], v15, s[4:7], s27 offen offset:0 sc1
    v_mfma_f32_16x16x32_bf16 v[200:203], a[232:235], v[148:151], v[200:203]
    s_waitcnt vmcnt(19)
    v_swap_b32 v154, v156
    v_swap_b32 v155, v157
    v_mfma_f32_16x16x32_bf16 v[188:191], a[236:239], v[144:147], v[188:191]
    v_mfma_f32_16x16x32_bf16 v[204:207], a[236:239], v[148:151], v[204:207]
    v_mfma_f32_16x16x32_bf16 v[232:235], v[152:155], v[152:155], v[232:235]
    buffer_load_dwordx4 a[148:151], v15, s[4:7], s27 offen offset:1024 sc1
    v_mfma_f32_16x16x32_bf16 v[236:239], v[156:159], v[156:159], v[236:239]
    s_waitcnt lgkmcnt(0)
    v_mfma_f32_16x16x32_bf16 v[176:179], a[240:243], v[152:155], v[176:179]
    ds_read_b128 a[224:227], v7 offset:8192
    v_mfma_f32_16x16x32_bf16 v[192:195], a[240:243], v[156:159], v[192:195]
    ds_read_b128 a[228:231], v7 offset:9216
    v_mfma_f32_16x16x32_bf16 v[180:183], a[244:247], v[152:155], v[180:183]
    ds_read_b128 a[232:235], v7 offset:10240
    v_mfma_f32_16x16x32_bf16 v[196:199], a[244:247], v[156:159], v[196:199]
    ds_read_b128 a[236:239], v7 offset:11264
    v_mfma_f32_16x16x32_bf16 v[184:187], a[248:251], v[152:155], v[184:187]
    buffer_load_dwordx4 a[152:155], v15, s[4:7], s27 offen offset:2048 sc1
    v_mfma_f32_16x16x32_bf16 v[200:203], a[248:251], v[156:159], v[200:203]
    s_waitcnt vmcnt(19)
    v_swap_b32 v162, v164
    v_swap_b32 v163, v165
    v_mfma_f32_16x16x32_bf16 v[188:191], a[252:255], v[152:155], v[188:191]
    v_mfma_f32_16x16x32_bf16 v[204:207], a[252:255], v[156:159], v[204:207]
    v_mfma_f32_16x16x32_bf16 v[232:235], v[160:163], v[160:163], v[232:235]
    buffer_load_dwordx4 a[156:159], v15, s[4:7], s27 offen offset:3072 sc1
    s_add_u32 s27, s27, 4096
    v_mfma_f32_16x16x32_bf16 v[236:239], v[164:167], v[164:167], v[236:239]
    s_waitcnt lgkmcnt(0)
    v_mfma_f32_16x16x32_bf16 v[176:179], a[224:227], v[160:163], v[176:179]
    ds_read_b128 a[240:243], v7 offset:12288
    v_mfma_f32_16x16x32_bf16 v[192:195], a[224:227], v[164:167], v[192:195]
    ds_read_b128 a[244:247], v7 offset:13312
    v_mfma_f32_16x16x32_bf16 v[180:183], a[228:231], v[160:163], v[180:183]
    ds_read_b128 a[248:251], v7 offset:14336
    v_mfma_f32_16x16x32_bf16 v[196:199], a[228:231], v[164:167], v[196:199]
    ds_read_b128 a[252:255], v7 offset:15360
    v_mfma_f32_16x16x32_bf16 v[184:187], a[232:235], v[160:163], v[184:187]
    buffer_load_dwordx4 a[160:163], v15, s[4:7], s27 offen offset:0 sc1
    v_mfma_f32_16x16x32_bf16 v[200:203], a[232:235], v[164:167], v[200:203]
    s_waitcnt vmcnt(19)
    v_swap_b32 v170, v172
    v_swap_b32 v171, v173
    v_mfma_f32_16x16x32_bf16 v[188:191], a[236:239], v[160:163], v[188:191]
    v_mfma_f32_16x16x32_bf16 v[204:207], a[236:239], v[164:167], v[204:207]
    v_mfma_f32_16x16x32_bf16 v[232:235], v[168:171], v[168:171], v[232:235]
    buffer_load_dwordx4 a[164:167], v15, s[4:7], s27 offen offset:1024 sc1
    v_mfma_f32_16x16x32_bf16 v[236:239], v[172:175], v[172:175], v[236:239]
    s_waitcnt lgkmcnt(0)
    v_mfma_f32_16x16x32_bf16 v[176:179], a[240:243], v[168:171], v[176:179]
    ds_read_b128 a[224:227], v7 offset:16384
    v_mfma_f32_16x16x32_bf16 v[192:195], a[240:243], v[172:175], v[192:195]
    ds_read_b128 a[228:231], v7 offset:17408
    v_mfma_f32_16x16x32_bf16 v[180:183], a[244:247], v[168:171], v[180:183]
    ds_read_b128 a[232:235], v7 offset:18432
    v_mfma_f32_16x16x32_bf16 v[196:199], a[244:247], v[172:175], v[196:199]
    ds_read_b128 v[244:247], v10 offset:384
    v_mfma_f32_16x16x32_bf16 v[184:187], a[248:251], v[168:171], v[184:187]
    ds_read_b128 v[248:251], v10 offset:0
    v_mfma_f32_16x16x32_bf16 v[200:203], a[248:251], v[172:175], v[200:203]
    v_mfma_f32_16x16x32_bf16 v[188:191], a[252:255], v[168:171], v[188:191]
    v_mfma_f32_16x16x32_bf16 v[204:207], a[252:255], v[172:175], v[204:207]
    s_waitcnt lgkmcnt(4)
    v_mfma_f32_16x16x32_bf16 v[208:211], a[224:227], v[16:19], 0
    ds_read_b128 a[236:239], v7 offset:19456
    v_cmp_eq_u32 vcc, 3, v4
    s_nop 1
    v_cndmask_b32 v240, 0, v176, vcc
    v_cndmask_b32 v241, 0, v192, vcc
    v_mov_b32 v242, v240
    v_mov_b32 v243, v241
    v_mfma_f32_16x16x32_bf16 v[220:223], a[224:227], v[20:23], 0
    v_permlane16_swap_b32 v240, v242
    v_permlane16_swap_b32 v241, v243
    v_add_f32 v240, v240, v242
    v_add_f32 v241, v241, v243
    v_mov_b32 v242, v240
    v_mov_b32 v243, v241
    s_waitcnt lgkmcnt(4)
    v_mfma_f32_16x16x32_bf16 v[212:215], a[228:231], v[16:19], 0
    ds_read_b128 a[240:243], v7 offset:20480
    v_permlane32_swap_b32 v240, v242
    v_permlane32_swap_b32 v241, v243
    v_add_f32 v240, v240, v242
    v_add_f32 v241, v241, v243
    v_mul_f32 v242, 0x3acccccd, v240
    v_mfma_f32_16x16x32_bf16 v[224:227], a[228:231], v[20:23], 0
    ds_read_b128 a[244:247], v7 offset:21504
    v_mul_f32 v243, 0x3acccccd, v241
    v_cvt_pk_bf16_f32 v242, v242, v242
    v_cvt_pk_bf16_f32 v243, v243, v243
    v_lshlrev_b32 v242, 16, v242
    v_lshlrev_b32 v243, 16, v243
    s_waitcnt lgkmcnt(5)
    v_mfma_f32_16x16x32_bf16 v[216:219], a[232:235], v[16:19], 0
    ds_read_b128 a[248:251], v7 offset:22528
    s_waitcnt lgkmcnt(4)
    v_fma_f32 v176, -v242, v244, v176
    v_fma_f32 v177, -v242, v245, v177
    v_fma_f32 v178, -v242, v246, v178
    v_fma_f32 v179, -v242, v247, v179
    v_fma_f32 v180, -v242, v248, v180
    v_mfma_f32_16x16x32_bf16 v[228:231], a[232:235], v[20:23], 0
    v_fma_f32 v181, -v242, v249, v181
    v_fma_f32 v182, -v242, v250, v182
    v_fma_f32 v183, -v242, v251, v183
    v_fma_f32 v192, -v243, v244, v192
    v_fma_f32 v193, -v243, v245, v193
    v_fma_f32 v194, -v243, v246, v194
    s_waitcnt lgkmcnt(3)
    v_mfma_f32_16x16x32_bf16 v[208:211], a[236:239], v[24:27], v[208:211]
    ds_read_b128 a[252:255], v7 offset:23552
    v_fma_f32 v195, -v243, v247, v195
    v_fma_f32 v196, -v243, v248, v196
    v_fma_f32 v197, -v243, v249, v197
    v_fma_f32 v198, -v243, v250, v198
    v_fma_f32 v199, -v243, v251, v199
    v_mfma_f32_16x16x32_bf16 v[220:223], a[236:239], v[28:31], v[220:223]
    ds_read_b128 v[244:247], v10 offset:64
    ds_read_b128 v[248:251], v10 offset:128
    v_cvt_pk_bf16_f32 v176, v176, v177
    v_cvt_pk_bf16_f32 v177, v178, v179
    v_pk_max_i16 v176, v176, 0
    v_pk_max_i16 v177, v177, 0
    s_waitcnt lgkmcnt(5)
    v_mfma_f32_16x16x32_bf16 v[212:215], a[240:243], v[24:27], v[212:215]
    ds_read_b128 a[224:227], v7 offset:24576
    v_cvt_pk_bf16_f32 v178, v180, v181
    v_cvt_pk_bf16_f32 v179, v182, v183
    v_pk_max_i16 v178, v178, 0
    v_pk_max_i16 v179, v179, 0
    buffer_store_dwordx4 v[176:179], v15, s[4:7], s34 offen offset:0 sc1
    v_mfma_f32_16x16x32_bf16 v[224:227], a[240:243], v[28:31], v[224:227]
    v_cvt_pk_bf16_f32 v192, v192, v193
    v_cvt_pk_bf16_f32 v193, v194, v195
    v_pk_max_i16 v192, v192, 0
    v_pk_max_i16 v193, v193, 0
    v_cvt_pk_bf16_f32 v194, v196, v197
    v_cvt_pk_bf16_f32 v195, v198, v199
    s_waitcnt lgkmcnt(5)
    v_mfma_f32_16x16x32_bf16 v[216:219], a[244:247], v[24:27], v[216:219]
    ds_read_b128 a[228:231], v7 offset:25600
    v_pk_max_i16 v194, v194, 0
    v_pk_max_i16 v195, v195, 0
    buffer_store_dwordx4 v[192:195], v15, s[4:7], s34 offen offset:1024 sc1
    s_waitcnt lgkmcnt(2)
    v_fma_f32 v184, -v242, v244, v184
    v_fma_f32 v185, -v242, v245, v185
    v_mfma_f32_16x16x32_bf16 v[228:231], a[244:247], v[28:31], v[228:231]
    v_fma_f32 v186, -v242, v246, v186
    v_fma_f32 v187, -v242, v247, v187
    v_fma_f32 v188, -v242, v248, v188
    v_fma_f32 v189, -v242, v249, v189
    v_fma_f32 v190, -v242, v250, v190
    v_fma_f32 v191, -v242, v251, v191
    s_waitcnt lgkmcnt(5)
    v_mfma_f32_16x16x32_bf16 v[208:211], a[248:251], v[32:35], v[208:211]
    ds_read_b128 a[232:235], v7 offset:26624
    v_fma_f32 v200, -v243, v244, v200
    v_fma_f32 v201, -v243, v245, v201
    v_fma_f32 v202, -v243, v246, v202
    v_fma_f32 v203, -v243, v247, v203
    v_fma_f32 v204, -v243, v248, v204
    v_mfma_f32_16x16x32_bf16 v[220:223], a[248:251], v[36:39], v[220:223]
    v_fma_f32 v205, -v243, v249, v205
    v_fma_f32 v206, -v243, v250, v206
    v_fma_f32 v207, -v243, v251, v207
    ds_read_b128 v[244:247], v10 offset:192
    ds_read_b128 v[248:251], v10 offset:256
    v_cvt_pk_bf16_f32 v184, v184, v185
    s_waitcnt lgkmcnt(7)
    v_mfma_f32_16x16x32_bf16 v[212:215], a[252:255], v[32:35], v[212:215]
    ds_read_b128 a[236:239], v7 offset:27648
    v_cvt_pk_bf16_f32 v185, v186, v187
    v_pk_max_i16 v184, v184, 0
    v_pk_max_i16 v185, v185, 0
    v_cvt_pk_bf16_f32 v186, v188, v189
    v_cvt_pk_bf16_f32 v187, v190, v191
    v_mfma_f32_16x16x32_bf16 v[224:227], a[252:255], v[36:39], v[224:227]
    v_pk_max_i16 v186, v186, 0
    v_pk_max_i16 v187, v187, 0
    buffer_store_dwordx4 v[184:187], v15, s[4:7], s38 offen offset:0 sc1
    v_cvt_pk_bf16_f32 v200, v200, v201
    v_cvt_pk_bf16_f32 v201, v202, v203
    v_pk_max_i16 v200, v200, 0
    s_waitcnt lgkmcnt(5)
    v_mfma_f32_16x16x32_bf16 v[216:219], a[224:227], v[32:35], v[216:219]
    ds_read_b128 a[240:243], v7 offset:28672
    v_pk_max_i16 v201, v201, 0
    v_cvt_pk_bf16_f32 v202, v204, v205
    v_cvt_pk_bf16_f32 v203, v206, v207
    v_pk_max_i16 v202, v202, 0
    v_pk_max_i16 v203, v203, 0
    v_mfma_f32_16x16x32_bf16 v[228:231], a[224:227], v[36:39], v[228:231]
    buffer_store_dwordx4 v[200:203], v15, s[4:7], s38 offen offset:1024 sc1
    ds_read_b128 v[180:183], v10 offset:320
    s_waitcnt lgkmcnt(6)
    v_mfma_f32_16x16x32_bf16 v[208:211], a[228:231], v[40:43], v[208:211]
    ds_read_b128 a[244:247], v7 offset:29696
    v_mfma_f32_16x16x32_bf16 v[220:223], a[228:231], v[44:47], v[220:223]
    buffer_load_dwordx4 a[168:171], v15, s[4:7], s27 offen offset:2048 sc1
    s_waitcnt lgkmcnt(6)
    v_mfma_f32_16x16x32_bf16 v[212:215], a[232:235], v[40:43], v[212:215]
    ds_read_b128 a[248:251], v7 offset:30720
    v_mfma_f32_16x16x32_bf16 v[224:227], a[232:235], v[44:47], v[224:227]
    s_waitcnt lgkmcnt(4)
    v_mfma_f32_16x16x32_bf16 v[216:219], a[236:239], v[40:43], v[216:219]
    ds_read_b128 a[252:255], v7 offset:31744
    buffer_load_dwordx4 a[172:175], v15, s[4:7], s27 offen offset:3072 sc1
    s_add_u32 s27, s27, 4096
    v_mfma_f32_16x16x32_bf16 v[228:231], a[236:239], v[44:47], v[228:231]
    s_waitcnt lgkmcnt(4)
    v_mfma_f32_16x16x32_bf16 v[208:211], a[240:243], v[48:51], v[208:211]
    ds_read_b128 a[224:227], v7 offset:32768
    v_mfma_f32_16x16x32_bf16 v[220:223], a[240:243], v[52:55], v[220:223]
    buffer_load_dwordx4 a[176:179], v15, s[4:7], s27 offen offset:0 sc1
    s_waitcnt lgkmcnt(3)
    v_mfma_f32_16x16x32_bf16 v[212:215], a[244:247], v[48:51], v[212:215]
    ds_read_b128 a[228:231], v7 offset:33792
    v_mfma_f32_16x16x32_bf16 v[224:227], a[244:247], v[52:55], v[224:227]
    s_waitcnt lgkmcnt(3)
    v_mfma_f32_16x16x32_bf16 v[216:219], a[248:251], v[48:51], v[216:219]
    ds_read_b128 a[232:235], v7 offset:34816
    v_mfma_f32_16x16x32_bf16 v[228:231], a[248:251], v[52:55], v[228:231]
    s_waitcnt lgkmcnt(3)
    v_mfma_f32_16x16x32_bf16 v[208:211], a[252:255], v[56:59], v[208:211]
    ds_read_b128 a[236:239], v7 offset:35840
    v_mfma_f32_16x16x32_bf16 v[220:223], a[252:255], v[60:63], v[220:223]
    buffer_load_dwordx4 a[180:183], v15, s[4:7], s27 offen offset:1024 sc1
    s_waitcnt lgkmcnt(3)
    v_mfma_f32_16x16x32_bf16 v[212:215], a[224:227], v[56:59], v[212:215]
    ds_read_b128 a[240:243], v7 offset:36864
    v_mfma_f32_16x16x32_bf16 v[224:227], a[224:227], v[60:63], v[224:227]
    s_waitcnt lgkmcnt(3)
    v_mfma_f32_16x16x32_bf16 v[216:219], a[228:231], v[56:59], v[216:219]
    ds_read_b128 a[244:247], v7 offset:37888
    buffer_load_dwordx4 a[184:187], v15, s[4:7], s27 offen offset:2048 sc1
    v_mfma_f32_16x16x32_bf16 v[228:231], a[228:231], v[60:63], v[228:231]
    s_waitcnt lgkmcnt(3)
    v_mfma_f32_16x16x32_bf16 v[208:211], a[232:235], v[64:67], v[208:211]
    ds_read_b128 a[248:251], v7 offset:38912
    v_mfma_f32_16x16x32_bf16 v[220:223], a[232:235], v[68:71], v[220:223]
    buffer_load_dwordx4 a[188:191], v15, s[4:7], s27 offen offset:3072 sc1
    s_add_u32 s27, s27, 4096
    s_waitcnt lgkmcnt(3)
    v_mfma_f32_16x16x32_bf16 v[212:215], a[236:239], v[64:67], v[212:215]
    ds_read_b128 a[252:255], v7 offset:39936
    v_mfma_f32_16x16x32_bf16 v[224:227], a[236:239], v[68:71], v[224:227]
    s_waitcnt lgkmcnt(3)
    v_mfma_f32_16x16x32_bf16 v[216:219], a[240:243], v[64:67], v[216:219]
    ds_read_b128 a[224:227], v7 offset:40960
    v_mfma_f32_16x16x32_bf16 v[228:231], a[240:243], v[68:71], v[228:231]
    s_waitcnt lgkmcnt(3)
    v_mfma_f32_16x16x32_bf16 v[208:211], a[244:247], v[72:75], v[208:211]
    ds_read_b128 a[228:231], v7 offset:41984
    s_barrier
    v_mfma_f32_16x16x32_bf16 v[220:223], a[244:247], v[76:79], v[220:223]
    buffer_load_dwordx4 a[192:195], v15, s[4:7], s27 offen offset:0 sc1
    s_waitcnt lgkmcnt(3)
    v_mfma_f32_16x16x32_bf16 v[212:215], a[248:251], v[72:75], v[212:215]
    ds_read_b128 a[232:235], v7 offset:43008
    v_mfma_f32_16x16x32_bf16 v[224:227], a[248:251], v[76:79], v[224:227]
    s_waitcnt lgkmcnt(3)
    v_mfma_f32_16x16x32_bf16 v[216:219], a[252:255], v[72:75], v[216:219]
    ds_read_b128 a[236:239], v7 offset:44032
    buffer_load_dwordx4 a[196:199], v15, s[4:7], s27 offen offset:1024 sc1
    v_mfma_f32_16x16x32_bf16 v[228:231], a[252:255], v[76:79], v[228:231]
    s_waitcnt lgkmcnt(3)
    v_mfma_f32_16x16x32_bf16 v[208:211], a[224:227], v[80:83], v[208:211]
    ds_read_b128 a[240:243], v7 offset:45056
    v_mfma_f32_16x16x32_bf16 v[220:223], a[224:227], v[84:87], v[220:223]
    buffer_load_dwordx4 a[200:203], v15, s[4:7], s27 offen offset:2048 sc1
    s_waitcnt lgkmcnt(3)
    v_mfma_f32_16x16x32_bf16 v[212:215], a[228:231], v[80:83], v[212:215]
    ds_read_b128 a[244:247], v7 offset:46080
    v_mfma_f32_16x16x32_bf16 v[224:227], a[228:231], v[84:87], v[224:227]
    s_waitcnt lgkmcnt(3)
    v_mfma_f32_16x16x32_bf16 v[216:219], a[232:235], v[80:83], v[216:219]
    ds_read_b128 a[248:251], v7 offset:47104
    s_waitcnt lgkmcnt(15)
    v_fma_f32 v208, -v242, v244, v208
    v_fma_f32 v209, -v242, v245, v209
    v_fma_f32 v210, -v242, v246, v210
    v_fma_f32 v211, -v242, v247, v211
    v_mfma_f32_16x16x32_bf16 v[228:231], a[232:235], v[84:87], v[228:231]
    s_waitcnt lgkmcnt(3)
    v_mfma_f32_16x16x32_bf16 v[208:211], a[236:239], v[88:91], v[208:211]
    ds_read_b128 a[252:255], v7 offset:48128
    v_mfma_f32_16x16x32_bf16 v[220:223], a[236:239], v[92:95], v[220:223]
    buffer_load_dwordx4 a[204:207], v15, s[4:7], s27 offen offset:3072 sc1
    s_add_u32 s27, s27, 4096
    s_waitcnt lgkmcnt(3)
    v_mfma_f32_16x16x32_bf16 v[212:215], a[240:243], v[88:91], v[212:215]
    ds_read_b128 a[224:227], v7 offset:49152
    v_mfma_f32_16x16x32_bf16 v[224:227], a[240:243], v[92:95], v[224:227]
    s_waitcnt lgkmcnt(3)
    v_mfma_f32_16x16x32_bf16 v[216:219], a[244:247], v[88:91], v[216:219]
    ds_read_b128 a[228:231], v7 offset:50176
    buffer_load_dwordx4 a[208:211], v15, s[4:7], s27 offen offset:0 sc1
    v_mfma_f32_16x16x32_bf16 v[228:231], a[244:247], v[92:95], v[228:231]
    v_fma_f32 v220, -v243, v244, v220
    v_fma_f32 v221, -v243, v245, v221
    v_fma_f32 v222, -v243, v246, v222
    v_fma_f32 v223, -v243, v247, v223
    s_waitcnt lgkmcnt(3)
    v_mfma_f32_16x16x32_bf16 v[208:211], a[248:251], v[96:99], v[208:211]
    ds_read_b128 a[232:235], v7 offset:51200
    v_fma_f32 v212, -v242, v248, v212
    v_fma_f32 v213, -v242, v249, v213
    v_fma_f32 v214, -v242, v250, v214
    v_fma_f32 v215, -v242, v251, v215
    v_mfma_f32_16x16x32_bf16 v[220:223], a[248:251], v[100:103], v[220:223]
    buffer_load_dwordx4 a[212:215], v15, s[4:7], s27 offen offset:1024 sc1
    s_waitcnt lgkmcnt(3)
    v_mfma_f32_16x16x32_bf16 v[212:215], a[252:255], v[96:99], v[212:215]
    ds_read_b128 a[236:239], v7 offset:52224
    v_mul_u32_u24 v5, 16768, v4
    v_mfma_f32_16x16x32_bf16 v[224:227], a[252:255], v[100:103], v[224:227]
    v_lshl_add_u32 v5, v3, 4, v5
    s_waitcnt lgkmcnt(3)
    v_mfma_f32_16x16x32_bf16 v[216:219], a[224:227], v[96:99], v[216:219]
    ds_read_b128 a[240:243], v7 offset:53248
    s_add_u32 s18, s3, 0
    v_mfma_f32_16x16x32_bf16 v[228:231], a[224:227], v[100:103], v[228:231]
    s_and_b32 s18, s18, 3
    s_waitcnt lgkmcnt(3)
    v_mfma_f32_16x16x32_bf16 v[208:211], a[228:231], v[104:107], v[208:211]
    ds_read_b128 a[244:247], v7 offset:54272
    s_waitcnt vmcnt(12)
    s_mov_b64 exec, 0xffff
    buffer_store_dwordx2 v[252:253], v254, s[4:7], s36 offen offset:0 sc1
    s_mov_b64 exec, -1
    v_mfma_f32_16x16x32_bf16 v[220:223], a[228:231], v[108:111], v[220:223]
    v_fma_f32 v224, -v243, v248, v224
    v_fma_f32 v225, -v243, v249, v225
    v_fma_f32 v226, -v243, v250, v226
    v_fma_f32 v227, -v243, v251, v227
    s_waitcnt lgkmcnt(3)
    v_mfma_f32_16x16x32_bf16 v[212:215], a[232:235], v[104:107], v[212:215]
    ds_read_b128 a[248:251], v7 offset:55296
    s_lshl_b32 s19, s18, 10
    v_mfma_f32_16x16x32_bf16 v[224:227], a[232:235], v[108:111], v[224:227]
    v_add_u32 v90, s19, v15
    s_waitcnt lgkmcnt(3)
    v_mfma_f32_16x16x32_bf16 v[216:219], a[236:239], v[104:107], v[216:219]
    ds_read_b128 a[252:255], v7 offset:56320
    buffer_load_dwordx4 a[216:219], v15, s[4:7], s27 offen offset:2048 sc1
    v_mfma_f32_16x16x32_bf16 v[228:231], a[236:239], v[108:111], v[228:231]
    s_add_u32 s18, s3, 1
    s_waitcnt lgkmcnt(3)
    v_mfma_f32_16x16x32_bf16 v[208:211], a[240:243], v[112:115], v[208:211]
    ds_read_b128 a[224:227], v7 offset:57344
    s_and_b32 s18, s18, 3
    v_mfma_f32_16x16x32_bf16 v[220:223], a[240:243], v[116:119], v[220:223]
    buffer_load_dwordx4 a[220:223], v15, s[4:7], s27 offen offset:3072 sc1
    s_add_u32 s27, s27, 4096
    s_waitcnt lgkmcnt(3)
    v_mfma_f32_16x16x32_bf16 v[212:215], a[244:247], v[112:115], v[212:215]
    ds_read_b128 a[228:231], v7 offset:58368
    v_fma_f32 v216, -v242, v180, v216
    v_fma_f32 v217, -v242, v181, v217
    v_fma_f32 v218, -v242, v182, v218
    v_fma_f32 v219, -v242, v183, v219
    v_mfma_f32_16x16x32_bf16 v[224:227], a[244:247], v[116:119], v[224:227]
    s_lshl_b32 s19, s18, 10
    s_waitcnt lgkmcnt(3)
    v_mfma_f32_16x16x32_bf16 v[216:219], a[248:251], v[112:115], v[216:219]
    ds_read_b128 a[232:235], v7 offset:59392
    v_add_u32 v91, s19, v15
    v_mfma_f32_16x16x32_bf16 v[228:231], a[248:251], v[116:119], v[228:231]
    s_add_u32 s18, s3, 2
    s_waitcnt lgkmcnt(3)
    v_mfma_f32_16x16x32_bf16 v[208:211], a[252:255], v[120:123], v[208:211]
    ds_read_b128 a[236:239], v7 offset:60416
    s_and_b32 s18, s18, 3
    v_mfma_f32_16x16x32_bf16 v[220:223], a[252:255], v[124:127], v[220:223]
    buffer_load_dwordx4 v[16:19], v15, s[4:7], s27 offen offset:0 sc1
    s_waitcnt lgkmcnt(3)
    v_mfma_f32_16x16x32_bf16 v[212:215], a[224:227], v[120:123], v[212:215]
    ds_read_b128 a[240:243], v7 offset:61440
    s_lshl_b32 s19, s18, 10
    v_mfma_f32_16x16x32_bf16 v[224:227], a[224:227], v[124:127], v[224:227]
    v_fma_f32 v228, -v243, v180, v228
    v_fma_f32 v229, -v243, v181, v229
    v_fma_f32 v230, -v243, v182, v230
    v_fma_f32 v231, -v243, v183, v231
    s_waitcnt lgkmcnt(3)
    v_mfma_f32_16x16x32_bf16 v[216:219], a[228:231], v[120:123], v[216:219]
    ds_read_b128 a[244:247], v7 offset:62464
    buffer_load_dwordx4 v[20:23], v15, s[4:7], s27 offen offset:1024 sc1
    v_mfma_f32_16x16x32_bf16 v[228:231], a[228:231], v[124:127], v[228:231]
    v_add_u32 v92, s19, v15
    s_waitcnt lgkmcnt(3)
    v_mfma_f32_16x16x32_bf16 v[208:211], a[232:235], v[128:131], v[208:211]
    ds_read_b128 a[248:251], v7 offset:63488
    s_add_u32 s18, s3, 3
    v_mfma_f32_16x16x32_bf16 v[220:223], a[232:235], v[132:135], v[220:223]
    buffer_load_dwordx4 v[24:27], v15, s[4:7], s27 offen offset:2048 sc1
    s_waitcnt lgkmcnt(3)
    v_mfma_f32_16x16x32_bf16 v[212:215], a[236:239], v[128:131], v[212:215]
    ds_read_b128 a[252:255], v7 offset:64512
    s_and_b32 s18, s18, 3
    v_mfma_f32_16x16x32_bf16 v[224:227], a[236:239], v[132:135], v[224:227]
    s_lshl_b32 s19, s18, 10
    s_waitcnt lgkmcnt(3)
    v_mfma_f32_16x16x32_bf16 v[216:219], a[240:243], v[128:131], v[216:219]
    ds_read_b128 a[224:227], v8 offset:0
    v_add_u32 v93, s19, v15
    v_mfma_f32_16x16x32_bf16 v[228:231], a[240:243], v[132:135], v[228:231]
    s_waitcnt lgkmcnt(3)
    v_mfma_f32_16x16x32_bf16 v[208:211], a[244:247], v[136:139], v[208:211]
    ds_read_b128 a[228:231], v8 offset:1024
    v_mfma_f32_16x16x32_bf16 v[220:223], a[244:247], v[140:143], v[220:223]
    buffer_load_dwordx4 v[28:31], v15, s[4:7], s27 offen offset:3072 sc1
    s_add_u32 s27, s27, 4096
    s_waitcnt lgkmcnt(3)
    v_mfma_f32_16x16x32_bf16 v[212:215], a[248:251], v[136:139], v[212:215]
    ds_read_b128 a[232:235], v8 offset:2048
    v_mfma_f32_16x16x32_bf16 v[224:227], a[248:251], v[140:143], v[224:227]
    s_waitcnt lgkmcnt(3)
    v_mfma_f32_16x16x32_bf16 v[216:219], a[252:255], v[136:139], v[216:219]
    ds_read_b128 a[236:239], v8 offset:3072
    buffer_load_dwordx4 v[32:35], v15, s[4:7], s27 offen offset:0 sc1
    v_mfma_f32_16x16x32_bf16 v[228:231], a[252:255], v[140:143], v[228:231]
    s_waitcnt lgkmcnt(3)
    v_mfma_f32_16x16x32_bf16 v[208:211], a[224:227], v[144:147], v[208:211]
    ds_read_b128 a[240:243], v8 offset:4096
    v_mfma_f32_16x16x32_bf16 v[220:223], a[224:227], v[148:151], v[220:223]
    buffer_load_dwordx4 v[36:39], v15, s[4:7], s27 offen offset:1024 sc1
    s_waitcnt lgkmcnt(3)
    v_mfma_f32_16x16x32_bf16 v[212:215], a[228:231], v[144:147], v[212:215]
    ds_read_b128 a[244:247], v8 offset:5120
    v_mfma_f32_16x16x32_bf16 v[224:227], a[228:231], v[148:151], v[224:227]
    s_waitcnt lgkmcnt(3)
    v_mfma_f32_16x16x32_bf16 v[216:219], a[232:235], v[144:147], v[216:219]
    ds_read_b128 a[248:251], v8 offset:6144
    v_mfma_f32_16x16x32_bf16 v[228:231], a[232:235], v[148:151], v[228:231]
    s_waitcnt lgkmcnt(3)
    v_mfma_f32_16x16x32_bf16 v[208:211], a[236:239], v[152:155], v[208:211]
    ds_read_b128 a[252:255], v8 offset:7168
    v_mfma_f32_16x16x32_bf16 v[220:223], a[236:239], v[156:159], v[220:223]
    buffer_load_dwordx4 v[40:43], v15, s[4:7], s27 offen offset:2048 sc1
    s_waitcnt lgkmcnt(3)
    v_mfma_f32_16x16x32_bf16 v[212:215], a[240:243], v[152:155], v[212:215]
    ds_read_b128 a[224:227], v8 offset:8192
    v_mfma_f32_16x16x32_bf16 v[224:227], a[240:243], v[156:159], v[224:227]
    s_waitcnt lgkmcnt(3)
    v_mfma_f32_16x16x32_bf16 v[216:219], a[244:247], v[152:155], v[216:219]
    ds_read_b128 a[228:231], v8 offset:9216
    buffer_load_dwordx4 v[44:47], v15, s[4:7], s27 offen offset:3072 sc1
    s_add_u32 s27, s27, 4096
    v_mfma_f32_16x16x32_bf16 v[228:231], a[244:247], v[156:159], v[228:231]
    s_waitcnt lgkmcnt(3)
    v_mfma_f32_16x16x32_bf16 v[208:211], a[248:251], v[160:163], v[208:211]
    ds_read_b128 a[232:235], v8 offset:10240
    buffer_load_dwordx2 v[86:87], v11, s[4:7], s39 offen sc1
    v_mfma_f32_16x16x32_bf16 v[220:223], a[248:251], v[164:167], v[220:223]
    s_waitcnt lgkmcnt(3)
    v_mfma_f32_16x16x32_bf16 v[212:215], a[252:255], v[160:163], v[212:215]
    ds_read_b128 a[236:239], v8 offset:11264
    v_mfma_f32_16x16x32_bf16 v[224:227], a[252:255], v[164:167], v[224:227]
    s_waitcnt lgkmcnt(3)
    v_mfma_f32_16x16x32_bf16 v[216:219], a[224:227], v[160:163], v[216:219]
    v_mfma_f32_16x16x32_bf16 v[228:231], a[224:227], v[164:167], v[228:231]
    s_waitcnt lgkmcnt(2)
    v_mfma_f32_16x16x32_bf16 v[208:211], a[228:231], v[168:171], v[208:211]
    v_mfma_f32_16x16x32_bf16 v[220:223], a[228:231], v[172:175], v[220:223]
    s_waitcnt lgkmcnt(1)
    v_mfma_f32_16x16x32_bf16 v[212:215], a[232:235], v[168:171], v[212:215]
    v_mfma_f32_16x16x32_bf16 v[224:227], a[232:235], v[172:175], v[224:227]
    s_waitcnt lgkmcnt(0)
    v_mfma_f32_16x16x32_bf16 v[216:219], a[236:239], v[168:171], v[216:219]
    v_mfma_f32_16x16x32_bf16 v[228:231], a[236:239], v[172:175], v[228:231]
    s_nop 0
    v_cvt_pk_bf16_f32 v208, v208, v209
    v_cvt_pk_bf16_f32 v209, v210, v211
    v_pk_max_i16 v208, v208, 0
    v_pk_max_i16 v209, v209, 0
    v_cvt_pk_bf16_f32 v210, v212, v213
    v_cvt_pk_bf16_f32 v211, v214, v215
    v_pk_max_i16 v210, v210, 0
    v_pk_max_i16 v211, v211, 0
    v_cvt_pk_bf16_f32 v216, v216, v217
    v_cvt_pk_bf16_f32 v217, v218, v219
    v_pk_max_i16 v216, v216, 0
    v_pk_max_i16 v217, v217, 0
    buffer_store_dwordx4 v[208:211], v15, s[4:7], s35 offen offset:0 sc1
    buffer_store_dwordx2 v[216:217], v254, s[4:7], s37 offen offset:0 sc1
    v_cvt_pk_bf16_f32 v220, v220, v221
    v_cvt_pk_bf16_f32 v221, v222, v223
    v_pk_max_i16 v220, v220, 0
    v_pk_max_i16 v221, v221, 0
    v_cvt_pk_bf16_f32 v222, v224, v225
    v_cvt_pk_bf16_f32 v223, v226, v227
    v_pk_max_i16 v222, v222, 0
    v_pk_max_i16 v223, v223, 0
    v_cvt_pk_bf16_f32 v228, v228, v229
    v_cvt_pk_bf16_f32 v229, v230, v231
    v_pk_max_i16 v228, v228, 0
    v_pk_max_i16 v229, v229, 0
    buffer_store_dwordx4 v[220:223], v15, s[4:7], s35 offen offset:1024 sc1
    buffer_store_dwordx2 v[228:229], v254, s[4:7], s37 offen offset:1024 sc1
    s_waitcnt vmcnt(4)
    v_cmp_eq_u64 vcc, s[48:49], v[86:87]
    s_cmp_eq_u64 vcc, exec
    s_cbranch_scc1 L_sp3ac_out
    s_waitcnt vmcnt(0)
    s_mov_b64 exec, 0xffff
    buffer_store_dwordx2 v[252:253], v254, s[4:7], s36 offen offset:128 sc1
    s_mov_b64 exec, -1
    s_mov_b32 s58, 0
L_sp3ac:
    buffer_load_dwordx2 v[86:87], v11, s[4:7], s39 offen sc1
    s_add_u32 s58, s58, 1
    s_waitcnt vmcnt(0)
    v_cmp_eq_u64 vcc, s[48:49], v[86:87]
    s_cmp_eq_u64 vcc, exec
    s_cbranch_scc1 L_sp3ac_out
    s_sleep 1
    s_cmp_le_u32 s58, 200000
    s_cbranch_scc1 L_sp3ac
L_sp3ac_out:
    buffer_load_dwordx4 v[176:179], v91, s[4:7], s40 offen sc1
    buffer_load_dwordx4 v[180:183], v92, s[4:7], s40 offen sc1
    buffer_load_dwordx4 v[184:187], v93, s[4:7], s40 offen sc1
    buffer_load_dwordx4 v[188:191], v90, s[4:7], s40 offen sc1
    s_add_u32 s40, s45, 4096
    buffer_load_dwordx4 v[192:195], v91, s[4:7], s40 offen sc1
    buffer_load_dwordx4 v[196:199], v92, s[4:7], s40 offen sc1
    buffer_load_dwordx4 v[200:203], v93, s[4:7], s40 offen sc1
    buffer_load_dwordx4 v[204:207], v90, s[4:7], s40 offen sc1
    s_add_u32 s40, s45, 8192
    buffer_load_dwordx4 v[208:211], v91, s[4:7], s40 offen sc1
    buffer_load_dwordx4 v[212:215], v92, s[4:7], s40 offen sc1
    buffer_load_dwordx4 v[216:219], v93, s[4:7], s40 offen sc1
    buffer_load_dwordx4 v[220:223], v90, s[4:7], s40 offen sc1
    buffer_load_dwordx4 v[48:51], v15, s[4:7], s27 offen offset:0 sc1
    buffer_load_dwordx4 v[52:55], v15, s[4:7], s27 offen offset:1024 sc1
    buffer_load_dwordx4 v[56:59], v15, s[4:7], s27 offen offset:2048 sc1
    buffer_load_dwordx4 v[60:63], v15, s[4:7], s27 offen offset:3072 sc1
    s_add_u32 s27, s27, 4096
    buffer_load_dwordx4 v[64:67], v15, s[4:7], s27 offen offset:0 sc1
    buffer_load_dwordx4 v[68:71], v15, s[4:7], s27 offen offset:1024 sc1
    buffer_load_dwordx2 v[76:77], v5, s[4:7], s42 offen sc1
    s_add_u32 s42, s42, 67072
    buffer_load_dwordx2 v[78:79], v5, s[4:7], s42 offen sc1
    s_add_u32 s42, s42, 67072
    buffer_load_dwordx2 v[80:81], v5, s[4:7], s42 offen sc1
    s_add_u32 s42, s42, 67072
    buffer_load_dwordx2 v[82:83], v5, s[4:7], s42 offen sc1
    s_add_u32 s42, s42, 67072
    buffer_load_dwordx2 v[84:85], v5, s[4:7], s42 offen sc1
    v_and_b32 v12, 3, v3
    v_lshrrev_b32 v13, 2, v3
    v_cmp_eq_u32 vcc, 1, v12
    s_nop 1
    v_cndmask_b32 v232, v232, v233, vcc
    v_cndmask_b32 v236, v236, v237, vcc
    v_cmp_eq_u32 vcc, 2, v12
    s_nop 1
    v_cndmask_b32 v232, v232, v234, vcc
    v_cndmask_b32 v236, v236, v238, vcc
    v_cmp_eq_u32 vcc, 3, v12
    s_nop 1
    v_cndmask_b32 v232, v232, v235, vcc
    v_cndmask_b32 v236, v236, v239, vcc
    v_mul_f32 v234, 0x3acccccd, v240
    v_mul_f32 v238, 0x3acccccd, v241
    v_mul_f32 v233, 0x3acccccd, v232
    v_mul_f32 v237, 0x3acccccd, v236
    v_fma_f32 v233, -v234, v234, v233
    v_fma_f32 v237, -v238, v238, v237
    v_max_f32 v233, 0, v233
    v_max_f32 v237, 0, v237
    v_cvt_pk_bf16_f32 v234, v234, v233
    v_cvt_pk_bf16_f32 v238, v238, v237
    v_and_b32 v233, 0xffff0000, v234
    v_and_b32 v237, 0xffff0000, v238
    v_add_f32 v233, 0x3727c5ac, v233
    v_add_f32 v237, 0x3727c5ac, v237
    v_cvt_pk_bf16_f32 v233, v233, v233
    v_cvt_pk_bf16_f32 v237, v237, v237
    v_lshlrev_b32 v233, 16, v233
    v_lshlrev_b32 v237, 16, v237
    v_sqrt_f32 v233, v233
    v_sqrt_f32 v237, v237
    v_cvt_pk_bf16_f32 v233, v233, v233
    v_cvt_pk_bf16_f32 v237, v237, v237
    v_lshlrev_b32 v233, 16, v233
    v_lshlrev_b32 v237, 16, v237
    v_rcp_f32 v233, v233
    v_rcp_f32 v237, v237
    v_cmp_eq_u32 vcc, v13, v4
    s_lshl_b32 s18, s3, 7
    s_add_u32 s18, s18, 143872
    v_lshl_add_u32 v12, v3, 2, s18
    v_mov_b32 v13, 144384
    v_cndmask_b32 v12, v13, v12, vcc
    ds_write_b32 v12, v233 offset:0
    ds_write_b32 v12, v237 offset:64
    s_waitcnt vmcnt(22)
    s_mov_b64 exec, 0xffff
    buffer_store_dwordx2 v[252:253], v254, s[4:7], s36 offen offset:128 sc1
    s_mov_b64 exec, -1
    v_mfma_f32_16x16x32_bf16 v[116:119], a[0:3], v[176:179], 0
    s_add_u32 s18, s3, 1
    s_and_b32 s18, s18, 3
    v_mfma_f32_16x16x32_bf16 v[120:123], a[4:7], v[176:179], 0
    s_add_u32 s40, s45, 12288
    buffer_load_dwordx4 v[224:227], v91, s[4:7], s40 offen sc1
    v_mfma_f32_16x16x32_bf16 v[124:127], a[8:11], v[176:179], 0
    s_mul_i32 s19, s18, 15360
    s_add_u32 s19, s19, 0
    v_mfma_f32_16x16x32_bf16 v[128:131], a[12:15], v[176:179], 0
    v_add_u32 v73, s19, v15
    s_add_u32 s18, s3, 2
    v_mfma_f32_16x16x32_bf16 v[132:135], a[16:19], v[176:179], 0
    s_and_b32 s18, s18, 3
    s_mul_i32 s19, s18, 15360
    s_waitcnt vmcnt(23)
    v_mfma_f32_16x16x32_bf16 v[136:139], a[0:3], v[180:183], 0
    s_add_u32 s19, s19, 5120
    v_add_u32 v74, s19, v15
    v_mfma_f32_16x16x32_bf16 v[140:143], a[4:7], v[180:183], 0
    buffer_load_dwordx4 v[228:231], v92, s[4:7], s40 offen sc1
    v_mfma_f32_16x16x32_bf16 v[144:147], a[8:11], v[180:183], 0
    s_add_u32 s18, s3, 3
    s_and_b32 s18, s18, 3
    v_mfma_f32_16x16x32_bf16 v[148:151], a[12:15], v[180:183], 0
    s_mul_i32 s19, s18, 15360
    s_add_u32 s19, s19, 10240
    v_mfma_f32_16x16x32_bf16 v[152:155], a[16:19], v[180:183], 0
    v_add_u32 v75, s19, v15
    v_mul_u32_u24 v6, 1280, v3
    s_waitcnt vmcnt(23)
    v_mfma_f32_16x16x32_bf16 v[156:159], a[0:3], v[184:187], 0
    v_lshl_add_u32 v6, v4, 3, v6
    s_mul_i32 s18, s3, 15360
    v_mfma_f32_16x16x32_bf16 v[160:163], a[4:7], v[184:187], 0
    buffer_load_dwordx4 v[232:235], v93, s[4:7], s40 offen sc1
    v_mfma_f32_16x16x32_bf16 v[164:167], a[8:11], v[184:187], 0
    v_add_u32 v72, s18, v15
    s_and_b32 s18, s22, 1
    v_mfma_f32_16x16x32_bf16 v[168:171], a[12:15], v[184:187], 0
    s_lshl_b32 s18, s18, 8
    s_lshl_b32 s19, s3, 6
    v_mfma_f32_16x16x32_bf16 v[172:175], a[16:19], v[184:187], 0
    s_add_u32 s18, s18, s19
    s_add_u32 s18, s18, 143872
    s_waitcnt vmcnt(23)
    v_mfma_f32_16x16x32_bf16 v[96:99], a[0:3], v[188:191], 0
    v_lshl_add_u32 v94, v3, 2, s18
    v_mfma_f32_16x16x32_bf16 v[100:103], a[4:7], v[188:191], 0
    buffer_load_dwordx4 v[236:239], v90, s[4:7], s40 offen sc1
    v_mfma_f32_16x16x32_bf16 v[104:107], a[8:11], v[188:191], 0
    v_mfma_f32_16x16x32_bf16 v[108:111], a[12:15], v[188:191], 0
    v_mfma_f32_16x16x32_bf16 v[112:115], a[16:19], v[188:191], 0
    s_waitcnt vmcnt(23)
    v_mfma_f32_16x16x32_bf16 v[116:119], a[20:23], v[192:195], v[116:119]
    v_mfma_f32_16x16x32_bf16 v[120:123], a[24:27], v[192:195], v[120:123]
    s_add_u32 s40, s45, 16384
    buffer_load_dwordx4 v[176:179], v91, s[4:7], s40 offen sc1
    v_mfma_f32_16x16x32_bf16 v[124:127], a[28:31], v[192:195], v[124:127]
    v_mfma_f32_16x16x32_bf16 v[128:131], a[32:35], v[192:195], v[128:131]
    v_mfma_f32_16x16x32_bf16 v[132:135], a[36:39], v[192:195], v[132:135]
    s_waitcnt vmcnt(23)
    v_mfma_f32_16x16x32_bf16 v[136:139], a[20:23], v[196:199], v[136:139]
    v_mfma_f32_16x16x32_bf16 v[140:143], a[24:27], v[196:199], v[140:143]
    buffer_load_dwordx4 v[180:183], v92, s[4:7], s40 offen sc1
    v_mfma_f32_16x16x32_bf16 v[144:147], a[28:31], v[196:199], v[144:147]
    v_mfma_f32_16x16x32_bf16 v[148:151], a[32:35], v[196:199], v[148:151]
    v_mfma_f32_16x16x32_bf16 v[152:155], a[36:39], v[196:199], v[152:155]
    s_waitcnt vmcnt(23)
    v_mfma_f32_16x16x32_bf16 v[156:159], a[20:23], v[200:203], v[156:159]
    v_mfma_f32_16x16x32_bf16 v[160:163], a[24:27], v[200:203], v[160:163]
    buffer_load_dwordx4 v[184:187], v93, s[4:7], s40 offen sc1
    v_mfma_f32_16x16x32_bf16 v[164:167], a[28:31], v[200:203], v[164:167]
    v_mfma_f32_16x16x32_bf16 v[168:171], a[32:35], v[200:203], v[168:171]
    v_mfma_f32_16x16x32_bf16 v[172:175], a[36:39], v[200:203], v[172:175]
    s_waitcnt vmcnt(23)
    v_mfma_f32_16x16x32_bf16 v[96:99], a[20:23], v[204:207], v[96:99]
    v_mfma_f32_16x16x32_bf16 v[100:103], a[24:27], v[204:207], v[100:103]
    buffer_load_dwordx4 v[188:191], v90, s[4:7], s40 offen sc1
    v_mfma_f32_16x16x32_bf16 v[104:107], a[28:31], v[204:207], v[104:107]
    v_mfma_f32_16x16x32_bf16 v[108:111], a[32:35], v[204:207], v[108:111]
    v_mfma_f32_16x16x32_bf16 v[112:115], a[36:39], v[204:207], v[112:115]
    s_waitcnt vmcnt(23)
    v_mfma_f32_16x16x32_bf16 v[116:119], a[40:43], v[208:211], v[116:119]
    v_mfma_f32_16x16x32_bf16 v[120:123], a[44:47], v[208:211], v[120:123]
    s_add_u32 s40, s45, 20480
    buffer_load_dwordx4 v[192:195], v91, s[4:7], s40 offen sc1
    v_mfma_f32_16x16x32_bf16 v[124:127], a[48:51], v[208:211], v[124:127]
    v_mfma_f32_16x16x32_bf16 v[128:131], a[52:55], v[208:211], v[128:131]
    v_mfma_f32_16x16x32_bf16 v[132:135], a[56:59], v[208:211], v[132:135]
    s_waitcnt vmcnt(23)
    v_mfma_f32_16x16x32_bf16 v[136:139], a[40:43], v[212:215], v[136:139]
    v_mfma_f32_16x16x32_bf16 v[140:143], a[44:47], v[212:215], v[140:143]
    buffer_load_dwordx4 v[196:199], v92, s[4:7], s40 offen sc1
    v_mfma_f32_16x16x32_bf16 v[144:147], a[48:51], v[212:215], v[144:147]
    v_mfma_f32_16x16x32_bf16 v[148:151], a[52:55], v[212:215], v[148:151]
    v_mfma_f32_16x16x32_bf16 v[152:155], a[56:59], v[212:215], v[152:155]
    s_waitcnt vmcnt(23)
    v_mfma_f32_16x16x32_bf16 v[156:159], a[40:43], v[216:219], v[156:159]
    v_mfma_f32_16x16x32_bf16 v[160:163], a[44:47], v[216:219], v[160:163]
    buffer_load_dwordx4 v[200:203], v93, s[4:7], s40 offen sc1
    v_mfma_f32_16x16x32_bf16 v[164:167], a[48:51], v[216:219], v[164:167]
    v_mfma_f32_16x16x32_bf16 v[168:171], a[52:55], v[216:219], v[168:171]
    v_mfma_f32_16x16x32_bf16 v[172:175], a[56:59], v[216:219], v[172:175]
    s_waitcnt vmcnt(23)
    v_mfma_f32_16x16x32_bf16 v[96:99], a[40:43], v[220:223], v[96:99]
    v_mfma_f32_16x16x32_bf16 v[100:103], a[44:47], v[220:223], v[100:103]
    buffer_load_dwordx4 v[204:207], v90, s[4:7], s40 offen sc1
    v_mfma_f32_16x16x32_bf16 v[104:107], a[48:51], v[220:223], v[104:107]
    v_mfma_f32_16x16x32_bf16 v[108:111], a[52:55], v[220:223], v[108:111]
    v_mfma_f32_16x16x32_bf16 v[112:115], a[56:59], v[220:223], v[112:115]
    s_waitcnt vmcnt(11)
    v_mfma_f32_16x16x32_bf16 v[116:119], a[60:63], v[224:227], v[116:119]
    v_mfma_f32_16x16x32_bf16 v[120:123], a[64:67], v[224:227], v[120:123]
    s_add_u32 s40, s45, 24576
    buffer_load_dwordx4 v[208:211], v91, s[4:7], s40 offen sc1
    v_mfma_f32_16x16x32_bf16 v[124:127], a[68:71], v[224:227], v[124:127]
    v_mfma_f32_16x16x32_bf16 v[128:131], a[72:75], v[224:227], v[128:131]
    v_mfma_f32_16x16x32_bf16 v[132:135], a[76:79], v[224:227], v[132:135]
    s_waitcnt vmcnt(11)
    v_mfma_f32_16x16x32_bf16 v[136:139], a[60:63], v[228:231], v[136:139]
    v_mfma_f32_16x16x32_bf16 v[140:143], a[64:67], v[228:231], v[140:143]
    buffer_load_dwordx4 v[212:215], v92, s[4:7], s40 offen sc1
    buffer_load_dwordx2 v[86:87], v11, s[4:7], s39 offen offset:128 sc1
    v_mfma_f32_16x16x32_bf16 v[144:147], a[68:71], v[228:231], v[144:147]
    v_mfma_f32_16x16x32_bf16 v[148:151], a[72:75], v[228:231], v[148:151]
    v_mfma_f32_16x16x32_bf16 v[152:155], a[76:79], v[228:231], v[152:155]
    s_waitcnt vmcnt(12)
    v_mfma_f32_16x16x32_bf16 v[156:159], a[60:63], v[232:235], v[156:159]
    v_mfma_f32_16x16x32_bf16 v[160:163], a[64:67], v[232:235], v[160:163]
    buffer_load_dwordx4 v[216:219], v93, s[4:7], s40 offen sc1
    v_mfma_f32_16x16x32_bf16 v[164:167], a[68:71], v[232:235], v[164:167]
    v_mfma_f32_16x16x32_bf16 v[168:171], a[72:75], v[232:235], v[168:171]
    v_mfma_f32_16x16x32_bf16 v[172:175], a[76:79], v[232:235], v[172:175]
    s_waitcnt vmcnt(12)
    v_mfma_f32_16x16x32_bf16 v[96:99], a[60:63], v[236:239], v[96:99]
    v_mfma_f32_16x16x32_bf16 v[100:103], a[64:67], v[236:239], v[100:103]
    buffer_load_dwordx4 v[220:223], v90, s[4:7], s40 offen sc1
    v_mfma_f32_16x16x32_bf16 v[104:107], a[68:71], v[236:239], v[104:107]
    v_mfma_f32_16x16x32_bf16 v[108:111], a[72:75], v[236:239], v[108:111]
    v_mfma_f32_16x16x32_bf16 v[112:115], a[76:79], v[236:239], v[112:115]
    s_waitcnt vmcnt(12)
    v_mfma_f32_16x16x32_bf16 v[116:119], a[80:83], v[176:179], v[116:119]
    v_mfma_f32_16x16x32_bf16 v[120:123], a[84:87], v[176:179], v[120:123]
    s_add_u32 s40, s45, 28672
    buffer_load_dwordx4 v[224:227], v91, s[4:7], s40 offen sc1
    v_mfma_f32_16x16x32_bf16 v[124:127], a[88:91], v[176:179], v[124:127]
    v_mfma_f32_16x16x32_bf16 v[128:131], a[92:95], v[176:179], v[128:131]
    v_mfma_f32_16x16x32_bf16 v[132:135], a[96:99], v[176:179], v[132:135]
    s_waitcnt vmcnt(12)
    v_mfma_f32_16x16x32_bf16 v[136:139], a[80:83], v[180:183], v[136:139]
    v_mfma_f32_16x16x32_bf16 v[140:143], a[84:87], v[180:183], v[140:143]
    buffer_load_dwordx4 v[228:231], v92, s[4:7], s40 offen sc1
    v_mfma_f32_16x16x32_bf16 v[144:147], a[88:91], v[180:183], v[144:147]
    v_mfma_f32_16x16x32_bf16 v[148:151], a[92:95], v[180:183], v[148:151]
    v_mfma_f32_16x16x32_bf16 v[152:155], a[96:99], v[180:183], v[152:155]
    s_waitcnt vmcnt(12)
    v_mfma_f32_16x16x32_bf16 v[156:159], a[80:83], v[184:187], v[156:159]
    v_mfma_f32_16x16x32_bf16 v[160:163], a[84:87], v[184:187], v[160:163]
    buffer_load_dwordx4 v[232:235], v93, s[4:7], s40 offen sc1
    v_mfma_f32_16x16x32_bf16 v[164:167], a[88:91], v[184:187], v[164:167]
    v_mfma_f32_16x16x32_bf16 v[168:171], a[92:95], v[184:187], v[168:171]
    v_mfma_f32_16x16x32_bf16 v[172:175], a[96:99], v[184:187], v[172:175]
    s_waitcnt vmcnt(12)
    v_mfma_f32_16x16x32_bf16 v[96:99], a[80:83], v[188:191], v[96:99]
    v_mfma_f32_16x16x32_bf16 v[100:103], a[84:87], v[188:191], v[100:103]
    buffer_load_dwordx4 v[236:239], v90, s[4:7], s40 offen sc1
    v_mfma_f32_16x16x32_bf16 v[104:107], a[88:91], v[188:191], v[104:107]
    v_mfma_f32_16x16x32_bf16 v[108:111], a[92:95], v[188:191], v[108:111]
    v_mfma_f32_16x16x32_bf16 v[112:115], a[96:99], v[188:191], v[112:115]
    s_waitcnt vmcnt(12)
    v_mfma_f32_16x16x32_bf16 v[116:119], a[100:103], v[192:195], v[116:119]
    v_mfma_f32_16x16x32_bf16 v[120:123], a[104:107], v[192:195], v[120:123]
    s_waitcnt vmcnt(6)
    v_cmp_eq_u64 vcc, s[48:49], v[86:87]
    s_cmp_eq_u64 vcc, exec
    s_cbranch_scc1 L_sp3bc_out
    s_mov_b32 s58, 0
L_sp3bc:
    buffer_load_dwordx2 v[86:87], v11, s[4:7], s39 offen offset:128 sc1
    s_add_u32 s58, s58, 1
    s_waitcnt vmcnt(0)
    v_cmp_eq_u64 vcc, s[48:49], v[86:87]
    s_cmp_eq_u64 vcc, exec
    s_cbranch_scc1 L_sp3bc_out
    s_sleep 1
    s_cmp_le_u32 s58, 200000
    s_cbranch_scc1 L_sp3bc
L_sp3bc_out:
    s_add_u32 s40, s45, 32768
    buffer_load_dwordx4 v[176:179], v91, s[4:7], s40 offen sc1
    v_mfma_f32_16x16x32_bf16 v[124:127], a[108:111], v[192:195], v[124:127]
    v_mfma_f32_16x16x32_bf16 v[128:131], a[112:115], v[192:195], v[128:131]
    v_mfma_f32_16x16x32_bf16 v[132:135], a[116:119], v[192:195], v[132:135]
    s_waitcnt vmcnt(12)
    v_mfma_f32_16x16x32_bf16 v[136:139], a[100:103], v[196:199], v[136:139]
    v_mfma_f32_16x16x32_bf16 v[140:143], a[104:107], v[196:199], v[140:143]
    s_add_u32 s40, s45, 36864
    buffer_load_dwordx4 v[180:183], v91, s[4:7], s40 offen sc1
    v_mfma_f32_16x16x32_bf16 v[144:147], a[108:111], v[196:199], v[144:147]
    v_mfma_f32_16x16x32_bf16 v[148:151], a[112:115], v[196:199], v[148:151]
    v_mfma_f32_16x16x32_bf16 v[152:155], a[116:119], v[196:199], v[152:155]
    s_waitcnt vmcnt(12)
    v_mfma_f32_16x16x32_bf16 v[156:159], a[100:103], v[200:203], v[156:159]
    v_mfma_f32_16x16x32_bf16 v[160:163], a[104:107], v[200:203], v[160:163]
    s_add_u32 s40, s45, 40960
    buffer_load_dwordx4 v[184:187], v91, s[4:7], s40 offen sc1
    v_mfma_f32_16x16x32_bf16 v[164:167], a[108:111], v[200:203], v[164:167]
    v_mfma_f32_16x16x32_bf16 v[168:171], a[112:115], v[200:203], v[168:171]
    v_mfma_f32_16x16x32_bf16 v[172:175], a[116:119], v[200:203], v[172:175]
    s_waitcnt vmcnt(12)
    v_mfma_f32_16x16x32_bf16 v[96:99], a[100:103], v[204:207], v[96:99]
    v_mfma_f32_16x16x32_bf16 v[100:103], a[104:107], v[204:207], v[100:103]
    s_add_u32 s40, s45, 45056
    buffer_load_dwordx4 v[188:191], v91, s[4:7], s40 offen sc1
    v_mfma_f32_16x16x32_bf16 v[104:107], a[108:111], v[204:207], v[104:107]
    v_mfma_f32_16x16x32_bf16 v[108:111], a[112:115], v[204:207], v[108:111]
    v_mfma_f32_16x16x32_bf16 v[112:115], a[116:119], v[204:207], v[112:115]
    s_waitcnt vmcnt(12)
    v_mfma_f32_16x16x32_bf16 v[116:119], a[120:123], v[208:211], v[116:119]
    v_mfma_f32_16x16x32_bf16 v[120:123], a[124:127], v[208:211], v[120:123]
    s_add_u32 s40, s45, 49152
    v_sub_u32 v91, v91, v254
    buffer_load_dwordx2 v[192:193], v91, s[4:7], s40 offen offset:0 sc1
    buffer_load_dwordx2 v[194:195], v91, s[4:7], s40 offen offset:512 sc1
    v_mfma_f32_16x16x32_bf16 v[124:127], a[128:131], v[208:211], v[124:127]
    v_mfma_f32_16x16x32_bf16 v[128:131], a[132:135], v[208:211], v[128:131]
    v_mfma_f32_16x16x32_bf16 v[132:135], a[136:139], v[208:211], v[132:135]
    s_waitcnt vmcnt(13)
    v_mfma_f32_16x16x32_bf16 v[136:139], a[120:123], v[212:215], v[136:139]
    v_mfma_f32_16x16x32_bf16 v[140:143], a[124:127], v[212:215], v[140:143]
    s_add_u32 s40, s45, 53248
    buffer_load_dwordx2 v[196:197], v91, s[4:7], s40 offen offset:0 sc1
    buffer_load_dwordx2 v[198:199], v91, s[4:7], s40 offen offset:512 sc1
    v_mfma_f32_16x16x32_bf16 v[144:147], a[128:131], v[212:215], v[144:147]
    v_mfma_f32_16x16x32_bf16 v[148:151], a[132:135], v[212:215], v[148:151]
    v_mfma_f32_16x16x32_bf16 v[152:155], a[136:139], v[212:215], v[152:155]
    s_waitcnt vmcnt(13)
    v_mfma_f32_16x16x32_bf16 v[156:159], a[120:123], v[216:219], v[156:159]
    v_mfma_f32_16x16x32_bf16 v[160:163], a[124:127], v[216:219], v[160:163]
    s_add_u32 s40, s45, 32768
    buffer_load_dwordx4 v[200:203], v92, s[4:7], s40 offen sc1
    v_mfma_f32_16x16x32_bf16 v[164:167], a[128:131], v[216:219], v[164:167]
    v_mfma_f32_16x16x32_bf16 v[168:171], a[132:135], v[216:219], v[168:171]
    v_mfma_f32_16x16x32_bf16 v[172:175], a[136:139], v[216:219], v[172:175]
    s_waitcnt vmcnt(13)
    v_mfma_f32_16x16x32_bf16 v[96:99], a[120:123], v[220:223], v[96:99]
    v_mfma_f32_16x16x32_bf16 v[100:103], a[124:127], v[220:223], v[100:103]
    s_add_u32 s40, s45, 36864
    buffer_load_dwordx4 v[204:207], v92, s[4:7], s40 offen sc1
    v_mfma_f32_16x16x32_bf16 v[104:107], a[128:131], v[220:223], v[104:107]
    v_mfma_f32_16x16x32_bf16 v[108:111], a[132:135], v[220:223], v[108:111]
    v_mfma_f32_16x16x32_bf16 v[112:115], a[136:139], v[220:223], v[112:115]
    s_waitcnt vmcnt(13)
    v_mfma_f32_16x16x32_bf16 v[116:119], a[140:143], v[224:227], v[116:119]
    v_mfma_f32_16x16x32_bf16 v[120:123], a[144:147], v[224:227], v[120:123]
    s_add_u32 s40, s45, 40960
    buffer_load_dwordx4 v[208:211], v92, s[4:7], s40 offen sc1
    v_mfma_f32_16x16x32_bf16 v[124:127], a[148:151], v[224:227], v[124:127]
    v_mfma_f32_16x16x32_bf16 v[128:131], a[152:155], v[224:227], v[128:131]
    v_mfma_f32_16x16x32_bf16 v[132:135], a[156:159], v[224:227], v[132:135]
    s_waitcnt vmcnt(13)
    v_mfma_f32_16x16x32_bf16 v[136:139], a[140:143], v[228:231], v[136:139]
    v_mfma_f32_16x16x32_bf16 v[140:143], a[144:147], v[228:231], v[140:143]
    s_add_u32 s40, s45, 45056
    buffer_load_dwordx4 v[212:215], v92, s[4:7], s40 offen sc1
    v_mfma_f32_16x16x32_bf16 v[144:147], a[148:151], v[228:231], v[144:147]
    v_mfma_f32_16x16x32_bf16 v[148:151], a[152:155], v[228:231], v[148:151]
    v_mfma_f32_16x16x32_bf16 v[152:155], a[156:159], v[228:231], v[152:155]
    s_waitcnt vmcnt(13)
    v_mfma_f32_16x16x32_bf16 v[156:159], a[140:143], v[232:235], v[156:159]
    v_mfma_f32_16x16x32_bf16 v[160:163], a[144:147], v[232:235], v[160:163]
    s_add_u32 s40, s45, 49152
    v_sub_u32 v92, v92, v254
    buffer_load_dwordx2 v[216:217], v92, s[4:7], s40 offen offset:0 sc1
    buffer_load_dwordx2 v[218:219], v92, s[4:7], s40 offen offset:512 sc1
    v_mfma_f32_16x16x32_bf16 v[164:167], a[148:151], v[232:235], v[164:167]
    v_mfma_f32_16x16x32_bf16 v[168:171], a[152:155], v[232:235], v[168:171]
    v_mfma_f32_16x16x32_bf16 v[172:175], a[156:159], v[232:235], v[172:175]
    s_waitcnt vmcnt(14)
    v_mfma_f32_16x16x32_bf16 v[96:99], a[140:143], v[236:239], v[96:99]
    v_mfma_f32_16x16x32_bf16 v[100:103], a[144:147], v[236:239], v[100:103]
    s_add_u32 s40, s45, 53248
    buffer_load_dwordx2 v[220:221], v92, s[4:7], s40 offen offset:0 sc1
    buffer_load_dwordx2 v[222:223], v92, s[4:7], s40 offen offset:512 sc1
    v_mfma_f32_16x16x32_bf16 v[104:107], a[148:151], v[236:239], v[104:107]
    v_mfma_f32_16x16x32_bf16 v[108:111], a[152:155], v[236:239], v[108:111]
    v_mfma_f32_16x16x32_bf16 v[112:115], a[156:159], v[236:239], v[112:115]
    s_waitcnt vmcnt(15)
    v_mfma_f32_16x16x32_bf16 v[116:119], a[160:163], v[176:179], v[116:119]
    v_lshlrev_b32 v240, 16, v76
    v_and_b32 v241, 0xffff0000, v76
    v_mfma_f32_16x16x32_bf16 v[120:123], a[164:167], v[176:179], v[120:123]
    s_add_u32 s40, s45, 32768
    buffer_load_dwordx4 v[224:227], v93, s[4:7], s40 offen sc1
    v_mfma_f32_16x16x32_bf16 v[124:127], a[168:171], v[176:179], v[124:127]
    v_lshlrev_b32 v242, 16, v77
    v_and_b32 v243, 0xffff0000, v77
    v_mfma_f32_16x16x32_bf16 v[128:131], a[172:175], v[176:179], v[128:131]
    v_lshlrev_b32 v244, 16, v78
    v_and_b32 v245, 0xffff0000, v78
    v_mfma_f32_16x16x32_bf16 v[132:135], a[176:179], v[176:179], v[132:135]
    v_lshlrev_b32 v246, 16, v79
    v_and_b32 v247, 0xffff0000, v79
    s_waitcnt vmcnt(15)
    v_mfma_f32_16x16x32_bf16 v[116:119], a[180:183], v[180:183], v[116:119]
    v_lshlrev_b32 v248, 16, v80
    v_and_b32 v249, 0xffff0000, v80
    v_mfma_f32_16x16x32_bf16 v[120:123], a[184:187], v[180:183], v[120:123]
    s_add_u32 s40, s45, 36864
    buffer_load_dwordx4 v[228:231], v93, s[4:7], s40 offen sc1
    v_mfma_f32_16x16x32_bf16 v[124:127], a[188:191], v[180:183], v[124:127]
    v_lshlrev_b32 v250, 16, v81
    v_and_b32 v251, 0xffff0000, v81
    v_mfma_f32_16x16x32_bf16 v[128:131], a[192:195], v[180:183], v[128:131]
    v_lshlrev_b32 v5, 16, v82
    v_and_b32 v7, 0xffff0000, v82
    v_mfma_f32_16x16x32_bf16 v[132:135], a[196:199], v[180:183], v[132:135]
    v_lshlrev_b32 v8, 16, v83
    v_and_b32 v9, 0xffff0000, v83
    s_waitcnt vmcnt(15)
    v_mfma_f32_16x16x32_bf16 v[116:119], a[200:203], v[184:187], v[116:119]
    v_lshlrev_b32 v10, 16, v84
    v_and_b32 v12, 0xffff0000, v84
    v_mfma_f32_16x16x32_bf16 v[120:123], a[204:207], v[184:187], v[120:123]
    s_add_u32 s40, s45, 40960
    buffer_load_dwordx4 v[232:235], v93, s[4:7], s40 offen sc1
    v_mfma_f32_16x16x32_bf16 v[124:127], a[208:211], v[184:187], v[124:127]
    v_lshlrev_b32 v13, 16, v85
    v_and_b32 v14, 0xffff0000, v85
    v_mfma_f32_16x16x32_bf16 v[128:131], a[212:215], v[184:187], v[128:131]
    v_mfma_f32_16x16x32_bf16 v[132:135], a[216:219], v[184:187], v[132:135]
    s_waitcnt vmcnt(15)
    v_mfma_f32_16x16x32_bf16 v[116:119], a[220:223], v[188:191], v[116:119]
    v_mfma_f32_16x16x32_bf16 v[120:123], v[16:19], v[188:191], v[120:123]
    s_add_u32 s40, s45, 45056
    buffer_load_dwordx4 v[236:239], v93, s[4:7], s40 offen sc1
    v_mfma_f32_16x16x32_bf16 v[124:127], v[20:23], v[188:191], v[124:127]
    v_mfma_f32_16x16x32_bf16 v[128:131], v[24:27], v[188:191], v[128:131]
    v_mfma_f32_16x16x32_bf16 v[132:135], v[28:31], v[188:191], v[132:135]
    s_waitcnt vmcnt(14)
    v_mfma_f32_16x16x32_bf16 v[116:119], v[32:35], v[192:195], v[116:119]
    v_mfma_f32_16x16x32_bf16 v[120:123], v[36:39], v[192:195], v[120:123]
    s_add_u32 s40, s45, 49152
    v_sub_u32 v93, v93, v254
    buffer_load_dwordx2 v[176:177], v93, s[4:7], s40 offen offset:0 sc1
    buffer_load_dwordx2 v[178:179], v93, s[4:7], s40 offen offset:512 sc1
    v_mfma_f32_16x16x32_bf16 v[124:127], v[40:43], v[192:195], v[124:127]
    v_mfma_f32_16x16x32_bf16 v[128:131], v[44:47], v[192:195], v[128:131]
    v_mfma_f32_16x16x32_bf16 v[132:135], v[48:51], v[192:195], v[132:135]
    s_waitcnt vmcnt(14)
    v_mfma_f32_16x16x32_bf16 v[116:119], v[52:55], v[196:199], v[116:119]
    v_mfma_f32_16x16x32_bf16 v[120:123], v[56:59], v[196:199], v[120:123]
    s_add_u32 s40, s45, 53248
    buffer_load_dwordx2 v[180:181], v93, s[4:7], s40 offen offset:0 sc1
    buffer_load_dwordx2 v[182:183], v93, s[4:7], s40 offen offset:512 sc1
    v_mfma_f32_16x16x32_bf16 v[124:127], v[60:63], v[196:199], v[124:127]
    v_mfma_f32_16x16x32_bf16 v[128:131], v[64:67], v[196:199], v[128:131]
    v_mfma_f32_16x16x32_bf16 v[132:135], v[68:71], v[196:199], v[132:135]
    s_waitcnt vmcnt(15)
    v_mfma_f32_16x16x32_bf16 v[136:139], a[160:163], v[200:203], v[136:139]
    v_mfma_f32_16x16x32_bf16 v[140:143], a[164:167], v[200:203], v[140:143]
    s_add_u32 s40, s45, 32768
    buffer_load_dwordx4 v[184:187], v90, s[4:7], s40 offen sc1
    v_mfma_f32_16x16x32_bf16 v[144:147], a[168:171], v[200:203], v[144:147]
    v_mfma_f32_16x16x32_bf16 v[148:151], a[172:175], v[200:203], v[148:151]
    v_mfma_f32_16x16x32_bf16 v[152:155], a[176:179], v[200:203], v[152:155]
    s_waitcnt vmcnt(15)
    v_mfma_f32_16x16x32_bf16 v[136:139], a[180:183], v[204:207], v[136:139]
    ds_write_b128 v73, v[116:119] offset:0
    v_mfma_f32_16x16x32_bf16 v[140:143], a[184:187], v[204:207], v[140:143]
    s_add_u32 s40, s45, 36864
    buffer_load_dwordx4 v[188:191], v90, s[4:7], s40 offen sc1
    v_mfma_f32_16x16x32_bf16 v[144:147], a[188:191], v[204:207], v[144:147]
    v_mfma_f32_16x16x32_bf16 v[148:151], a[192:195], v[204:207], v[148:151]
    ds_write_b128 v73, v[120:123] offset:1024
    v_mfma_f32_16x16x32_bf16 v[152:155], a[196:199], v[204:207], v[152:155]
    s_waitcnt vmcnt(15)
    v_mfma_f32_16x16x32_bf16 v[136:139], a[200:203], v[208:211], v[136:139]
    ds_write_b128 v73, v[124:127] offset:2048
    v_mfma_f32_16x16x32_bf16 v[140:143], a[204:207], v[208:211], v[140:143]
    s_add_u32 s40, s45, 40960
    buffer_load_dwordx4 v[192:195], v90, s[4:7], s40 offen sc1
    v_mfma_f32_16x16x32_bf16 v[144:147], a[208:211], v[208:211], v[144:147]
    v_mfma_f32_16x16x32_bf16 v[148:151], a[212:215], v[208:211], v[148:151]
    ds_write_b128 v73, v[128:131] offset:3072
    v_mfma_f32_16x16x32_bf16 v[152:155], a[216:219], v[208:211], v[152:155]
    s_waitcnt vmcnt(15)
    v_mfma_f32_16x16x32_bf16 v[136:139], a[220:223], v[212:215], v[136:139]
    ds_write_b128 v73, v[132:135] offset:4096
    v_mfma_f32_16x16x32_bf16 v[140:143], v[16:19], v[212:215], v[140:143]
    s_add_u32 s40, s45, 45056
    buffer_load_dwordx4 v[196:199], v90, s[4:7], s40 offen sc1
    v_mfma_f32_16x16x32_bf16 v[144:147], v[20:23], v[212:215], v[144:147]
    v_mfma_f32_16x16x32_bf16 v[148:151], v[24:27], v[212:215], v[148:151]
    v_mfma_f32_16x16x32_bf16 v[152:155], v[28:31], v[212:215], v[152:155]
    s_waitcnt vmcnt(14)
    v_mfma_f32_16x16x32_bf16 v[136:139], v[32:35], v[216:219], v[136:139]
    v_mfma_f32_16x16x32_bf16 v[140:143], v[36:39], v[216:219], v[140:143]
    s_add_u32 s40, s45, 49152
    v_sub_u32 v90, v90, v254
    buffer_load_dwordx2 v[200:201], v90, s[4:7], s40 offen offset:0 sc1
    buffer_load_dwordx2 v[202:203], v90, s[4:7], s40 offen offset:512 sc1
    v_mfma_f32_16x16x32_bf16 v[144:147], v[40:43], v[216:219], v[144:147]
    v_mfma_f32_16x16x32_bf16 v[148:151], v[44:47], v[216:219], v[148:151]
    v_mfma_f32_16x16x32_bf16 v[152:155], v[48:51], v[216:219], v[152:155]
    s_waitcnt vmcnt(14)
    v_mfma_f32_16x16x32_bf16 v[136:139], v[52:55], v[220:223], v[136:139]
    v_mfma_f32_16x16x32_bf16 v[140:143], v[56:59], v[220:223], v[140:143]
    s_add_u32 s40, s45, 53248
    buffer_load_dwordx2 v[204:205], v90, s[4:7], s40 offen offset:0 sc1
    buffer_load_dwordx2 v[206:207], v90, s[4:7], s40 offen offset:512 sc1
    v_mfma_f32_16x16x32_bf16 v[144:147], v[60:63], v[220:223], v[144:147]
    v_mfma_f32_16x16x32_bf16 v[148:151], v[64:67], v[220:223], v[148:151]
    v_mfma_f32_16x16x32_bf16 v[152:155], v[68:71], v[220:223], v[152:155]
    s_waitcnt vmcnt(15)
    v_mfma_f32_16x16x32_bf16 v[156:159], a[160:163], v[224:227], v[156:159]
    v_mfma_f32_16x16x32_bf16 v[160:163], a[164:167], v[224:227], v[160:163]
    v_mfma_f32_16x16x32_bf16 v[164:167], a[168:171], v[224:227], v[164:167]
    v_mfma_f32_16x16x32_bf16 v[168:171], a[172:175], v[224:227], v[168:171]
    v_mfma_f32_16x16x32_bf16 v[172:175], a[176:179], v[224:227], v[172:175]
    s_waitcnt vmcnt(14)
    v_mfma_f32_16x16x32_bf16 v[156:159], a[180:183], v[228:231], v[156:159]
    ds_write_b128 v74, v[136:139] offset:0
    v_mfma_f32_16x16x32_bf16 v[160:163], a[184:187], v[228:231], v[160:163]
    v_mfma_f32_16x16x32_bf16 v[164:167], a[188:191], v[228:231], v[164:167]
    v_mfma_f32_16x16x32_bf16 v[168:171], a[192:195], v[228:231], v[168:171]
    ds_write_b128 v74, v[140:143] offset:1024
    v_mfma_f32_16x16x32_bf16 v[172:175], a[196:199], v[228:231], v[172:175]
    s_waitcnt vmcnt(13)
    v_mfma_f32_16x16x32_bf16 v[156:159], a[200:203], v[232:235], v[156:159]
    ds_write_b128 v74, v[144:147] offset:2048
    v_mfma_f32_16x16x32_bf16 v[160:163], a[204:207], v[232:235], v[160:163]
    v_mfma_f32_16x16x32_bf16 v[164:167], a[208:211], v[232:235], v[164:167]
    v_mfma_f32_16x16x32_bf16 v[168:171], a[212:215], v[232:235], v[168:171]
    ds_write_b128 v74, v[148:151] offset:3072
    v_mfma_f32_16x16x32_bf16 v[172:175], a[216:219], v[232:235], v[172:175]
    s_waitcnt vmcnt(12)
    v_mfma_f32_16x16x32_bf16 v[156:159], a[220:223], v[236:239], v[156:159]
    ds_write_b128 v74, v[152:155] offset:4096
    v_mfma_f32_16x16x32_bf16 v[160:163], v[16:19], v[236:239], v[160:163]
    v_mfma_f32_16x16x32_bf16 v[164:167], v[20:23], v[236:239], v[164:167]
    v_mfma_f32_16x16x32_bf16 v[168:171], v[24:27], v[236:239], v[168:171]
    v_mfma_f32_16x16x32_bf16 v[172:175], v[28:31], v[236:239], v[172:175]
    s_waitcnt vmcnt(10)
    v_mfma_f32_16x16x32_bf16 v[156:159], v[32:35], v[176:179], v[156:159]
    v_mfma_f32_16x16x32_bf16 v[160:163], v[36:39], v[176:179], v[160:163]
    v_mfma_f32_16x16x32_bf16 v[164:167], v[40:43], v[176:179], v[164:167]
    v_mfma_f32_16x16x32_bf16 v[168:171], v[44:47], v[176:179], v[168:171]
    v_mfma_f32_16x16x32_bf16 v[172:175], v[48:51], v[176:179], v[172:175]
    s_waitcnt vmcnt(8)
    v_mfma_f32_16x16x32_bf16 v[156:159], v[52:55], v[180:183], v[156:159]
    v_mfma_f32_16x16x32_bf16 v[160:163], v[56:59], v[180:183], v[160:163]
    v_mfma_f32_16x16x32_bf16 v[164:167], v[60:63], v[180:183], v[164:167]
    v_mfma_f32_16x16x32_bf16 v[168:171], v[64:67], v[180:183], v[168:171]
    v_mfma_f32_16x16x32_bf16 v[172:175], v[68:71], v[180:183], v[172:175]
    s_waitcnt vmcnt(7)
    v_mfma_f32_16x16x32_bf16 v[96:99], a[160:163], v[184:187], v[96:99]
    v_mfma_f32_16x16x32_bf16 v[100:103], a[164:167], v[184:187], v[100:103]
    v_mfma_f32_16x16x32_bf16 v[104:107], a[168:171], v[184:187], v[104:107]
    v_mfma_f32_16x16x32_bf16 v[108:111], a[172:175], v[184:187], v[108:111]
    v_mfma_f32_16x16x32_bf16 v[112:115], a[176:179], v[184:187], v[112:115]
    s_waitcnt vmcnt(6)
    v_mfma_f32_16x16x32_bf16 v[96:99], a[180:183], v[188:191], v[96:99]
    ds_write_b128 v75, v[156:159] offset:0
    v_mfma_f32_16x16x32_bf16 v[100:103], a[184:187], v[188:191], v[100:103]
    v_mfma_f32_16x16x32_bf16 v[104:107], a[188:191], v[188:191], v[104:107]
    v_mfma_f32_16x16x32_bf16 v[108:111], a[192:195], v[188:191], v[108:111]
    ds_write_b128 v75, v[160:163] offset:1024
    v_mfma_f32_16x16x32_bf16 v[112:115], a[196:199], v[188:191], v[112:115]
    s_waitcnt vmcnt(5)
    v_mfma_f32_16x16x32_bf16 v[96:99], a[200:203], v[192:195], v[96:99]
    ds_write_b128 v75, v[164:167] offset:2048
    v_mfma_f32_16x16x32_bf16 v[100:103], a[204:207], v[192:195], v[100:103]
    v_mfma_f32_16x16x32_bf16 v[104:107], a[208:211], v[192:195], v[104:107]
    v_mfma_f32_16x16x32_bf16 v[108:111], a[212:215], v[192:195], v[108:111]
    ds_write_b128 v75, v[168:171] offset:3072
    v_mfma_f32_16x16x32_bf16 v[112:115], a[216:219], v[192:195], v[112:115]
    s_waitcnt vmcnt(4)
    v_mfma_f32_16x16x32_bf16 v[96:99], a[220:223], v[196:199], v[96:99]
    ds_write_b128 v75, v[172:175] offset:4096
    v_mfma_f32_16x16x32_bf16 v[100:103], v[16:19], v[196:199], v[100:103]
    v_mfma_f32_16x16x32_bf16 v[104:107], v[20:23], v[196:199], v[104:107]
    v_mfma_f32_16x16x32_bf16 v[108:111], v[24:27], v[196:199], v[108:111]
    v_mfma_f32_16x16x32_bf16 v[112:115], v[28:31], v[196:199], v[112:115]
    s_waitcnt vmcnt(2)
    s_waitcnt lgkmcnt(0)
    s_barrier
    ds_read_b32 v88, v94
    v_mfma_f32_16x16x32_bf16 v[96:99], v[32:35], v[200:203], v[96:99]
    ds_read_b128 v[116:119], v72 offset:0
    ds_read_b128 v[120:123], v72 offset:5120
    v_mfma_f32_16x16x32_bf16 v[100:103], v[36:39], v[200:203], v[100:103]
    ds_read_b128 v[124:127], v72 offset:10240
    ds_read_b128 v[128:131], v72 offset:1024
    v_mfma_f32_16x16x32_bf16 v[104:107], v[40:43], v[200:203], v[104:107]
    ds_read_b128 v[132:135], v72 offset:6144
    ds_read_b128 v[136:139], v72 offset:11264
    v_mfma_f32_16x16x32_bf16 v[108:111], v[44:47], v[200:203], v[108:111]
    ds_read_b128 v[140:143], v72 offset:2048
    ds_read_b128 v[144:147], v72 offset:7168
    v_mfma_f32_16x16x32_bf16 v[112:115], v[48:51], v[200:203], v[112:115]
    ds_read_b128 v[148:151], v72 offset:12288
    ds_read_b128 v[152:155], v72 offset:3072
    s_waitcnt vmcnt(0)
    v_mfma_f32_16x16x32_bf16 v[96:99], v[52:55], v[204:207], v[96:99]
    ds_read_b128 v[156:159], v72 offset:8192
    ds_read_b128 v[160:163], v72 offset:13312
    v_mfma_f32_16x16x32_bf16 v[100:103], v[56:59], v[204:207], v[100:103]
    ds_read_b128 v[164:167], v72 offset:4096
    ds_read_b128 v[168:171], v72 offset:9216
    v_mfma_f32_16x16x32_bf16 v[104:107], v[60:63], v[204:207], v[104:107]
    ds_read_b128 v[172:175], v72 offset:14336
    s_waitcnt lgkmcnt(12)
    v_mfma_f32_16x16x32_bf16 v[108:111], v[64:67], v[204:207], v[108:111]
    v_add_f32 v116, v116, v120
    v_add_f32 v117, v117, v121
    v_mfma_f32_16x16x32_bf16 v[112:115], v[68:71], v[204:207], v[112:115]
    v_add_f32 v118, v118, v122
    v_add_f32 v119, v119, v123
    v_add_f32 v116, v116, v124
    v_add_f32 v117, v117, v125
    v_add_f32 v118, v118, v126
    v_add_f32 v119, v119, v127
    v_fma_f32 v116, v116, v88, v240
    v_fma_f32 v117, v117, v88, v241
    v_fma_f32 v118, v118, v88, v242
    v_fma_f32 v119, v119, v88, v243
    s_waitcnt lgkmcnt(9)
    v_add_f32 v128, v128, v132
    v_add_f32 v129, v129, v133
    v_add_f32 v130, v130, v134
    v_add_f32 v131, v131, v135
    v_add_f32 v128, v128, v136
    v_add_f32 v129, v129, v137
    v_add_f32 v130, v130, v138
    v_add_f32 v131, v131, v139
    v_fma_f32 v128, v128, v88, v244
    v_fma_f32 v129, v129, v88, v245
    v_fma_f32 v130, v130, v88, v246
    v_fma_f32 v131, v131, v88, v247
    s_waitcnt lgkmcnt(6)
    v_add_f32 v140, v140, v144
    v_add_f32 v141, v141, v145
    v_add_f32 v142, v142, v146
    v_add_f32 v143, v143, v147
    v_add_f32 v140, v140, v148
    v_add_f32 v141, v141, v149
    v_add_f32 v142, v142, v150
    v_add_f32 v143, v143, v151
    v_fma_f32 v140, v140, v88, v248
    v_fma_f32 v141, v141, v88, v249
    v_fma_f32 v142, v142, v88, v250
    v_fma_f32 v143, v143, v88, v251
    s_waitcnt lgkmcnt(3)
    v_add_f32 v152, v152, v156
    v_add_f32 v153, v153, v157
    v_add_f32 v154, v154, v158
    v_add_f32 v155, v155, v159
    v_add_f32 v152, v152, v160
    v_add_f32 v153, v153, v161
    v_add_f32 v154, v154, v162
    v_add_f32 v155, v155, v163
    v_fma_f32 v152, v152, v88, v5
    v_fma_f32 v153, v153, v88, v7
    v_fma_f32 v154, v154, v88, v8
    v_fma_f32 v155, v155, v88, v9
    s_waitcnt lgkmcnt(0)
    v_add_f32 v164, v164, v168
    v_add_f32 v165, v165, v169
    v_add_f32 v166, v166, v170
    v_add_f32 v167, v167, v171
    v_add_f32 v164, v164, v172
    v_add_f32 v165, v165, v173
    v_add_f32 v166, v166, v174
    v_add_f32 v167, v167, v175
    v_fma_f32 v164, v164, v88, v10
    v_fma_f32 v165, v165, v88, v12
    v_fma_f32 v166, v166, v88, v13
    v_fma_f32 v167, v167, v88, v14
    v_fma_f32 v96, v96, v88, v116
    v_fma_f32 v97, v97, v88, v117
    v_fma_f32 v98, v98, v88, v118
    v_fma_f32 v99, v99, v88, v119
    v_cvt_pk_bf16_f32 v76, v96, v97
    v_cvt_pk_bf16_f32 v77, v98, v99
    buffer_store_dwordx2 v[76:77], v6, s[8:11], s44 offen offset:0
    v_fma_f32 v100, v100, v88, v128
    v_fma_f32 v101, v101, v88, v129
    v_fma_f32 v102, v102, v88, v130
    v_fma_f32 v103, v103, v88, v131
    v_cvt_pk_bf16_f32 v78, v100, v101
    v_cvt_pk_bf16_f32 v79, v102, v103
    buffer_store_dwordx2 v[78:79], v6, s[8:11], s44 offen offset:32
    v_fma_f32 v104, v104, v88, v140
    v_fma_f32 v105, v105, v88, v141
    v_fma_f32 v106, v106, v88, v142
    v_fma_f32 v107, v107, v88, v143
    v_cvt_pk_bf16_f32 v80, v104, v105
    v_cvt_pk_bf16_f32 v81, v106, v107
    buffer_store_dwordx2 v[80:81], v6, s[8:11], s44 offen offset:64
    v_fma_f32 v108, v108, v88, v152
    v_fma_f32 v109, v109, v88, v153
    v_fma_f32 v110, v110, v88, v154
    v_fma_f32 v111, v111, v88, v155
    v_cvt_pk_bf16_f32 v82, v108, v109
    v_cvt_pk_bf16_f32 v83, v110, v111
    buffer_store_dwordx2 v[82:83], v6, s[8:11], s44 offen offset:96
    v_fma_f32 v112, v112, v88, v164
    v_fma_f32 v113, v113, v88, v165
    v_fma_f32 v114, v114, v88, v166
    v_fma_f32 v115, v115, v88, v167
    v_cvt_pk_bf16_f32 v84, v112, v113
    v_cvt_pk_bf16_f32 v85, v114, v115
    buffer_store_dwordx2 v[84:85], v6, s[8:11], s44 offen offset:128
    s_endpgm
L_idle:
    s_sub_u32 s18, s2, 160
    s_lshr_b32 s29, s18, 3
    s_mul_i32 s30, s3, 12
    s_add_u32 s29, s29, s30
    s_and_b32 s30, s2, 7
    v_lshrrev_b32 v1, 3, v0
    v_and_b32 v2, 7, v0
    s_cmp_lt_u32 s29, 16
    s_cbranch_scc1 L_pk1
    s_lshl_b32 s19, s30, 5
    s_add_u32 s19, s19, s29
    s_sub_u32 s19, s19, 16
    v_mul_u32_u24 v3, 1280, v1
    v_lshl_add_u32 v3, v2, 4, v3
    s_mul_i32 s31, s19, 10240
    s_waitcnt lgkmcnt(0)
    s_mov_b32 s8, s32
    s_and_b32 s9, s33, 0xffff
    s_mov_b32 s10, 0x280000
    s_mov_b32 s11, 0x20000
    buffer_load_dwordx4 v[16:19], v3, s[8:11], s31 offen offset:0
    buffer_load_dwordx4 v[20:23], v3, s[8:11], s31 offen offset:128
    buffer_load_dwordx4 v[24:27], v3, s[8:11], s31 offen offset:256
    buffer_load_dwordx4 v[28:31], v3, s[8:11], s31 offen offset:384
    buffer_load_dwordx4 v[32:35], v3, s[8:11], s31 offen offset:512
    buffer_load_dwordx4 v[36:39], v3, s[8:11], s31 offen offset:640
    buffer_load_dwordx4 v[40:43], v3, s[8:11], s31 offen offset:768
    buffer_load_dwordx4 v[44:47], v3, s[8:11], s31 offen offset:896
    buffer_load_dwordx4 v[48:51], v3, s[8:11], s31 offen offset:1024
    buffer_load_dwordx4 v[52:55], v3, s[8:11], s31 offen offset:1152
    s_barrier
    s_load_dword s48, s[14:15], 0
    s_mov_b32 s4, s14
    s_and_b32 s5, s15, 0xffff
    s_mov_b32 s6, 0x10000000
    s_mov_b32 s7, 0x20000
    v_mov_b32 v60, 0
    v_mov_b32 v61, 0
    v_mov_b32 v62, 0
    v_mov_b32 v63, 0
    v_lshlrev_b32 v66, 3, v1
    v_lshl_add_u32 v66, v2, 6, v66
    v_mov_b32 v67, 0x7fffff00
    v_cmp_gt_u32 vcc, 2, v2
    s_lshl_b32 s56, s19, 7
    s_add_u32 s56, s56, 4096
    v_cndmask_b32 v66, v67, v66, vcc
    s_waitcnt lgkmcnt(0)
    s_mul_i32 s49, s48, 0x9e3779b1
    s_add_u32 s48, s48, 1
    s_xor_b32 s49, s49, 0x5bd1e995
    s_waitcnt vmcnt(9)
    v_dot2c_f32_bf16 v60, 0x3f803f80, v16
    v_dot2c_f32_bf16 v62, v16, v16
    v_dot2c_f32_bf16 v61, 0x3f803f80, v17
    v_dot2c_f32_bf16 v63, v17, v17
    v_dot2c_f32_bf16 v60, 0x3f803f80, v18
    v_dot2c_f32_bf16 v62, v18, v18
    v_dot2c_f32_bf16 v61, 0x3f803f80, v19
    v_dot2c_f32_bf16 v63, v19, v19
    s_waitcnt vmcnt(8)
    v_dot2c_f32_bf16 v60, 0x3f803f80, v20
    v_dot2c_f32_bf16 v62, v20, v20
    v_dot2c_f32_bf16 v61, 0x3f803f80, v21
    v_dot2c_f32_bf16 v63, v21, v21
    v_dot2c_f32_bf16 v60, 0x3f803f80, v22
    v_dot2c_f32_bf16 v62, v22, v22
    v_dot2c_f32_bf16 v61, 0x3f803f80, v23
    v_dot2c_f32_bf16 v63, v23, v23
    s_waitcnt vmcnt(7)
    v_dot2c_f32_bf16 v60, 0x3f803f80, v24
    v_dot2c_f32_bf16 v62, v24, v24
    v_dot2c_f32_bf16 v61, 0x3f803f80, v25
    v_dot2c_f32_bf16 v63, v25, v25
    v_dot2c_f32_bf16 v60, 0x3f803f80, v26
    v_dot2c_f32_bf16 v62, v26, v26
    v_dot2c_f32_bf16 v61, 0x3f803f80, v27
    v_dot2c_f32_bf16 v63, v27, v27
    s_waitcnt vmcnt(6)
    v_dot2c_f32_bf16 v60, 0x3f803f80, v28
    v_dot2c_f32_bf16 v62, v28, v28
    v_dot2c_f32_bf16 v61, 0x3f803f80, v29
    v_dot2c_f32_bf16 v63, v29, v29
    v_dot2c_f32_bf16 v60, 0x3f803f80, v30
    v_dot2c_f32_bf16 v62, v30, v30
    v_dot2c_f32_bf16 v61, 0x3f803f80, v31
    v_dot2c_f32_bf16 v63, v31, v31
    s_waitcnt vmcnt(5)
    v_dot2c_f32_bf16 v60, 0x3f803f80, v32
    v_dot2c_f32_bf16 v62, v32, v32
    v_dot2c_f32_bf16 v61, 0x3f803f80, v33
    v_dot2c_f32_bf16 v63, v33, v33
    v_dot2c_f32_bf16 v60, 0x3f803f80, v34
    v_dot2c_f32_bf16 v62, v34, v34
    v_dot2c_f32_bf16 v61, 0x3f803f80, v35
    v_dot2c_f32_bf16 v63, v35, v35
    s_waitcnt vmcnt(4)
    v_dot2c_f32_bf16 v60, 0x3f803f80, v36
    v_dot2c_f32_bf16 v62, v36, v36
    v_dot2c_f32_bf16 v61, 0x3f803f80, v37
    v_dot2c_f32_bf16 v63, v37, v37
    v_dot2c_f32_bf16 v60, 0x3f803f80, v38
    v_dot2c_f32_bf16 v62, v38, v38
    v_dot2c_f32_bf16 v61, 0x3f803f80, v39
    v_dot2c_f32_bf16 v63, v39, v39
    s_waitcnt vmcnt(3)
    v_dot2c_f32_bf16 v60, 0x3f803f80, v40
    v_dot2c_f32_bf16 v62, v40, v40
    v_dot2c_f32_bf16 v61, 0x3f803f80, v41
    v_dot2c_f32_bf16 v63, v41, v41
    v_dot2c_f32_bf16 v60, 0x3f803f80, v42
    v_dot2c_f32_bf16 v62, v42, v42
    v_dot2c_f32_bf16 v61, 0x3f803f80, v43
    v_dot2c_f32_bf16 v63, v43, v43
    s_waitcnt vmcnt(2)
    v_dot2c_f32_bf16 v60, 0x3f803f80, v44
    v_dot2c_f32_bf16 v62, v44, v44
    v_dot2c_f32_bf16 v61, 0x3f803f80, v45
    v_dot2c_f32_bf16 v63, v45, v45
    v_dot2c_f32_bf16 v60, 0x3f803f80, v46
    v_dot2c_f32_bf16 v62, v46, v46
    v_dot2c_f32_bf16 v61, 0x3f803f80, v47
    v_dot2c_f32_bf16 v63, v47, v47
    s_waitcnt vmcnt(1)
    v_dot2c_f32_bf16 v60, 0x3f803f80, v48
    v_dot2c_f32_bf16 v62, v48, v48
    v_dot2c_f32_bf16 v61, 0x3f803f80, v49
    v_dot2c_f32_bf16 v63, v49, v49
    v_dot2c_f32_bf16 v60, 0x3f803f80, v50
    v_dot2c_f32_bf16 v62, v50, v50
    v_dot2c_f32_bf16 v61, 0x3f803f80, v51
    v_dot2c_f32_bf16 v63, v51, v51
    s_waitcnt vmcnt(0)
    v_dot2c_f32_bf16 v60, 0x3f803f80, v52
    v_dot2c_f32_bf16 v62, v52, v52
    v_dot2c_f32_bf16 v61, 0x3f803f80, v53
    v_dot2c_f32_bf16 v63, v53, v53
    v_dot2c_f32_bf16 v60, 0x3f803f80, v54
    v_dot2c_f32_bf16 v62, v54, v54
    v_dot2c_f32_bf16 v61, 0x3f803f80, v55
    v_dot2c_f32_bf16 v63, v55, v55
    s_nop 1
    v_add_f32 v60, v60, v61
    v_add_f32 v62, v62, v63
    s_nop 0
    v_add_f32_dpp v60, v60, v60 quad_perm:[1,0,3,2] row_mask:0xf bank_mask:0xf
    v_add_f32_dpp v62, v62, v62 quad_perm:[1,0,3,2] row_mask:0xf bank_mask:0xf
    s_nop 0
    v_add_f32_dpp v60, v60, v60 quad_perm:[2,3,0,1] row_mask:0xf bank_mask:0xf
    v_add_f32_dpp v62, v62, v62 quad_perm:[2,3,0,1] row_mask:0xf bank_mask:0xf
    s_nop 0
    v_add_f32_dpp v60, v60, v60 row_half_mirror row_mask:0xf bank_mask:0xf
    v_add_f32_dpp v62, v62, v62 row_half_mirror row_mask:0xf bank_mask:0xf
    v_mul_f32 v64, 0x3acccccd, v60
    v_mul_f32 v65, 0x3acccccd, v62
    v_fma_f32 v65, -v64, v64, v65
    v_max_f32 v65, 0, v65
    v_cvt_pk_bf16_f32 v64, v64, v65
    v_and_b32 v65, 0xffff0000, v64
    v_add_f32 v65, 0x3727c5ac, v65
    v_cvt_pk_bf16_f32 v65, v65, v65
    v_lshlrev_b32 v65, 16, v65
    v_sqrt_f32 v65, v65
    s_nop 0
    v_cvt_pk_bf16_f32 v65, v65, v65
    s_mov_b32 s57, 0xffff
    v_bfi_b32 v64, s57, v64, v65
    v_mov_b32 v65, s48
    buffer_store_dwordx2 v[64:65], v66, s[4:7], s56 offen sc1
    s_barrier
    s_and_b32 s31, s29, 60
    s_cmp_eq_u32 s31, 36
    s_cbranch_scc1 L_pkdone
    s_cmp_ge_u32 s29, 40
    s_cselect_b32 s31, 20, 16
    s_sub_u32 s31, s29, s31
    s_mov_b32 s44, s54
    s_and_b32 s45, s55, 0xffff
    s_mov_b32 s46, 0x21c000
    s_mov_b32 s47, 0x20000
    s_mul_i32 s33, s30, 7
    s_lshr_b32 s32, s31, 2
    s_add_u32 s59, s33, s32
    s_and_b32 s18, s31, 3
    s_mul_i32 s32, s59, 4682
    s_lshr_b32 s32, s32, 16
    s_mul_i32 s33, s32, 14
    s_sub_u32 s33, s59, s33
    s_lshr_b32 s34, s33, 1
    s_mul_i32 s34, s34, 108
    s_bitcmp1_b32 s33, 0
    s_mov_b32 s35, 96
    s_cselect_b32 s35, 16, s35
    s_cselect_b32 s36, 32, 0
    s_add_u32 s35, s35, s34
    s_add_u32 s36, s36, s34
    s_mul_i32 s34, s33, 108
    s_add_u32 s37, s34, -816
    s_add_u32 s38, s34, -800
    s_cmp_lt_u32 s33, 8
    s_cselect_b32 s35, s35, s37
    s_cselect_b32 s36, s36, s38
    s_lshl_b32 s34, s34, 1
    s_add_u32 s37, s34, -2512
    s_add_u32 s38, s34, -2404
    s_cmp_lt_u32 s33, 12
    s_cselect_b32 s35, s35, s37
    s_cselect_b32 s36, s36, s38
    s_mul_i32 s34, s32, 432
    s_mul_i32 s37, s18, 320
    s_add_u32 s35, s35, s34
    s_mul_i32 s35, s35, 1280
    s_add_u32 s35, s35, s37
    s_add_u32 s36, s36, s34
    s_mul_i32 s36, s36, 1280
    s_add_u32 s36, s36, s37
    s_mul_i32 s38, s3, 20480
    v_add_u32 v100, 0, v0
    v_mul_u32_u24 v101, 3277, v100
    v_lshrrev_b32 v101, 16, v101
    v_mul_u32_u24 v102, 20, v101
    v_sub_u32 v100, v100, v102
    v_mul_u32_u24 v101, 1280, v101
    v_lshl_add_u32 v124, v100, 4, v101
    s_add_u32 m0, s38, 0
    s_nop 0
    buffer_load_dwordx4 v124, s[44:47], s35 offen lds
    s_add_u32 m0, s38, 5120
    s_nop 0
    buffer_load_dwordx4 v124, s[44:47], s36 offen lds
    v_add_u32 v100, 64, v0
    v_mul_u32_u24 v101, 3277, v100
    v_lshrrev_b32 v101, 16, v101
    v_mul_u32_u24 v102, 20, v101
    v_sub_u32 v100, v100, v102
    v_mul_u32_u24 v101, 1280, v101
    v_lshl_add_u32 v125, v100, 4, v101
    s_add_u32 m0, s38, 1024
    s_nop 0
    buffer_load_dwordx4 v125, s[44:47], s35 offen lds
    s_add_u32 m0, s38, 6144
    s_nop 0
    buffer_load_dwordx4 v125, s[44:47], s36 offen lds
    v_add_u32 v100, 128, v0
    v_mul_u32_u24 v101, 3277, v100
    v_lshrrev_b32 v101, 16, v101
    v_mul_u32_u24 v102, 20, v101
    v_sub_u32 v100, v100, v102
    v_mul_u32_u24 v101, 1280, v101
    v_lshl_add_u32 v126, v100, 4, v101
    s_add_u32 m0, s38, 2048
    s_nop 0
    buffer_load_dwordx4 v126, s[44:47], s35 offen lds
    s_add_u32 m0, s38, 7168
    s_nop 0
    buffer_load_dwordx4 v126, s[44:47], s36 offen lds
    v_add_u32 v100, 192, v0
    v_mul_u32_u24 v101, 3277, v100
    v_lshrrev_b32 v101, 16, v101
    v_mul_u32_u24 v102, 20, v101
    v_sub_u32 v100, v100, v102
    v_mul_u32_u24 v101, 1280, v101
    v_lshl_add_u32 v127, v100, 4, v101
    s_add_u32 m0, s38, 3072
    s_nop 0
    buffer_load_dwordx4 v127, s[44:47], s35 offen lds
    s_add_u32 m0, s38, 8192
    s_nop 0
    buffer_load_dwordx4 v127, s[44:47], s36 offen lds
    v_add_u32 v100, 256, v0
    v_mul_u32_u24 v101, 3277, v100
    v_lshrrev_b32 v101, 16, v101
    v_mul_u32_u24 v102, 20, v101
    v_sub_u32 v100, v100, v102
    v_mul_u32_u24 v101, 1280, v101
    v_lshl_add_u32 v128, v100, 4, v101
    s_add_u32 m0, s38, 4096
    s_nop 0
    buffer_load_dwordx4 v128, s[44:47], s35 offen lds
    s_add_u32 m0, s38, 9216
    s_nop 0
    buffer_load_dwordx4 v128, s[44:47], s36 offen lds
    v_lshrrev_b32 v100, 4, v0
    v_bfe_u32 v101, v0, 2, 2
    v_lshl_add_u32 v101, v100, 2, v101
    v_mul_u32_u24 v101, 320, v101
    v_and_b32 v102, 3, v0
    v_lshl_add_u32 v101, v102, 3, v101
    v_add_u32 v98, s38, v101
    s_and_b32 s34, s33, 9
    s_cmp_eq_u32 s34, 0
    s_cselect_b32 s34, 3, 63
    v_cmp_eq_u32 vcc, s34, v100
    s_cmp_lt_u32 s33, 12
    s_cselect_b32 s37, 0, 0
    s_lshl_b32 s34, s18, 1
    s_add_u32 s34, s34, 0
    s_and_b32 s35, s34, s37
    s_xor_b32 s35, s35, s33
    s_lshl_b32 s34, s34, 2
    s_add_u32 s34, s34, s32
    s_mul_i32 s34, s34, 14
    s_add_u32 s34, s34, s35
    s_mul_i32 s41, s34, 5120
    s_add_u32 s41, s41, 7573504
    s_lshl_b32 s34, s18, 1
    s_add_u32 s34, s34, 1
    s_and_b32 s35, s34, s37
    s_xor_b32 s35, s35, s33
    s_lshl_b32 s34, s34, 2
    s_add_u32 s34, s34, s32
    s_mul_i32 s34, s34, 14
    s_add_u32 s34, s34, s35
    s_mul_i32 s42, s34, 5120
    s_add_u32 s42, s42, 7573504
    s_mul_i32 s43, s18, 56
    s_add_u32 s43, s43, s59
    s_lshl_b32 s43, s43, 7
    s_add_u32 s43, s43, 17256448
    s_waitcnt vmcnt(0)
    ds_read_b64_tr_b16 v[16:17], v98 offset:0
    ds_read_b64_tr_b16 v[18:19], v98 offset:5120
    ds_read_b64_tr_b16 v[20:21], v98 offset:32
    ds_read_b64_tr_b16 v[22:23], v98 offset:5152
    ds_read_b64_tr_b16 v[24:25], v98 offset:64
    ds_read_b64_tr_b16 v[26:27], v98 offset:5184
    ds_read_b64_tr_b16 v[28:29], v98 offset:96
    ds_read_b64_tr_b16 v[30:31], v98 offset:5216
    ds_read_b64_tr_b16 v[32:33], v98 offset:128
    ds_read_b64_tr_b16 v[34:35], v98 offset:5248
    s_waitcnt lgkmcnt(8)
    v_cndmask_b32 v16, v16, 0, vcc
    v_cndmask_b32 v17, v17, 0, vcc
    buffer_store_dwordx4 v[16:19], v15, s[4:7], s41 offen offset:0 sc1
    s_waitcnt lgkmcnt(6)
    v_cndmask_b32 v20, v20, 0, vcc
    v_cndmask_b32 v21, v21, 0, vcc
    buffer_store_dwordx4 v[20:23], v15, s[4:7], s41 offen offset:1024 sc1
    s_waitcnt lgkmcnt(4)
    v_cndmask_b32 v24, v24, 0, vcc
    v_cndmask_b32 v25, v25, 0, vcc
    buffer_store_dwordx4 v[24:27], v15, s[4:7], s41 offen offset:2048 sc1
    s_waitcnt lgkmcnt(2)
    v_cndmask_b32 v28, v28, 0, vcc
    v_cndmask_b32 v29, v29, 0, vcc
    buffer_store_dwordx4 v[28:31], v15, s[4:7], s41 offen offset:3072 sc1
    s_waitcnt lgkmcnt(0)
    v_cndmask_b32 v32, v32, 0, vcc
    v_cndmask_b32 v33, v33, 0, vcc
    s_add_u32 s41, s41, 4096
    buffer_store_dwordx4 v[32:35], v15, s[4:7], s41 offen offset:0 sc1
    ds_read_b64_tr_b16 v[36:37], v98 offset:160
    ds_read_b64_tr_b16 v[38:39], v98 offset:5280
    ds_read_b64_tr_b16 v[40:41], v98 offset:192
    ds_read_b64_tr_b16 v[42:43], v98 offset:5312
    ds_read_b64_tr_b16 v[44:45], v98 offset:224
    ds_read_b64_tr_b16 v[46:47], v98 offset:5344
    ds_read_b64_tr_b16 v[48:49], v98 offset:256
    ds_read_b64_tr_b16 v[50:51], v98 offset:5376
    ds_read_b64_tr_b16 v[52:53], v98 offset:288
    ds_read_b64_tr_b16 v[54:55], v98 offset:5408
    s_waitcnt lgkmcnt(8)
    v_cndmask_b32 v36, v36, 0, vcc
    v_cndmask_b32 v37, v37, 0, vcc
    buffer_store_dwordx4 v[36:39], v15, s[4:7], s42 offen offset:0 sc1
    s_waitcnt lgkmcnt(6)
    v_cndmask_b32 v40, v40, 0, vcc
    v_cndmask_b32 v41, v41, 0, vcc
    buffer_store_dwordx4 v[40:43], v15, s[4:7], s42 offen offset:1024 sc1
    s_waitcnt lgkmcnt(4)
    v_cndmask_b32 v44, v44, 0, vcc
    v_cndmask_b32 v45, v45, 0, vcc
    buffer_store_dwordx4 v[44:47], v15, s[4:7], s42 offen offset:2048 sc1
    s_waitcnt lgkmcnt(2)
    v_cndmask_b32 v48, v48, 0, vcc
    v_cndmask_b32 v49, v49, 0, vcc
    buffer_store_dwordx4 v[48:51], v15, s[4:7], s42 offen offset:3072 sc1
    s_waitcnt lgkmcnt(0)
    v_cndmask_b32 v52, v52, 0, vcc
    v_cndmask_b32 v53, v53, 0, vcc
    s_add_u32 s42, s42, 4096
    buffer_store_dwordx4 v[52:55], v15, s[4:7], s42 offen offset:0 sc1
    v_mov_b32 v252, s48
    v_mov_b32 v253, s49
    v_lshlrev_b32 v254, 3, v0
    s_waitcnt vmcnt(0)
    s_mov_b64 exec, 0xffff
    buffer_store_dwordx2 v[252:253], v254, s[4:7], s43 offen offset:0 sc1
    s_mov_b64 exec, -1
    s_branch L_pkdone
L_pk1:
    s_waitcnt lgkmcnt(0)
    s_and_b32 s41, s29, 1
    s_and_b32 s42, s30, 3
    s_lshr_b32 s43, s30, 2
    s_lshl_b32 s43, s43, 3
    s_lshr_b32 s44, s29, 1
    s_add_u32 s43, s43, s44
    v_mul_u32_u24 v9, 3456, v1
    v_lshl_add_u32 v9, v2, 4, v9
    s_mul_i32 s56, s42, 552960
    s_mul_i32 s57, s43, 216
    s_add_u32 s56, s56, s57
    s_lshl_b32 s57, s41, 7
    s_add_u32 s56, s56, s57
    s_mul_i32 s40, s3, 20480
    s_mov_b32 s8, s52
    s_and_b32 s9, s53, 0xffff
    s_mov_b32 s10, 0x21c000
    s_mov_b32 s11, 0x20000
    s_mov_b32 s44, s54
    s_and_b32 s45, s55, 0xffff
    s_mov_b32 s46, 0x21c000
    s_mov_b32 s47, 0x20000
    v_min_u32 v10, 44, v0
    v_lshlrev_b32 v10, 7, v10
    s_mul_i32 s57, s30, 276480
    s_mul_i32 s59, s29, 17280
    s_add_u32 s57, s57, s59
    s_barrier
    buffer_load_dword v11, v10, s[44:47], s57 offen
    s_add_u32 s57, s57, 5760
    buffer_load_dword v11, v10, s[44:47], s57 offen
    s_add_u32 s57, s57, 5760
    buffer_load_dword v11, v10, s[44:47], s57 offen
    s_barrier
    s_add_u32 m0, s40, 0
    s_nop 0
    buffer_load_dwordx4 v9, s[8:11], s56 offen lds
    s_add_u32 s56, s56, 27648
    s_add_u32 m0, s40, 1024
    s_nop 0
    buffer_load_dwordx4 v9, s[8:11], s56 offen lds
    s_add_u32 s56, s56, 27648
    s_add_u32 m0, s40, 2048
    s_nop 0
    buffer_load_dwordx4 v9, s[8:11], s56 offen lds
    s_add_u32 s56, s56, 27648
    s_add_u32 m0, s40, 3072
    s_nop 0
    buffer_load_dwordx4 v9, s[8:11], s56 offen lds
    s_add_u32 s56, s56, 27648
    s_add_u32 m0, s40, 4096
    s_nop 0
    buffer_load_dwordx4 v9, s[8:11], s56 offen lds
    s_add_u32 s56, s56, 27648
    s_add_u32 m0, s40, 5120
    s_nop 0
    buffer_load_dwordx4 v9, s[8:11], s56 offen lds
    s_add_u32 s56, s56, 27648
    s_add_u32 m0, s40, 6144
    s_nop 0
    buffer_load_dwordx4 v9, s[8:11], s56 offen lds
    s_add_u32 s56, s56, 27648
    s_add_u32 m0, s40, 7168
    s_nop 0
    buffer_load_dwordx4 v9, s[8:11], s56 offen lds
    s_add_u32 s56, s56, 27648
    s_add_u32 m0, s40, 8192
    s_nop 0
    buffer_load_dwordx4 v9, s[8:11], s56 offen lds
    s_add_u32 s56, s56, 27648
    s_add_u32 m0, s40, 9216
    s_nop 0
    buffer_load_dwordx4 v9, s[8:11], s56 offen lds
    s_add_u32 s56, s56, 27648
    s_add_u32 m0, s40, 10240
    s_nop 0
    buffer_load_dwordx4 v9, s[8:11], s56 offen lds
    s_add_u32 s56, s56, 27648
    s_add_u32 m0, s40, 11264
    s_nop 0
    buffer_load_dwordx4 v9, s[8:11], s56 offen lds
    s_add_u32 s56, s56, 27648
    s_add_u32 m0, s40, 12288
    s_nop 0
    buffer_load_dwordx4 v9, s[8:11], s56 offen lds
    s_add_u32 s56, s56, 27648
    s_add_u32 m0, s40, 13312
    s_nop 0
    buffer_load_dwordx4 v9, s[8:11], s56 offen lds
    s_add_u32 s56, s56, 27648
    s_add_u32 m0, s40, 14336
    s_nop 0
    buffer_load_dwordx4 v9, s[8:11], s56 offen lds
    s_add_u32 s56, s56, 27648
    s_add_u32 m0, s40, 15360
    s_nop 0
    buffer_load_dwordx4 v9, s[8:11], s56 offen lds
    s_add_u32 s56, s56, 27648
    s_add_u32 m0, s40, 16384
    s_nop 0
    buffer_load_dwordx4 v9, s[8:11], s56 offen lds
    s_add_u32 s56, s56, 27648
    s_add_u32 m0, s40, 17408
    s_nop 0
    buffer_load_dwordx4 v9, s[8:11], s56 offen lds
    s_add_u32 s56, s56, 27648
    s_add_u32 m0, s40, 18432
    s_nop 0
    buffer_load_dwordx4 v9, s[8:11], s56 offen lds
    s_add_u32 s56, s56, 27648
    s_add_u32 m0, s40, 19456
    s_nop 0
    buffer_load_dwordx4 v9, s[8:11], s56 offen lds
    s_load_dword s48, s[14:15], 0
    s_mov_b32 s4, s14
    s_and_b32 s5, s15, 0xffff
    s_mov_b32 s6, 0x10000000
    s_mov_b32 s7, 0x20000
    v_lshrrev_b32 v6, 4, v0
    v_and_b32 v7, 15, v0
    v_bfe_u32 v4, v0, 2, 2
    v_and_b32 v5, 3, v0
    v_lshlrev_b32 v8, 10, v6
    v_lshl_add_u32 v8, v4, 7, v8
    v_lshl_add_u32 v8, v5, 3, v8
    v_add_u32 v8, s40, v8
    v_lshlrev_b32 v12, 2, v0
    s_lshl_b32 s39, s42, 13
    s_lshl_b32 s38, s43, 9
    s_add_u32 s39, s39, s38
    s_lshl_b32 s38, s41, 8
    s_add_u32 s39, s39, s38
    s_add_u32 s39, s39, 9867264
    s_mul_i32 s46, s43, 143360
    s_add_u32 s46, s46, 5279744
    s_mov_b32 s44, s46
    s_add_u32 s45, s46, 81920
    s_mul_i32 s37, s42, 5
    s_and_b32 s36, s43, 0
    s_add_u32 s56, s44, 1024
    s_add_u32 s57, s45, 1024
    s_cmp_eq_u32 s41, 0
    s_cselect_b32 s50, s56, s57
    s_mov_b32 s62, 3072
    s_cselect_b32 s62, 4096, s62
    s_add_u32 s56, s44, 2048
    s_add_u32 s57, s45, 2048
    s_cmp_eq_u32 s41, 0
    s_cselect_b32 s51, s56, s57
    s_mov_b32 s63, 3072
    s_cselect_b32 s63, 4096, s63
    s_add_u32 s56, s44, 3072
    s_add_u32 s57, s44, 0
    s_cmp_eq_u32 s41, 0
    s_cselect_b32 s52, s56, s57
    s_mov_b32 s64, 4096
    s_cselect_b32 s64, 4096, s64
    s_add_u32 s56, s45, 0
    s_mov_b32 s57, 0x70000000
    s_cmp_eq_u32 s41, 0
    s_cselect_b32 s53, s56, s57
    s_mov_b32 s65, 0
    s_cselect_b32 s65, 3072, s65
    s_cselect_b32 s47, 64, 12
    v_cmp_eq_u32 vcc, 12, v7
    v_mov_b32 v9, 0x3f803f80
    s_nop 0
    v_cndmask_b32 v9, 0, v9, vcc
    v_cmp_le_u32 vcc, s47, v7
    v_mov_b32 v100, 0
    v_mov_b32 v101, 0
    v_mov_b32 v102, 0
    v_mov_b32 v103, 0
    s_waitcnt lgkmcnt(0)
    s_mul_i32 s49, s48, 0x9e3779b1
    s_add_u32 s48, s48, 1
    s_xor_b32 s49, s49, 0x5bd1e995
    s_waitcnt vmcnt(16)
    ds_read_b64_tr_b16 v[16:17], v8 offset:0
    ds_read_b64_tr_b16 v[18:19], v8 offset:512
    ds_read_b64_tr_b16 v[20:21], v8 offset:32
    ds_read_b64_tr_b16 v[22:23], v8 offset:544
    ds_read_b64_tr_b16 v[24:25], v8 offset:64
    ds_read_b64_tr_b16 v[26:27], v8 offset:576
    ds_read_b64_tr_b16 v[28:29], v8 offset:96
    ds_read_b64_tr_b16 v[30:31], v8 offset:608
    s_waitcnt lgkmcnt(6)
    s_add_u32 s35, s37, 0
    s_xor_b32 s35, s35, s36
    s_mul_i32 s34, s35, s62
    s_add_u32 s34, s34, s50
    buffer_store_dwordx4 v[16:19], v15, s[4:7], s34 offen sc1
    s_waitcnt lgkmcnt(4)
    s_mul_i32 s34, s35, s63
    s_add_u32 s34, s34, s51
    buffer_store_dwordx4 v[20:23], v15, s[4:7], s34 offen sc1
    s_waitcnt lgkmcnt(2)
    v_cndmask_b32 v24, v24, v9, vcc
    v_cndmask_b32 v25, v25, v9, vcc
    v_cndmask_b32 v26, v26, v9, vcc
    v_cndmask_b32 v27, v27, v9, vcc
    s_mul_i32 s34, s35, s64
    s_add_u32 s34, s34, s52
    buffer_store_dwordx4 v[24:27], v15, s[4:7], s34 offen sc1
    s_waitcnt lgkmcnt(0)
    s_mul_i32 s34, s35, s65
    s_add_u32 s34, s34, s53
    buffer_store_dwordx4 v[28:31], v15, s[4:7], s34 offen sc1
    v_dot2c_f32_bf16 v100, 0x3f803f80, v16
    v_dot2c_f32_bf16 v101, 0x3f803f80, v20
    v_dot2c_f32_bf16 v102, 0x3f803f80, v24
    v_dot2c_f32_bf16 v103, 0x3f803f80, v28
    v_dot2c_f32_bf16 v100, 0x3f803f80, v17
    v_dot2c_f32_bf16 v101, 0x3f803f80, v21
    v_dot2c_f32_bf16 v102, 0x3f803f80, v25
    v_dot2c_f32_bf16 v103, 0x3f803f80, v29
    v_dot2c_f32_bf16 v100, 0x3f803f80, v18
    v_dot2c_f32_bf16 v101, 0x3f803f80, v22
    v_dot2c_f32_bf16 v102, 0x3f803f80, v26
    v_dot2c_f32_bf16 v103, 0x3f803f80, v30
    v_dot2c_f32_bf16 v100, 0x3f803f80, v19
    v_dot2c_f32_bf16 v101, 0x3f803f80, v23
    v_dot2c_f32_bf16 v102, 0x3f803f80, v27
    v_dot2c_f32_bf16 v103, 0x3f803f80, v31
    s_waitcnt vmcnt(16)
    ds_read_b64_tr_b16 v[32:33], v8 offset:4096
    ds_read_b64_tr_b16 v[34:35], v8 offset:4608
    ds_read_b64_tr_b16 v[36:37], v8 offset:4128
    ds_read_b64_tr_b16 v[38:39], v8 offset:4640
    ds_read_b64_tr_b16 v[40:41], v8 offset:4160
    ds_read_b64_tr_b16 v[42:43], v8 offset:4672
    ds_read_b64_tr_b16 v[44:45], v8 offset:4192
    ds_read_b64_tr_b16 v[46:47], v8 offset:4704
    s_waitcnt lgkmcnt(6)
    s_add_u32 s35, s37, 1
    s_xor_b32 s35, s35, s36
    s_mul_i32 s34, s35, s62
    s_add_u32 s34, s34, s50
    buffer_store_dwordx4 v[32:35], v15, s[4:7], s34 offen sc1
    s_waitcnt lgkmcnt(4)
    s_mul_i32 s34, s35, s63
    s_add_u32 s34, s34, s51
    buffer_store_dwordx4 v[36:39], v15, s[4:7], s34 offen sc1
    s_waitcnt lgkmcnt(2)
    v_cndmask_b32 v40, v40, v9, vcc
    v_cndmask_b32 v41, v41, v9, vcc
    v_cndmask_b32 v42, v42, v9, vcc
    v_cndmask_b32 v43, v43, v9, vcc
    s_mul_i32 s34, s35, s64
    s_add_u32 s34, s34, s52
    buffer_store_dwordx4 v[40:43], v15, s[4:7], s34 offen sc1
    s_waitcnt lgkmcnt(0)
    s_mul_i32 s34, s35, s65
    s_add_u32 s34, s34, s53
    buffer_store_dwordx4 v[44:47], v15, s[4:7], s34 offen sc1
    v_dot2c_f32_bf16 v100, 0x3f803f80, v32
    v_dot2c_f32_bf16 v101, 0x3f803f80, v36
    v_dot2c_f32_bf16 v102, 0x3f803f80, v40
    v_dot2c_f32_bf16 v103, 0x3f803f80, v44
    v_dot2c_f32_bf16 v100, 0x3f803f80, v33
    v_dot2c_f32_bf16 v101, 0x3f803f80, v37
    v_dot2c_f32_bf16 v102, 0x3f803f80, v41
    v_dot2c_f32_bf16 v103, 0x3f803f80, v45
    v_dot2c_f32_bf16 v100, 0x3f803f80, v34
    v_dot2c_f32_bf16 v101, 0x3f803f80, v38
    v_dot2c_f32_bf16 v102, 0x3f803f80, v42
    v_dot2c_f32_bf16 v103, 0x3f803f80, v46
    v_dot2c_f32_bf16 v100, 0x3f803f80, v35
    v_dot2c_f32_bf16 v101, 0x3f803f80, v39
    v_dot2c_f32_bf16 v102, 0x3f803f80, v43
    v_dot2c_f32_bf16 v103, 0x3f803f80, v47
    s_waitcnt vmcnt(16)
    ds_read_b64_tr_b16 v[48:49], v8 offset:8192
    ds_read_b64_tr_b16 v[50:51], v8 offset:8704
    ds_read_b64_tr_b16 v[52:53], v8 offset:8224
    ds_read_b64_tr_b16 v[54:55], v8 offset:8736
    ds_read_b64_tr_b16 v[56:57], v8 offset:8256
    ds_read_b64_tr_b16 v[58:59], v8 offset:8768
    ds_read_b64_tr_b16 v[60:61], v8 offset:8288
    ds_read_b64_tr_b16 v[62:63], v8 offset:8800
    s_waitcnt lgkmcnt(6)
    s_add_u32 s35, s37, 2
    s_xor_b32 s35, s35, s36
    s_mul_i32 s34, s35, s62
    s_add_u32 s34, s34, s50
    buffer_store_dwordx4 v[48:51], v15, s[4:7], s34 offen sc1
    s_waitcnt lgkmcnt(4)
    s_mul_i32 s34, s35, s63
    s_add_u32 s34, s34, s51
    buffer_store_dwordx4 v[52:55], v15, s[4:7], s34 offen sc1
    s_waitcnt lgkmcnt(2)
    v_cndmask_b32 v56, v56, v9, vcc
    v_cndmask_b32 v57, v57, v9, vcc
    v_cndmask_b32 v58, v58, v9, vcc
    v_cndmask_b32 v59, v59, v9, vcc
    s_mul_i32 s34, s35, s64
    s_add_u32 s34, s34, s52
    buffer_store_dwordx4 v[56:59], v15, s[4:7], s34 offen sc1
    s_waitcnt lgkmcnt(0)
    s_mul_i32 s34, s35, s65
    s_add_u32 s34, s34, s53
    buffer_store_dwordx4 v[60:63], v15, s[4:7], s34 offen sc1
    v_dot2c_f32_bf16 v100, 0x3f803f80, v48
    v_dot2c_f32_bf16 v101, 0x3f803f80, v52
    v_dot2c_f32_bf16 v102, 0x3f803f80, v56
    v_dot2c_f32_bf16 v103, 0x3f803f80, v60
    v_dot2c_f32_bf16 v100, 0x3f803f80, v49
    v_dot2c_f32_bf16 v101, 0x3f803f80, v53
    v_dot2c_f32_bf16 v102, 0x3f803f80, v57
    v_dot2c_f32_bf16 v103, 0x3f803f80, v61
    v_dot2c_f32_bf16 v100, 0x3f803f80, v50
    v_dot2c_f32_bf16 v101, 0x3f803f80, v54
    v_dot2c_f32_bf16 v102, 0x3f803f80, v58
    v_dot2c_f32_bf16 v103, 0x3f803f80, v62
    v_dot2c_f32_bf16 v100, 0x3f803f80, v51
    v_dot2c_f32_bf16 v101, 0x3f803f80, v55
    v_dot2c_f32_bf16 v102, 0x3f803f80, v59
    v_dot2c_f32_bf16 v103, 0x3f803f80, v63
    s_waitcnt vmcnt(16)
    ds_read_b64_tr_b16 v[64:65], v8 offset:12288
    ds_read_b64_tr_b16 v[66:67], v8 offset:12800
    ds_read_b64_tr_b16 v[68:69], v8 offset:12320
    ds_read_b64_tr_b16 v[70:71], v8 offset:12832
    ds_read_b64_tr_b16 v[72:73], v8 offset:12352
    ds_read_b64_tr_b16 v[74:75], v8 offset:12864
    ds_read_b64_tr_b16 v[76:77], v8 offset:12384
    ds_read_b64_tr_b16 v[78:79], v8 offset:12896
    s_waitcnt lgkmcnt(6)
    s_add_u32 s35, s37, 3
    s_xor_b32 s35, s35, s36
    s_mul_i32 s34, s35, s62
    s_add_u32 s34, s34, s50
    buffer_store_dwordx4 v[64:67], v15, s[4:7], s34 offen sc1
    s_waitcnt lgkmcnt(4)
    s_mul_i32 s34, s35, s63
    s_add_u32 s34, s34, s51
    buffer_store_dwordx4 v[68:71], v15, s[4:7], s34 offen sc1
    s_waitcnt lgkmcnt(2)
    v_cndmask_b32 v72, v72, v9, vcc
    v_cndmask_b32 v73, v73, v9, vcc
    v_cndmask_b32 v74, v74, v9, vcc
    v_cndmask_b32 v75, v75, v9, vcc
    s_mul_i32 s34, s35, s64
    s_add_u32 s34, s34, s52
    buffer_store_dwordx4 v[72:75], v15, s[4:7], s34 offen sc1
    s_waitcnt lgkmcnt(0)
    s_mul_i32 s34, s35, s65
    s_add_u32 s34, s34, s53
    buffer_store_dwordx4 v[76:79], v15, s[4:7], s34 offen sc1
    v_dot2c_f32_bf16 v100, 0x3f803f80, v64
    v_dot2c_f32_bf16 v101, 0x3f803f80, v68
    v_dot2c_f32_bf16 v102, 0x3f803f80, v72
    v_dot2c_f32_bf16 v103, 0x3f803f80, v76
    v_dot2c_f32_bf16 v100, 0x3f803f80, v65
    v_dot2c_f32_bf16 v101, 0x3f803f80, v69
    v_dot2c_f32_bf16 v102, 0x3f803f80, v73
    v_dot2c_f32_bf16 v103, 0x3f803f80, v77
    v_dot2c_f32_bf16 v100, 0x3f803f80, v66
    v_dot2c_f32_bf16 v101, 0x3f803f80, v70
    v_dot2c_f32_bf16 v102, 0x3f803f80, v74
    v_dot2c_f32_bf16 v103, 0x3f803f80, v78
    v_dot2c_f32_bf16 v100, 0x3f803f80, v67
    v_dot2c_f32_bf16 v101, 0x3f803f80, v71
    v_dot2c_f32_bf16 v102, 0x3f803f80, v75
    v_dot2c_f32_bf16 v103, 0x3f803f80, v79
    s_waitcnt vmcnt(16)
    ds_read_b64_tr_b16 v[80:81], v8 offset:16384
    ds_read_b64_tr_b16 v[82:83], v8 offset:16896
    ds_read_b64_tr_b16 v[84:85], v8 offset:16416
    ds_read_b64_tr_b16 v[86:87], v8 offset:16928
    ds_read_b64_tr_b16 v[88:89], v8 offset:16448
    ds_read_b64_tr_b16 v[90:91], v8 offset:16960
    ds_read_b64_tr_b16 v[92:93], v8 offset:16480
    ds_read_b64_tr_b16 v[94:95], v8 offset:16992
    s_waitcnt lgkmcnt(6)
    s_add_u32 s35, s37, 4
    s_xor_b32 s35, s35, s36
    s_mul_i32 s34, s35, s62
    s_add_u32 s34, s34, s50
    buffer_store_dwordx4 v[80:83], v15, s[4:7], s34 offen sc1
    s_waitcnt lgkmcnt(4)
    s_mul_i32 s34, s35, s63
    s_add_u32 s34, s34, s51
    buffer_store_dwordx4 v[84:87], v15, s[4:7], s34 offen sc1
    s_waitcnt lgkmcnt(2)
    v_cndmask_b32 v88, v88, v9, vcc
    v_cndmask_b32 v89, v89, v9, vcc
    v_cndmask_b32 v90, v90, v9, vcc
    v_cndmask_b32 v91, v91, v9, vcc
    s_mul_i32 s34, s35, s64
    s_add_u32 s34, s34, s52
    buffer_store_dwordx4 v[88:91], v15, s[4:7], s34 offen sc1
    s_waitcnt lgkmcnt(0)
    s_mul_i32 s34, s35, s65
    s_add_u32 s34, s34, s53
    buffer_store_dwordx4 v[92:95], v15, s[4:7], s34 offen sc1
    v_dot2c_f32_bf16 v100, 0x3f803f80, v80
    v_dot2c_f32_bf16 v101, 0x3f803f80, v84
    v_dot2c_f32_bf16 v102, 0x3f803f80, v88
    v_dot2c_f32_bf16 v103, 0x3f803f80, v92
    v_dot2c_f32_bf16 v100, 0x3f803f80, v81
    v_dot2c_f32_bf16 v101, 0x3f803f80, v85
    v_dot2c_f32_bf16 v102, 0x3f803f80, v89
    v_dot2c_f32_bf16 v103, 0x3f803f80, v93
    v_dot2c_f32_bf16 v100, 0x3f803f80, v82
    v_dot2c_f32_bf16 v101, 0x3f803f80, v86
    v_dot2c_f32_bf16 v102, 0x3f803f80, v90
    v_dot2c_f32_bf16 v103, 0x3f803f80, v94
    v_dot2c_f32_bf16 v100, 0x3f803f80, v83
    v_dot2c_f32_bf16 v101, 0x3f803f80, v87
    v_dot2c_f32_bf16 v102, 0x3f803f80, v91
    v_dot2c_f32_bf16 v103, 0x3f803f80, v95
    v_mov_b32 v104, v100
    v_mov_b32 v105, v101
    v_mov_b32 v106, v102
    v_mov_b32 v107, v103
    v_permlane16_swap_b32 v100, v104
    v_permlane16_swap_b32 v101, v105
    v_permlane16_swap_b32 v102, v106
    v_permlane16_swap_b32 v103, v107
    v_add_f32 v100, v100, v104
    v_add_f32 v101, v101, v105
    v_add_f32 v102, v102, v106
    v_add_f32 v103, v103, v107
    v_mov_b32 v104, v100
    v_mov_b32 v105, v101
    v_mov_b32 v106, v102
    v_mov_b32 v107, v103
    v_permlane32_swap_b32 v100, v104
    v_permlane32_swap_b32 v101, v105
    v_permlane32_swap_b32 v102, v106
    v_permlane32_swap_b32 v103, v107
    v_add_f32 v100, v100, v104
    v_add_f32 v101, v101, v105
    v_add_f32 v102, v102, v106
    v_add_f32 v103, v103, v107
    v_cmp_eq_u32 vcc, 1, v6
    s_nop 1
    v_cndmask_b32 v100, v100, v101, vcc
    v_cmp_eq_u32 vcc, 2, v6
    s_nop 1
    v_cndmask_b32 v100, v100, v102, vcc
    v_cmp_eq_u32 vcc, 3, v6
    s_nop 1
    v_cndmask_b32 v100, v100, v103, vcc
    buffer_store_dword v100, v12, s[4:7], s39 offen sc1
    s_lshl_b32 s46, s43, 2
    s_add_u32 s46, s46, s42
    s_lshl_b32 s46, s46, 1
    s_add_u32 s46, s46, s41
    s_lshl_b32 s46, s46, 7
    s_add_u32 s46, s46, 17240064
    v_mov_b32 v252, s48
    v_mov_b32 v253, s49
    v_lshlrev_b32 v254, 3, v0
    s_waitcnt vmcnt(0)
    s_mov_b64 exec, 0xffff
    buffer_store_dwordx2 v[252:253], v254, s[4:7], s46 offen offset:0 sc1
    s_mov_b64 exec, -1
L_pkdone:
    v_mov_b32 v252, s48
    v_mov_b32 v253, s49
    v_lshlrev_b32 v254, 3, v0
    s_lshl_b32 s61, s21, 10
    s_add_u32 s61, s61, 17240064
    s_lshr_b32 s60, s23, 1
    s_lshl_b32 s60, s60, 2
    s_add_u32 s60, s60, s3
    s_mul_i32 s60, s60, 1792
    s_add_u32 s60, s60, 17256448
    v_min_u32 v13, 13, v0
    v_lshlrev_b32 v13, 7, v13
    v_and_b32 v1, 7, v0
    v_lshlrev_b32 v1, 7, v1
    s_barrier
    s_mov_b32 s58, 0
L_sp1e:
    buffer_load_dwordx2 v[230:231], v1, s[4:7], s61 offen sc1
    s_add_u32 s58, s58, 1
    s_waitcnt vmcnt(0)
    v_cmp_eq_u64 vcc, s[48:49], v[230:231]
    s_cmp_eq_u64 vcc, exec
    s_cbranch_scc1 L_sp1e_out
    s_sleep 1
    s_cmp_le_u32 s58, 200000
    s_cbranch_scc1 L_sp1e
L_sp1e_out:
    buffer_load_dword v224, v14, s[4:7], s28 offen sc1
    s_add_u32 s28, s28, 8192
    buffer_load_dword v225, v14, s[4:7], s28 offen sc1
    s_add_u32 s28, s28, 8192
    buffer_load_dword v226, v14, s[4:7], s28 offen sc1
    s_add_u32 s28, s28, 8192
    buffer_load_dword v227, v14, s[4:7], s28 offen sc1
    s_mov_b32 m0, s25
    s_nop 0
    buffer_load_dwordx4 v15, s[4:7], s26 offen offset:0 sc1 lds
    buffer_load_dwordx4 v15, s[4:7], s26 offen offset:1024 sc1 lds
    buffer_load_dwordx4 v15, s[4:7], s26 offen offset:2048 sc1 lds
    buffer_load_dwordx4 v15, s[4:7], s26 offen offset:3072 sc1 lds
    s_add_u32 s25, s25, 16384
    s_add_u32 s26, s26, 16384
    s_mov_b32 m0, s25
    s_nop 0
    buffer_load_dwordx4 v15, s[4:7], s26 offen offset:0 sc1 lds
    buffer_load_dwordx4 v15, s[4:7], s26 offen offset:1024 sc1 lds
    buffer_load_dwordx4 v15, s[4:7], s26 offen offset:2048 sc1 lds
    buffer_load_dwordx4 v15, s[4:7], s26 offen offset:3072 sc1 lds
    s_add_u32 s25, s25, 16384
    s_add_u32 s26, s26, 16384
    s_mov_b32 m0, s25
    s_nop 0
    buffer_load_dwordx4 v15, s[4:7], s26 offen offset:0 sc1 lds
    buffer_load_dwordx4 v15, s[4:7], s26 offen offset:1024 sc1 lds
    buffer_load_dwordx4 v15, s[4:7], s26 offen offset:2048 sc1 lds
    buffer_load_dwordx4 v15, s[4:7], s26 offen offset:3072 sc1 lds
    s_add_u32 s25, s25, 16384
    s_add_u32 s26, s26, 16384
    s_mov_b32 m0, s25
    s_nop 0
    buffer_load_dwordx4 v15, s[4:7], s26 offen offset:0 sc1 lds
    buffer_load_dwordx4 v15, s[4:7], s26 offen offset:1024 sc1 lds
    buffer_load_dwordx4 v15, s[4:7], s26 offen offset:2048 sc1 lds
    buffer_load_dwordx4 v15, s[4:7], s26 offen offset:3072 sc1 lds
    s_add_u32 s25, s25, 16384
    s_add_u32 s26, s26, 16384
    s_mov_b32 m0, s25
    s_nop 0
    buffer_load_dwordx4 v15, s[4:7], s26 offen offset:0 sc1 lds
    buffer_load_dwordx4 v15, s[4:7], s26 offen offset:1024 sc1 lds
    buffer_load_dwordx4 v15, s[4:7], s26 offen offset:2048 sc1 lds
    buffer_load_dwordx4 v15, s[4:7], s26 offen offset:3072 sc1 lds
    s_mov_b32 s58, 0
L_sp1c:
    buffer_load_dwordx2 v[228:229], v13, s[4:7], s60 offen sc1
    s_add_u32 s58, s58, 1
    s_waitcnt vmcnt(0)
    v_cmp_eq_u64 vcc, s[48:49], v[228:229]
    s_cmp_eq_u64 vcc, exec
    s_cbranch_scc1 L_sp1c_out
    s_sleep 1
    s_cmp_le_u32 s58, 200000
    s_cbranch_scc1 L_sp1c
L_sp1c_out:
    buffer_load_dwordx4 a[0:3], v15, s[4:7], s27 offen offset:0 sc1
    buffer_load_dwordx4 a[4:7], v15, s[4:7], s27 offen offset:1024 sc1
    buffer_load_dwordx4 a[8:11], v15, s[4:7], s27 offen offset:2048 sc1
    buffer_load_dwordx4 a[12:15], v15, s[4:7], s27 offen offset:3072 sc1
    s_add_u32 s27, s27, 4096
    buffer_load_dwordx4 a[16:19], v15, s[4:7], s27 offen offset:0 sc1
    buffer_load_dwordx4 a[20:23], v15, s[4:7], s27 offen offset:1024 sc1
    buffer_load_dwordx4 a[24:27], v15, s[4:7], s27 offen offset:2048 sc1
    buffer_load_dwordx4 a[28:31], v15, s[4:7], s27 offen offset:3072 sc1
    s_add_u32 s27, s27, 4096
    buffer_load_dwordx4 a[32:35], v15, s[4:7], s27 offen offset:0 sc1
    buffer_load_dwordx4 a[36:39], v15, s[4:7], s27 offen offset:1024 sc1
    buffer_load_dwordx4 a[40:43], v15, s[4:7], s27 offen offset:2048 sc1
    buffer_load_dwordx4 a[44:47], v15, s[4:7], s27 offen offset:3072 sc1
    s_add_u32 s27, s27, 4096
    buffer_load_dwordx4 a[48:51], v15, s[4:7], s27 offen offset:0 sc1
    buffer_load_dwordx4 a[52:55], v15, s[4:7], s27 offen offset:1024 sc1
    buffer_load_dwordx4 a[56:59], v15, s[4:7], s27 offen offset:2048 sc1
    buffer_load_dwordx4 a[60:63], v15, s[4:7], s27 offen offset:3072 sc1
    s_add_u32 s27, s27, 4096
    buffer_load_dwordx4 a[64:67], v15, s[4:7], s27 offen offset:0 sc1
    buffer_load_dwordx4 a[68:71], v15, s[4:7], s27 offen offset:1024 sc1
    buffer_load_dwordx4 a[72:75], v15, s[4:7], s27 offen offset:2048 sc1
    buffer_load_dwordx4 a[76:79], v15, s[4:7], s27 offen offset:3072 sc1
    s_add_u32 s27, s27, 4096
    s_mul_i32 s25, s3, 3072
    s_add_u32 s25, s25, 81920
    s_add_u32 s26, s24, s25
    s_mov_b32 m0, s25
    s_nop 0
    buffer_load_dwordx4 v15, s[4:7], s26 offen offset:0 sc1 lds
    buffer_load_dwordx4 v15, s[4:7], s26 offen offset:1024 sc1 lds
    buffer_load_dwordx4 v15, s[4:7], s26 offen offset:2048 sc1 lds
    s_add_u32 s25, s25, 12288
    s_add_u32 s26, s26, 12288
    s_mov_b32 m0, s25
    s_nop 0
    buffer_load_dwordx4 v15, s[4:7], s26 offen offset:0 sc1 lds
    buffer_load_dwordx4 v15, s[4:7], s26 offen offset:1024 sc1 lds
    buffer_load_dwordx4 v15, s[4:7], s26 offen offset:2048 sc1 lds
    s_add_u32 s25, s25, 12288
    s_add_u32 s26, s26, 12288
    s_mov_b32 m0, s25
    s_nop 0
    buffer_load_dwordx4 v15, s[4:7], s26 offen offset:0 sc1 lds
    buffer_load_dwordx4 v15, s[4:7], s26 offen offset:1024 sc1 lds
    buffer_load_dwordx4 v15, s[4:7], s26 offen offset:2048 sc1 lds
    s_add_u32 s25, s25, 12288
    s_add_u32 s26, s26, 12288
    s_mov_b32 m0, s25
    s_nop 0
    buffer_load_dwordx4 v15, s[4:7], s26 offen offset:0 sc1 lds
    buffer_load_dwordx4 v15, s[4:7], s26 offen offset:1024 sc1 lds
    s_waitcnt vmcnt(24)
    buffer_load_dwordx4 v15, s[4:7], s26 offen offset:2048 sc1 lds
    s_add_u32 s25, s25, 12288
    s_add_u32 s26, s26, 12288
    s_mov_b32 m0, s25
    s_nop 0
    buffer_load_dwordx4 v15, s[4:7], s26 offen offset:0 sc1 lds
    buffer_load_dwordx4 v15, s[4:7], s26 offen offset:1024 sc1 lds
    buffer_load_dwordx4 v15, s[4:7], s26 offen offset:2048 sc1 lds
    buffer_load_dwordx4 a[80:83], v15, s[4:7], s27 offen offset:0 sc1
    buffer_load_dwordx4 a[84:87], v15, s[4:7], s27 offen offset:1024 sc1
    buffer_load_dwordx4 a[88:91], v15, s[4:7], s27 offen offset:2048 sc1
    buffer_load_dwordx4 a[92:95], v15, s[4:7], s27 offen offset:3072 sc1
    s_add_u32 s27, s27, 4096
    buffer_load_dwordx4 a[96:99], v15, s[4:7], s27 offen offset:0 sc1
    buffer_load_dwordx4 a[100:103], v15, s[4:7], s27 offen offset:1024 sc1
    buffer_load_dwordx4 a[104:107], v15, s[4:7], s27 offen offset:2048 sc1
    buffer_load_dwordx4 a[108:111], v15, s[4:7], s27 offen offset:3072 sc1
    s_add_u32 s27, s27, 4096
    buffer_load_dwordx4 a[112:115], v15, s[4:7], s27 offen offset:0 sc1
    buffer_load_dwordx4 a[116:119], v15, s[4:7], s27 offen offset:1024 sc1
    buffer_load_dwordx4 a[120:123], v15, s[4:7], s27 offen offset:2048 sc1
    buffer_load_dwordx4 a[124:127], v15, s[4:7], s27 offen offset:3072 sc1
    s_add_u32 s27, s27, 4096
    buffer_load_dwordx4 a[128:131], v15, s[4:7], s27 offen offset:0 sc1
    buffer_load_dwordx4 a[132:135], v15, s[4:7], s27 offen offset:1024 sc1
    buffer_load_dwordx4 a[136:139], v15, s[4:7], s27 offen offset:2048 sc1
    buffer_load_dwordx4 a[140:143], v15, s[4:7], s27 offen offset:3072 sc1
    s_add_u32 s27, s27, 4096
    buffer_load_dwordx4 a[144:147], v15, s[4:7], s27 offen offset:0 sc1
    buffer_load_dwordx4 a[148:151], v15, s[4:7], s27 offen offset:1024 sc1
    buffer_load_dwordx4 a[152:155], v15, s[4:7], s27 offen offset:2048 sc1
    buffer_load_dwordx4 a[156:159], v15, s[4:7], s27 offen offset:3072 sc1
    s_add_u32 s27, s27, 4096
    buffer_load_dwordx4 a[160:163], v15, s[4:7], s27 offen offset:0 sc1
    buffer_load_dwordx4 a[164:167], v15, s[4:7], s27 offen offset:1024 sc1
    buffer_load_dwordx4 a[168:171], v15, s[4:7], s27 offen offset:2048 sc1
    buffer_load_dwordx4 a[172:175], v15, s[4:7], s27 offen offset:3072 sc1
    s_add_u32 s27, s27, 4096
    buffer_load_dwordx4 a[176:179], v15, s[4:7], s27 offen offset:0 sc1
    buffer_load_dwordx4 a[180:183], v15, s[4:7], s27 offen offset:1024 sc1
    buffer_load_dwordx4 a[184:187], v15, s[4:7], s27 offen offset:2048 sc1
    buffer_load_dwordx4 a[188:191], v15, s[4:7], s27 offen offset:3072 sc1
    s_add_u32 s27, s27, 4096
    s_waitcnt vmcnt(24)
    buffer_load_dwordx4 a[192:195], v15, s[4:7], s27 offen offset:0 sc1
    buffer_load_dwordx4 a[196:199], v15, s[4:7], s27 offen offset:1024 sc1
    buffer_load_dwordx4 a[200:203], v15, s[4:7], s27 offen offset:2048 sc1
    buffer_load_dwordx4 a[204:207], v15, s[4:7], s27 offen offset:3072 sc1
    s_add_u32 s27, s27, 4096
    buffer_load_dwordx4 a[208:211], v15, s[4:7], s27 offen offset:0 sc1
    buffer_load_dwordx4 a[212:215], v15, s[4:7], s27 offen offset:1024 sc1
    buffer_load_dwordx4 a[216:219], v15, s[4:7], s27 offen offset:2048 sc1
    buffer_load_dwordx4 a[220:223], v15, s[4:7], s27 offen offset:3072 sc1
    s_add_u32 s27, s27, 4096
    s_mov_b32 s8, s16
    s_and_b32 s9, s17, 0xffff
    s_mov_b32 s10, 0x280000
    s_mov_b32 s11, 0x20000
    v_min_u32 v1, 39, v0
    v_lshlrev_b32 v1, 10, v1
    s_mul_i32 s18, s3, 40960
    s_cmp_lt_u32 s20, 10
    s_cselect_b32 s19, 0, 2
    s_cselect_b32 s29, 0, 128
    s_add_u32 s19, s19, s20
    s_and_b32 s19, s19, 3
    s_lshl_b32 s19, s19, 8
    s_add_u32 s18, s18, s19
    s_add_u32 s18, s18, s29
    s_add_u32 s18, s18, 17313792
    v_and_b32 v3, 15, v0
    v_lshrrev_b32 v4, 4, v0
    v_mul_u32_u24 v5, 33536, v4
    v_lshl_add_u32 v5, v3, 4, v5
    v_add_u32 v6, 16768, v5
    v_add_u32 v7, 0x10000, v15
    v_add_u32 v8, 0x20000, v15
    s_lshl_b32 s30, s20, 2
    s_add_u32 s30, s30, s3
    s_lshl_b32 s31, s30, 8
    s_add_u32 s46, s31, 36864
    s_and_b32 s47, s21, 0
    s_and_b32 s29, s23, 0
    s_lshl_b32 s29, s29, 12
    s_mul_i32 s31, s47, 134144
    s_add_u32 s31, s31, s46
    s_lshr_b32 s32, s3, 1
    s_lshl_b32 s33, s20, 1
    s_add_u32 s32, s32, s33
    s_mul_i32 s32, s32, 56
    s_lshr_b32 s33, s21, 2
    s_mul_i32 s33, s33, 14
    s_add_u32 s32, s32, s33
    s_lshl_b32 s32, s32, 12
    s_and_b32 s33, s3, 1
    s_lshl_b32 s33, s33, 11
    s_add_u32 s32, s32, s33
    s_add_u32 s32, s32, 9900032
    s_and_b32 s33, s21, 3
    s_lshl_b32 s34, s33, 13
    s_add_u32 s34, s34, s32
    s_add_u32 s38, s34, 4096
    s_add_u32 s35, s33, 8
    s_lshl_b32 s35, s35, 12
    s_add_u32 s35, s35, s32
    s_lshr_b32 s37, s33, 1
    s_add_u32 s37, s37, 12
    s_lshl_b32 s37, s37, 12
    s_add_u32 s37, s37, s32
    s_and_b32 s36, s33, 1
    s_lshl_b32 s36, s36, 9
    s_add_u32 s37, s37, s36
    s_lshl_b32 s36, s20, 4
    s_add_u32 s36, s36, s21
    s_lshl_b32 s36, s36, 2
    s_add_u32 s36, s36, s3
    s_lshl_b32 s36, s36, 8
    s_add_u32 s36, s36, 17477632
    s_lshl_b32 s39, s20, 2
    s_add_u32 s39, s39, s3
    s_lshl_b32 s39, s39, 12
    s_and_b32 s40, s22, 1
    s_lshl_b32 s40, s40, 9
    s_add_u32 s39, s39, s40
    s_add_u32 s39, s39, 17477632
    s_mul_i32 s40, s22, 56
    s_mul_i32 s41, s3, 14
    s_add_u32 s40, s40, s41
    s_lshl_b32 s40, s40, 12
    s_add_u32 s40, s40, 9900032
    s_mov_b32 s45, s40
    s_add_u32 s40, s45, s29
    s_lshl_b32 s41, s22, 2
    s_add_u32 s41, s41, s3
    s_lshr_b32 s42, s41, 1
    s_lshl_b32 s42, s42, 8
    s_and_b32 s43, s41, 1
    s_lshl_b32 s43, s43, 3
    s_add_u32 s42, s42, s43
    s_mul_i32 s43, s23, 335360
    s_add_u32 s42, s42, s43
    s_add_u32 s42, s42, 36864
    s_mul_i32 s44, s41, 20480
    s_mul_i32 s43, s23, 160
    s_add_u32 s44, s44, s43
    v_lshlrev_b32 v10, 4, v4
    v_add_u32 v10, 143360, v10
    v_bfe_u32 v11, v0, 1, 2
    v_lshlrev_b32 v11, 10, v11
    v_and_b32 v12, 1, v0
    v_lshl_add_u32 v11, v12, 8, v11
    s_mov_b32 s58, 0
L_sp2i:
    buffer_load_dwordx2 v[228:229], v1, s[4:7], s18 offen sc1
    s_add_u32 s58, s58, 1
    s_waitcnt vmcnt(0)
    v_cmp_eq_u64 vcc, s[48:49], v[228:229]
    s_cmp_eq_u64 vcc, exec
    s_cbranch_scc1 L_sp2i_out
    s_sleep 1
    s_cmp_le_u32 s58, 200000
    s_cbranch_scc1 L_sp2i
L_sp2i_out:
    v_add_f32 v224, v224, v225
    v_add_f32 v224, v224, v226
    v_add_f32 v224, v224, v227
    v_add_u32 v14, 143360, v14
    ds_write_b32 v14, v224
    s_waitcnt lgkmcnt(0)
    s_barrier
    buffer_load_dwordx4 v[16:19], v5, s[4:7], s31 offen sc1
    buffer_load_dwordx4 v[20:23], v6, s[4:7], s31 offen sc1
    s_add_u32 s31, s31, 134144
    buffer_load_dwordx4 v[24:27], v5, s[4:7], s31 offen sc1
    buffer_load_dwordx4 v[28:31], v6, s[4:7], s31 offen sc1
    s_add_u32 s31, s31, 134144
    buffer_load_dwordx4 v[32:35], v5, s[4:7], s31 offen sc1
    buffer_load_dwordx4 v[36:39], v6, s[4:7], s31 offen sc1
    s_add_u32 s31, s31, 134144
    buffer_load_dwordx4 v[40:43], v5, s[4:7], s31 offen sc1
    buffer_load_dwordx4 v[44:47], v6, s[4:7], s31 offen sc1
    s_add_u32 s31, s31, 134144
    buffer_load_dwordx4 v[48:51], v5, s[4:7], s31 offen sc1
    buffer_load_dwordx4 v[52:55], v6, s[4:7], s31 offen sc1
    s_add_u32 s31, s31, 134144
    buffer_load_dwordx4 v[56:59], v5, s[4:7], s31 offen sc1
    buffer_load_dwordx4 v[60:63], v6, s[4:7], s31 offen sc1
    s_add_u32 s31, s31, 134144
    ds_read_b128 a[224:227], v15 offset:0
    ds_read_b128 a[228:231], v15 offset:1024
    ds_read_b128 a[232:235], v15 offset:2048
    ds_read_b128 a[236:239], v15 offset:3072
    s_lshl_b32 s18, s2, 2
    s_add_u32 s18, s18, s3
    s_cmp_lg_u32 s18, 1020
    s_cbranch_scc1 L_nobump
    s_mov_b64 exec, 1
    buffer_store_dword v252, v254, s[4:7], 0 offen offset:0
    s_mov_b64 exec, -1
L_nobump:
    s_waitcnt vmcnt(10)
    v_swap_b32 v18, v20
    v_swap_b32 v19, v21
    s_nop 1
    v_mfma_f32_16x16x32_bf16 v[232:235], v[16:19], v[16:19], 0
    buffer_load_dwordx4 v[64:67], v5, s[4:7], s31 offen sc1
    v_mfma_f32_16x16x32_bf16 v[236:239], v[20:23], v[20:23], 0
    s_waitcnt lgkmcnt(0)
    v_mfma_f32_16x16x32_bf16 v[176:179], a[224:227], v[16:19], 0
    ds_read_b128 a[240:243], v15 offset:4096
    v_mfma_f32_16x16x32_bf16 v[192:195], a[224:227], v[20:23], 0
    ds_read_b128 a[244:247], v15 offset:5120
    buffer_load_dwordx4 v[68:71], v6, s[4:7], s31 offen sc1
    s_add_u32 s31, s31, 134144
    v_mfma_f32_16x16x32_bf16 v[180:183], a[228:231], v[16:19], 0
    ds_read_b128 a[248:251], v15 offset:6144
    v_mfma_f32_16x16x32_bf16 v[196:199], a[228:231], v[20:23], 0
    ds_read_b128 a[252:255], v15 offset:7168
    v_mfma_f32_16x16x32_bf16 v[184:187], a[232:235], v[16:19], 0
    buffer_load_dwordx4 v[72:75], v5, s[4:7], s31 offen sc1
    v_mfma_f32_16x16x32_bf16 v[200:203], a[232:235], v[20:23], 0
    s_waitcnt vmcnt(11)
    v_swap_b32 v26, v28
    v_swap_b32 v27, v29
    v_mfma_f32_16x16x32_bf16 v[188:191], a[236:239], v[16:19], 0
    v_mfma_f32_16x16x32_bf16 v[204:207], a[236:239], v[20:23], 0
    v_mfma_f32_16x16x32_bf16 v[232:235], v[24:27], v[24:27], v[232:235]
    buffer_load_dwordx4 v[76:79], v6, s[4:7], s31 offen sc1
    s_add_u32 s31, s31, 134144
    v_mfma_f32_16x16x32_bf16 v[236:239], v[28:31], v[28:31], v[236:239]
    s_waitcnt lgkmcnt(0)
    v_mfma_f32_16x16x32_bf16 v[176:179], a[240:243], v[24:27], v[176:179]
    ds_read_b128 a[224:227], v15 offset:8192
    v_mfma_f32_16x16x32_bf16 v[192:195], a[240:243], v[28:31], v[192:195]
    ds_read_b128 a[228:231], v15 offset:9216
    buffer_load_dwordx4 v[80:83], v5, s[4:7], s31 offen sc1
    v_mfma_f32_16x16x32_bf16 v[180:183], a[244:247], v[24:27], v[180:183]
    ds_read_b128 a[232:235], v15 offset:10240
    v_mfma_f32_16x16x32_bf16 v[196:199], a[244:247], v[28:31], v[196:199]
    ds_read_b128 a[236:239], v15 offset:11264
    v_mfma_f32_16x16x32_bf16 v[184:187], a[248:251], v[24:27], v[184:187]
    buffer_load_dwordx4 v[84:87], v6, s[4:7], s31 offen sc1
    s_add_u32 s31, s31, 134144
    v_mfma_f32_16x16x32_bf16 v[200:203], a[248:251], v[28:31], v[200:203]
    s_waitcnt vmcnt(12)
    v_swap_b32 v34, v36
    v_swap_b32 v35, v37
    v_mfma_f32_16x16x32_bf16 v[188:191], a[252:255], v[24:27], v[188:191]
    v_mfma_f32_16x16x32_bf16 v[204:207], a[252:255], v[28:31], v[204:207]
    v_mfma_f32_16x16x32_bf16 v[232:235], v[32:35], v[32:35], v[232:235]
    buffer_load_dwordx4 v[88:91], v5, s[4:7], s31 offen sc1
    v_mfma_f32_16x16x32_bf16 v[236:239], v[36:39], v[36:39], v[236:239]
    s_waitcnt lgkmcnt(0)
    v_mfma_f32_16x16x32_bf16 v[176:179], a[224:227], v[32:35], v[176:179]
    ds_read_b128 a[240:243], v15 offset:12288
    v_mfma_f32_16x16x32_bf16 v[192:195], a[224:227], v[36:39], v[192:195]
    ds_read_b128 a[244:247], v15 offset:13312
    buffer_load_dwordx4 v[92:95], v6, s[4:7], s31 offen sc1
    s_add_u32 s31, s31, 134144
    v_mfma_f32_16x16x32_bf16 v[180:183], a[228:231], v[32:35], v[180:183]
    ds_read_b128 a[248:251], v15 offset:14336
    v_mfma_f32_16x16x32_bf16 v[196:199], a[228:231], v[36:39], v[196:199]
    ds_read_b128 a[252:255], v15 offset:15360
    v_mfma_f32_16x16x32_bf16 v[184:187], a[232:235], v[32:35], v[184:187]
    buffer_load_dwordx4 v[96:99], v5, s[4:7], s31 offen sc1
    v_mfma_f32_16x16x32_bf16 v[200:203], a[232:235], v[36:39], v[200:203]
    s_waitcnt vmcnt(13)
    v_swap_b32 v42, v44
    v_swap_b32 v43, v45
    v_mfma_f32_16x16x32_bf16 v[188:191], a[236:239], v[32:35], v[188:191]
    v_mfma_f32_16x16x32_bf16 v[204:207], a[236:239], v[36:39], v[204:207]
    v_mfma_f32_16x16x32_bf16 v[232:235], v[40:43], v[40:43], v[232:235]
    buffer_load_dwordx4 v[100:103], v6, s[4:7], s31 offen sc1
    s_add_u32 s31, s31, 134144
    v_mfma_f32_16x16x32_bf16 v[236:239], v[44:47], v[44:47], v[236:239]
    s_waitcnt lgkmcnt(0)
    v_mfma_f32_16x16x32_bf16 v[176:179], a[240:243], v[40:43], v[176:179]
    ds_read_b128 a[224:227], v15 offset:16384
    v_mfma_f32_16x16x32_bf16 v[192:195], a[240:243], v[44:47], v[192:195]
    ds_read_b128 a[228:231], v15 offset:17408
    buffer_load_dwordx4 v[104:107], v5, s[4:7], s31 offen sc1
    v_mfma_f32_16x16x32_bf16 v[180:183], a[244:247], v[40:43], v[180:183]
    ds_read_b128 a[232:235], v15 offset:18432
    v_mfma_f32_16x16x32_bf16 v[196:199], a[244:247], v[44:47], v[196:199]
    ds_read_b128 a[236:239], v15 offset:19456
    v_mfma_f32_16x16x32_bf16 v[184:187], a[248:251], v[40:43], v[184:187]
    buffer_load_dwordx4 v[108:111], v6, s[4:7], s31 offen sc1
    s_add_u32 s31, s31, 134144
    v_mfma_f32_16x16x32_bf16 v[200:203], a[248:251], v[44:47], v[200:203]
    s_waitcnt vmcnt(14)
    v_swap_b32 v50, v52
    v_swap_b32 v51, v53
    v_mfma_f32_16x16x32_bf16 v[188:191], a[252:255], v[40:43], v[188:191]
    v_mfma_f32_16x16x32_bf16 v[204:207], a[252:255], v[44:47], v[204:207]
    v_mfma_f32_16x16x32_bf16 v[232:235], v[48:51], v[48:51], v[232:235]
    buffer_load_dwordx4 v[112:115], v5, s[4:7], s31 offen sc1
    v_mfma_f32_16x16x32_bf16 v[236:239], v[52:55], v[52:55], v[236:239]
    s_waitcnt lgkmcnt(0)
    v_mfma_f32_16x16x32_bf16 v[176:179], a[224:227], v[48:51], v[176:179]
    ds_read_b128 a[240:243], v15 offset:20480
    v_mfma_f32_16x16x32_bf16 v[192:195], a[224:227], v[52:55], v[192:195]
    ds_read_b128 a[244:247], v15 offset:21504
    buffer_load_dwordx4 v[116:119], v6, s[4:7], s31 offen sc1
    s_add_u32 s31, s31, 134144
    v_mfma_f32_16x16x32_bf16 v[180:183], a[228:231], v[48:51], v[180:183]
    ds_read_b128 a[248:251], v15 offset:22528
    v_mfma_f32_16x16x32_bf16 v[196:199], a[228:231], v[52:55], v[196:199]
    ds_read_b128 a[252:255], v15 offset:23552
    v_mfma_f32_16x16x32_bf16 v[184:187], a[232:235], v[48:51], v[184:187]
    buffer_load_dwordx4 v[120:123], v5, s[4:7], s31 offen sc1
    v_mfma_f32_16x16x32_bf16 v[200:203], a[232:235], v[52:55], v[200:203]
    s_waitcnt vmcnt(15)
    v_swap_b32 v58, v60
    v_swap_b32 v59, v61
    v_mfma_f32_16x16x32_bf16 v[188:191], a[236:239], v[48:51], v[188:191]
    v_mfma_f32_16x16x32_bf16 v[204:207], a[236:239], v[52:55], v[204:207]
    v_mfma_f32_16x16x32_bf16 v[232:235], v[56:59], v[56:59], v[232:235]
    buffer_load_dwordx4 v[124:127], v6, s[4:7], s31 offen sc1
    s_add_u32 s31, s31, 134144
    v_mfma_f32_16x16x32_bf16 v[236:239], v[60:63], v[60:63], v[236:239]
    s_waitcnt lgkmcnt(0)
    v_mfma_f32_16x16x32_bf16 v[176:179], a[240:243], v[56:59], v[176:179]
    ds_read_b128 a[224:227], v15 offset:24576
    v_mfma_f32_16x16x32_bf16 v[192:195], a[240:243], v[60:63], v[192:195]
    ds_read_b128 a[228:231], v15 offset:25600
    buffer_load_dwordx4 v[128:131], v5, s[4:7], s31 offen sc1
    v_mfma_f32_16x16x32_bf16 v[180:183], a[244:247], v[56:59], v[180:183]
    ds_read_b128 a[232:235], v15 offset:26624
    v_mfma_f32_16x16x32_bf16 v[196:199], a[244:247], v[60:63], v[196:199]
    ds_read_b128 a[236:239], v15 offset:27648
    v_mfma_f32_16x16x32_bf16 v[184:187], a[248:251], v[56:59], v[184:187]
    buffer_load_dwordx4 v[132:135], v6, s[4:7], s31 offen sc1
    s_add_u32 s31, s31, 134144
    v_mfma_f32_16x16x32_bf16 v[200:203], a[248:251], v[60:63], v[200:203]
    s_waitcnt vmcnt(16)
    v_swap_b32 v66, v68
    v_swap_b32 v67, v69
    v_mfma_f32_16x16x32_bf16 v[188:191], a[252:255], v[56:59], v[188:191]
    v_mfma_f32_16x16x32_bf16 v[204:207], a[252:255], v[60:63], v[204:207]
    v_mfma_f32_16x16x32_bf16 v[232:235], v[64:67], v[64:67], v[232:235]
    buffer_load_dwordx4 v[136:139], v5, s[4:7], s31 offen sc1
    v_mfma_f32_16x16x32_bf16 v[236:239], v[68:71], v[68:71], v[236:239]
    s_waitcnt lgkmcnt(0)
    v_mfma_f32_16x16x32_bf16 v[176:179], a[224:227], v[64:67], v[176:179]
    ds_read_b128 a[240:243], v15 offset:28672
    v_mfma_f32_16x16x32_bf16 v[192:195], a[224:227], v[68:71], v[192:195]
    ds_read_b128 a[244:247], v15 offset:29696
    buffer_load_dwordx4 v[140:143], v6, s[4:7], s31 offen sc1
    s_add_u32 s31, s31, 134144
    v_mfma_f32_16x16x32_bf16 v[180:183], a[228:231], v[64:67], v[180:183]
    ds_read_b128 a[248:251], v15 offset:30720
    v_mfma_f32_16x16x32_bf16 v[196:199], a[228:231], v[68:71], v[196:199]
    ds_read_b128 a[252:255], v15 offset:31744
    v_mfma_f32_16x16x32_bf16 v[184:187], a[232:235], v[64:67], v[184:187]
    buffer_load_dwordx4 v[144:147], v5, s[4:7], s31 offen sc1
    v_mfma_f32_16x16x32_bf16 v[200:203], a[232:235], v[68:71], v[200:203]
    s_waitcnt vmcnt(17)
    v_swap_b32 v74, v76
    v_swap_b32 v75, v77
    v_mfma_f32_16x16x32_bf16 v[188:191], a[236:239], v[64:67], v[188:191]
    v_mfma_f32_16x16x32_bf16 v[204:207], a[236:239], v[68:71], v[204:207]
    v_mfma_f32_16x16x32_bf16 v[232:235], v[72:75], v[72:75], v[232:235]
    buffer_load_dwordx4 v[148:151], v6, s[4:7], s31 offen sc1
    s_add_u32 s31, s31, 134144
    v_mfma_f32_16x16x32_bf16 v[236:239], v[76:79], v[76:79], v[236:239]
    s_waitcnt lgkmcnt(0)
    v_mfma_f32_16x16x32_bf16 v[176:179], a[240:243], v[72:75], v[176:179]
    ds_read_b128 a[224:227], v15 offset:32768
    v_mfma_f32_16x16x32_bf16 v[192:195], a[240:243], v[76:79], v[192:195]
    ds_read_b128 a[228:231], v15 offset:33792
    buffer_load_dwordx4 v[152:155], v5, s[4:7], s31 offen sc1
    v_mfma_f32_16x16x32_bf16 v[180:183], a[244:247], v[72:75], v[180:183]
    ds_read_b128 a[232:235], v15 offset:34816
    v_mfma_f32_16x16x32_bf16 v[196:199], a[244:247], v[76:79], v[196:199]
    ds_read_b128 a[236:239], v15 offset:35840
    v_mfma_f32_16x16x32_bf16 v[184:187], a[248:251], v[72:75], v[184:187]
    buffer_load_dwordx4 v[156:159], v6, s[4:7], s31 offen sc1
    s_add_u32 s31, s31, 134144
    v_mfma_f32_16x16x32_bf16 v[200:203], a[248:251], v[76:79], v[200:203]
    s_waitcnt vmcnt(18)
    v_swap_b32 v82, v84
    v_swap_b32 v83, v85
    v_mfma_f32_16x16x32_bf16 v[188:191], a[252:255], v[72:75], v[188:191]
    v_mfma_f32_16x16x32_bf16 v[204:207], a[252:255], v[76:79], v[204:207]
    v_mfma_f32_16x16x32_bf16 v[232:235], v[80:83], v[80:83], v[232:235]
    buffer_load_dwordx4 v[160:163], v5, s[4:7], s31 offen sc1
    v_mfma_f32_16x16x32_bf16 v[236:239], v[84:87], v[84:87], v[236:239]
    s_waitcnt lgkmcnt(0)
    v_mfma_f32_16x16x32_bf16 v[176:179], a[224:227], v[80:83], v[176:179]
    ds_read_b128 a[240:243], v15 offset:36864
    v_mfma_f32_16x16x32_bf16 v[192:195], a[224:227], v[84:87], v[192:195]
    ds_read_b128 a[244:247], v15 offset:37888
    buffer_load_dwordx4 v[164:167], v6, s[4:7], s31 offen sc1
    s_add_u32 s31, s31, 134144
    v_mfma_f32_16x16x32_bf16 v[180:183], a[228:231], v[80:83], v[180:183]
    ds_read_b128 a[248:251], v15 offset:38912
    v_mfma_f32_16x16x32_bf16 v[196:199], a[228:231], v[84:87], v[196:199]
    ds_read_b128 a[252:255], v15 offset:39936
    v_mfma_f32_16x16x32_bf16 v[184:187], a[232:235], v[80:83], v[184:187]
    buffer_load_dwordx4 v[168:171], v5, s[4:7], s31 offen sc1
    v_mfma_f32_16x16x32_bf16 v[200:203], a[232:235], v[84:87], v[200:203]
    s_waitcnt vmcnt(19)
    v_swap_b32 v90, v92
    v_swap_b32 v91, v93
    v_mfma_f32_16x16x32_bf16 v[188:191], a[236:239], v[80:83], v[188:191]
    v_mfma_f32_16x16x32_bf16 v[204:207], a[236:239], v[84:87], v[204:207]
    v_mfma_f32_16x16x32_bf16 v[232:235], v[88:91], v[88:91], v[232:235]
    buffer_load_dwordx4 v[172:175], v6, s[4:7], s31 offen sc1
    v_mfma_f32_16x16x32_bf16 v[236:239], v[92:95], v[92:95], v[236:239]
    s_waitcnt lgkmcnt(0)
    v_mfma_f32_16x16x32_bf16 v[176:179], a[240:243], v[88:91], v[176:179]
    ds_read_b128 a[224:227], v15 offset:40960
    v_mfma_f32_16x16x32_bf16 v[192:195], a[240:243], v[92:95], v[192:195]
    ds_read_b128 a[228:231], v15 offset:41984
    v_mfma_f32_16x16x32_bf16 v[180:183], a[244:247], v[88:91], v[180:183]
    ds_read_b128 a[232:235], v15 offset:43008
    v_mfma_f32_16x16x32_bf16 v[196:199], a[244:247], v[92:95], v[196:199]
    ds_read_b128 a[236:239], v15 offset:44032
    v_mfma_f32_16x16x32_bf16 v[184:187], a[248:251], v[88:91], v[184:187]
    v_mfma_f32_16x16x32_bf16 v[200:203], a[248:251], v[92:95], v[200:203]
    s_waitcnt vmcnt(18)
    v_swap_b32 v98, v100
    v_swap_b32 v99, v101
    v_mfma_f32_16x16x32_bf16 v[188:191], a[252:255], v[88:91], v[188:191]
    v_mfma_f32_16x16x32_bf16 v[204:207], a[252:255], v[92:95], v[204:207]
    v_mfma_f32_16x16x32_bf16 v[232:235], v[96:99], v[96:99], v[232:235]
    v_mfma_f32_16x16x32_bf16 v[236:239], v[100:103], v[100:103], v[236:239]
    s_waitcnt lgkmcnt(0)
    v_mfma_f32_16x16x32_bf16 v[176:179], a[224:227], v[96:99], v[176:179]
    ds_read_b128 a[240:243], v15 offset:45056
    v_mfma_f32_16x16x32_bf16 v[192:195], a[224:227], v[100:103], v[192:195]
    ds_read_b128 a[244:247], v15 offset:46080
    v_mfma_f32_16x16x32_bf16 v[180:183], a[228:231], v[96:99], v[180:183]
    ds_read_b128 a[248:251], v15 offset:47104
    v_mfma_f32_16x16x32_bf16 v[196:199], a[228:231], v[100:103], v[196:199]
    ds_read_b128 a[252:255], v15 offset:48128
    v_mfma_f32_16x16x32_bf16 v[184:187], a[232:235], v[96:99], v[184:187]
    v_mfma_f32_16x16x32_bf16 v[200:203], a[232:235], v[100:103], v[200:203]
    s_waitcnt vmcnt(16)
    v_swap_b32 v106, v108
    v_swap_b32 v107, v109
    v_mfma_f32_16x16x32_bf16 v[188:191], a[236:239], v[96:99], v[188:191]
    v_mfma_f32_16x16x32_bf16 v[204:207], a[236:239], v[100:103], v[204:207]
    v_mfma_f32_16x16x32_bf16 v[232:235], v[104:107], v[104:107], v[232:235]
    v_mfma_f32_16x16x32_bf16 v[236:239], v[108:111], v[108:111], v[236:239]
    s_waitcnt lgkmcnt(0)
    v_mfma_f32_16x16x32_bf16 v[176:179], a[240:243], v[104:107], v[176:179]
    ds_read_b128 a[224:227], v15 offset:49152
    v_mfma_f32_16x16x32_bf16 v[192:195], a[240:243], v[108:111], v[192:195]
    ds_read_b128 a[228:231], v15 offset:50176
    v_mfma_f32_16x16x32_bf16 v[180:183], a[244:247], v[104:107], v[180:183]
    ds_read_b128 a[232:235], v15 offset:51200
    v_mfma_f32_16x16x32_bf16 v[196:199], a[244:247], v[108:111], v[196:199]
    ds_read_b128 a[236:239], v15 offset:52224
    v_mfma_f32_16x16x32_bf16 v[184:187], a[248:251], v[104:107], v[184:187]
    v_mfma_f32_16x16x32_bf16 v[200:203], a[248:251], v[108:111], v[200:203]
    s_waitcnt vmcnt(14)
    v_swap_b32 v114, v116
    v_swap_b32 v115, v117
    v_mfma_f32_16x16x32_bf16 v[188:191], a[252:255], v[104:107], v[188:191]
    v_mfma_f32_16x16x32_bf16 v[204:207], a[252:255], v[108:111], v[204:207]
    v_mfma_f32_16x16x32_bf16 v[232:235], v[112:115], v[112:115], v[232:235]
    v_mfma_f32_16x16x32_bf16 v[236:239], v[116:119], v[116:119], v[236:239]
    s_waitcnt lgkmcnt(0)
    v_mfma_f32_16x16x32_bf16 v[176:179], a[224:227], v[112:115], v[176:179]
    ds_read_b128 a[240:243], v15 offset:53248
    v_mfma_f32_16x16x32_bf16 v[192:195], a[224:227], v[116:119], v[192:195]
    ds_read_b128 a[244:247], v15 offset:54272
    v_mfma_f32_16x16x32_bf16 v[180:183], a[228:231], v[112:115], v[180:183]
    ds_read_b128 a[248:251], v15 offset:55296
    v_mfma_f32_16x16x32_bf16 v[196:199], a[228:231], v[116:119], v[196:199]
    ds_read_b128 a[252:255], v15 offset:56320
    v_mfma_f32_16x16x32_bf16 v[184:187], a[232:235], v[112:115], v[184:187]
    v_mfma_f32_16x16x32_bf16 v[200:203], a[232:235], v[116:119], v[200:203]
    s_waitcnt vmcnt(12)
    v_swap_b32 v122, v124
    v_swap_b32 v123, v125
    v_mfma_f32_16x16x32_bf16 v[188:191], a[236:239], v[112:115], v[188:191]
    v_mfma_f32_16x16x32_bf16 v[204:207], a[236:239], v[116:119], v[204:207]
    v_mfma_f32_16x16x32_bf16 v[232:235], v[120:123], v[120:123], v[232:235]
    v_mfma_f32_16x16x32_bf16 v[236:239], v[124:127], v[124:127], v[236:239]
    s_waitcnt lgkmcnt(0)
    v_mfma_f32_16x16x32_bf16 v[176:179], a[240:243], v[120:123], v[176:179]
    ds_read_b128 a[224:227], v15 offset:57344
    v_mfma_f32_16x16x32_bf16 v[192:195], a[240:243], v[124:127], v[192:195]
    ds_read_b128 a[228:231], v15 offset:58368
    v_mfma_f32_16x16x32_bf16 v[180:183], a[244:247], v[120:123], v[180:183]
    ds_read_b128 a[232:235], v15 offset:59392
    v_mfma_f32_16x16x32_bf16 v[196:199], a[244:247], v[124:127], v[196:199]
    ds_read_b128 a[236:239], v15 offset:60416
    v_mfma_f32_16x16x32_bf16 v[184:187], a[248:251], v[120:123], v[184:187]
    v_mfma_f32_16x16x32_bf16 v[200:203], a[248:251], v[124:127], v[200:203]
    s_waitcnt vmcnt(10)
    v_swap_b32 v130, v132
    v_swap_b32 v131, v133
    v_mfma_f32_16x16x32_bf16 v[188:191], a[252:255], v[120:123], v[188:191]
    v_mfma_f32_16x16x32_bf16 v[204:207], a[252:255], v[124:127], v[204:207]
    v_mfma_f32_16x16x32_bf16 v[232:235], v[128:131], v[128:131], v[232:235]
    v_mfma_f32_16x16x32_bf16 v[236:239], v[132:135], v[132:135], v[236:239]
    s_waitcnt lgkmcnt(0)
    v_mfma_f32_16x16x32_bf16 v[176:179], a[224:227], v[128:131], v[176:179]
    ds_read_b128 a[240:243], v15 offset:61440
    v_mfma_f32_16x16x32_bf16 v[192:195], a[224:227], v[132:135], v[192:195]
    ds_read_b128 a[244:247], v15 offset:62464
    v_mfma_f32_16x16x32_bf16 v[180:183], a[228:231], v[128:131], v[180:183]
    ds_read_b128 a[248:251], v15 offset:63488
    v_mfma_f32_16x16x32_bf16 v[196:199], a[228:231], v[132:135], v[196:199]
    ds_read_b128 a[252:255], v15 offset:64512
    v_mfma_f32_16x16x32_bf16 v[184:187], a[232:235], v[128:131], v[184:187]
    v_mfma_f32_16x16x32_bf16 v[200:203], a[232:235], v[132:135], v[200:203]
    s_waitcnt vmcnt(8)
    v_swap_b32 v138, v140
    v_swap_b32 v139, v141
    v_mfma_f32_16x16x32_bf16 v[188:191], a[236:239], v[128:131], v[188:191]
    v_mfma_f32_16x16x32_bf16 v[204:207], a[236:239], v[132:135], v[204:207]
    v_mfma_f32_16x16x32_bf16 v[232:235], v[136:139], v[136:139], v[232:235]
    v_mfma_f32_16x16x32_bf16 v[236:239], v[140:143], v[140:143], v[236:239]
    s_waitcnt lgkmcnt(0)
    v_mfma_f32_16x16x32_bf16 v[176:179], a[240:243], v[136:139], v[176:179]
    ds_read_b128 a[224:227], v7 offset:0
    v_mfma_f32_16x16x32_bf16 v[192:195], a[240:243], v[140:143], v[192:195]
    ds_read_b128 a[228:231], v7 offset:1024
    v_mfma_f32_16x16x32_bf16 v[180:183], a[244:247], v[136:139], v[180:183]
    ds_read_b128 a[232:235], v7 offset:2048
    v_mfma_f32_16x16x32_bf16 v[196:199], a[244:247], v[140:143], v[196:199]
    ds_read_b128 a[236:239], v7 offset:3072
    v_mfma_f32_16x16x32_bf16 v[184:187], a[248:251], v[136:139], v[184:187]
    v_mfma_f32_16x16x32_bf16 v[200:203], a[248:251], v[140:143], v[200:203]
    s_waitcnt vmcnt(6)
    v_swap_b32 v146, v148
    v_swap_b32 v147, v149
    v_mfma_f32_16x16x32_bf16 v[188:191], a[252:255], v[136:139], v[188:191]
    v_mfma_f32_16x16x32_bf16 v[204:207], a[252:255], v[140:143], v[204:207]
    v_mfma_f32_16x16x32_bf16 v[232:235], v[144:147], v[144:147], v[232:235]
    v_mfma_f32_16x16x32_bf16 v[236:239], v[148:151], v[148:151], v[236:239]
    s_waitcnt lgkmcnt(0)
    v_mfma_f32_16x16x32_bf16 v[176:179], a[224:227], v[144:147], v[176:179]
    ds_read_b128 a[240:243], v7 offset:4096
    v_mfma_f32_16x16x32_bf16 v[192:195], a[224:227], v[148:151], v[192:195]
    ds_read_b128 a[244:247], v7 offset:5120
    v_mfma_f32_16x16x32_bf16 v[180:183], a[228:231], v[144:147], v[180:183]
    ds_read_b128 a[248:251], v7 offset:6144
    v_mfma_f32_16x16x32_bf16 v[196:199], a[228:231], v[148:151], v[196:199]
    ds_read_b128 a[252:255], v7 offset:7168
    v_mfma_f32_16x16x32_bf16 v[184:187], a[232:235], v[144:147], v[184:187]
    v_mfma_f32_16x16x32_bf16 v[200:203], a[232:235], v[148:151], v[200:203]
    s_waitcnt vmcnt(4)
    v_swap_b32 v154, v156
    v_swap_b32 v155, v157
    v_mfma_f32_16x16x32_bf16 v[188:191], a[236:239], v[144:147], v[188:191]
    v_mfma_f32_16x16x32_bf16 v[204:207], a[236:239], v[148:151], v[204:207]
    v_mfma_f32_16x16x32_bf16 v[232:235], v[152:155], v[152:155], v[232:235]
    v_mfma_f32_16x16x32_bf16 v[236:239], v[156:159], v[156:159], v[236:239]
    s_waitcnt lgkmcnt(0)
    v_mfma_f32_16x16x32_bf16 v[176:179], a[240:243], v[152:155], v[176:179]
    ds_read_b128 a[224:227], v7 offset:8192
    v_mfma_f32_16x16x32_bf16 v[192:195], a[240:243], v[156:159], v[192:195]
    ds_read_b128 a[228:231], v7 offset:9216
    v_mfma_f32_16x16x32_bf16 v[180:183], a[244:247], v[152:155], v[180:183]
    ds_read_b128 a[232:235], v7 offset:10240
    v_mfma_f32_16x16x32_bf16 v[196:199], a[244:247], v[156:159], v[196:199]
    ds_read_b128 a[236:239], v7 offset:11264
    v_mfma_f32_16x16x32_bf16 v[184:187], a[248:251], v[152:155], v[184:187]
    v_mfma_f32_16x16x32_bf16 v[200:203], a[248:251], v[156:159], v[200:203]
    s_waitcnt vmcnt(2)
    v_swap_b32 v162, v164
    v_swap_b32 v163, v165
    v_mfma_f32_16x16x32_bf16 v[188:191], a[252:255], v[152:155], v[188:191]
    v_mfma_f32_16x16x32_bf16 v[204:207], a[252:255], v[156:159], v[204:207]
    v_mfma_f32_16x16x32_bf16 v[232:235], v[160:163], v[160:163], v[232:235]
    v_mfma_f32_16x16x32_bf16 v[236:239], v[164:167], v[164:167], v[236:239]
    s_waitcnt lgkmcnt(0)
    v_mfma_f32_16x16x32_bf16 v[176:179], a[224:227], v[160:163], v[176:179]
    ds_read_b128 a[240:243], v7 offset:12288
    v_mfma_f32_16x16x32_bf16 v[192:195], a[224:227], v[164:167], v[192:195]
    ds_read_b128 a[244:247], v7 offset:13312
    v_mfma_f32_16x16x32_bf16 v[180:183], a[228:231], v[160:163], v[180:183]
    ds_read_b128 a[248:251], v7 offset:14336
    v_mfma_f32_16x16x32_bf16 v[196:199], a[228:231], v[164:167], v[196:199]
    ds_read_b128 a[252:255], v7 offset:15360
    v_mfma_f32_16x16x32_bf16 v[184:187], a[232:235], v[160:163], v[184:187]
    v_mfma_f32_16x16x32_bf16 v[200:203], a[232:235], v[164:167], v[200:203]
    s_waitcnt vmcnt(0)
    v_swap_b32 v170, v172
    v_swap_b32 v171, v173
    v_mfma_f32_16x16x32_bf16 v[188:191], a[236:239], v[160:163], v[188:191]
    v_mfma_f32_16x16x32_bf16 v[204:207], a[236:239], v[164:167], v[204:207]
    v_mfma_f32_16x16x32_bf16 v[232:235], v[168:171], v[168:171], v[232:235]
    v_mfma_f32_16x16x32_bf16 v[236:239], v[172:175], v[172:175], v[236:239]
    s_waitcnt lgkmcnt(0)
    v_mfma_f32_16x16x32_bf16 v[176:179], a[240:243], v[168:171], v[176:179]
    ds_read_b128 a[224:227], v7 offset:16384
    v_mfma_f32_16x16x32_bf16 v[192:195], a[240:243], v[172:175], v[192:195]
    ds_read_b128 a[228:231], v7 offset:17408
    v_mfma_f32_16x16x32_bf16 v[180:183], a[244:247], v[168:171], v[180:183]
    ds_read_b128 a[232:235], v7 offset:18432
    v_mfma_f32_16x16x32_bf16 v[196:199], a[244:247], v[172:175], v[196:199]
    ds_read_b128 v[244:247], v10 offset:384
    v_mfma_f32_16x16x32_bf16 v[184:187], a[248:251], v[168:171], v[184:187]
    ds_read_b128 v[248:251], v10 offset:0
    v_mfma_f32_16x16x32_bf16 v[200:203], a[248:251], v[172:175], v[200:203]
    v_mfma_f32_16x16x32_bf16 v[188:191], a[252:255], v[168:171], v[188:191]
    v_mfma_f32_16x16x32_bf16 v[204:207], a[252:255], v[172:175], v[204:207]
    s_waitcnt lgkmcnt(4)
    v_mfma_f32_16x16x32_bf16 v[208:211], a[224:227], v[16:19], 0
    ds_read_b128 a[236:239], v7 offset:19456
    v_cmp_eq_u32 vcc, 3, v4
    s_nop 1
    v_cndmask_b32 v240, 0, v176, vcc
    v_cndmask_b32 v241, 0, v192, vcc
    v_mov_b32 v242, v240
    v_mov_b32 v243, v241
    v_mfma_f32_16x16x32_bf16 v[220:223], a[224:227], v[20:23], 0
    v_permlane16_swap_b32 v240, v242
    v_permlane16_swap_b32 v241, v243
    v_add_f32 v240, v240, v242
    v_add_f32 v241, v241, v243
    v_mov_b32 v242, v240
    v_mov_b32 v243, v241
    s_waitcnt lgkmcnt(4)
    v_mfma_f32_16x16x32_bf16 v[212:215], a[228:231], v[16:19], 0
    ds_read_b128 a[240:243], v7 offset:20480
    v_permlane32_swap_b32 v240, v242
    v_permlane32_swap_b32 v241, v243
    v_add_f32 v240, v240, v242
    v_add_f32 v241, v241, v243
    v_mul_f32 v242, 0x3acccccd, v240
    v_mfma_f32_16x16x32_bf16 v[224:227], a[228:231], v[20:23], 0
    ds_read_b128 a[244:247], v7 offset:21504
    v_mul_f32 v243, 0x3acccccd, v241
    v_cvt_pk_bf16_f32 v242, v242, v242
    v_cvt_pk_bf16_f32 v243, v243, v243
    v_lshlrev_b32 v242, 16, v242
    v_lshlrev_b32 v243, 16, v243
    s_waitcnt lgkmcnt(5)
    v_mfma_f32_16x16x32_bf16 v[216:219], a[232:235], v[16:19], 0
    ds_read_b128 a[248:251], v7 offset:22528
    s_waitcnt lgkmcnt(4)
    v_fma_f32 v176, -v242, v244, v176
    v_fma_f32 v177, -v242, v245, v177
    v_fma_f32 v178, -v242, v246, v178
    v_fma_f32 v179, -v242, v247, v179
    v_fma_f32 v180, -v242, v248, v180
    v_mfma_f32_16x16x32_bf16 v[228:231], a[232:235], v[20:23], 0
    v_fma_f32 v181, -v242, v249, v181
    v_fma_f32 v182, -v242, v250, v182
    v_fma_f32 v183, -v242, v251, v183
    v_fma_f32 v192, -v243, v244, v192
    v_fma_f32 v193, -v243, v245, v193
    v_fma_f32 v194, -v243, v246, v194
    s_waitcnt lgkmcnt(3)
    v_mfma_f32_16x16x32_bf16 v[208:211], a[236:239], v[24:27], v[208:211]
    ds_read_b128 a[252:255], v7 offset:23552
    v_fma_f32 v195, -v243, v247, v195
    v_fma_f32 v196, -v243, v248, v196
    v_fma_f32 v197, -v243, v249, v197
    v_fma_f32 v198, -v243, v250, v198
    v_fma_f32 v199, -v243, v251, v199
    v_mfma_f32_16x16x32_bf16 v[220:223], a[236:239], v[28:31], v[220:223]
    ds_read_b128 v[244:247], v10 offset:64
    ds_read_b128 v[248:251], v10 offset:128
    v_cvt_pk_bf16_f32 v176, v176, v177
    v_cvt_pk_bf16_f32 v177, v178, v179
    v_pk_max_i16 v176, v176, 0
    v_pk_max_i16 v177, v177, 0
    s_waitcnt lgkmcnt(5)
    v_mfma_f32_16x16x32_bf16 v[212:215], a[240:243], v[24:27], v[212:215]
    ds_read_b128 a[224:227], v7 offset:24576
    v_cvt_pk_bf16_f32 v178, v180, v181
    v_cvt_pk_bf16_f32 v179, v182, v183
    v_pk_max_i16 v178, v178, 0
    v_pk_max_i16 v179, v179, 0
    buffer_store_dwordx4 v[176:179], v15, s[4:7], s34 offen offset:0 sc1
    v_mfma_f32_16x16x32_bf16 v[224:227], a[240:243], v[28:31], v[224:227]
    v_cvt_pk_bf16_f32 v192, v192, v193
    v_cvt_pk_bf16_f32 v193, v194, v195
    v_pk_max_i16 v192, v192, 0
    v_pk_max_i16 v193, v193, 0
    v_cvt_pk_bf16_f32 v194, v196, v197
    v_cvt_pk_bf16_f32 v195, v198, v199
    s_waitcnt lgkmcnt(5)
    v_mfma_f32_16x16x32_bf16 v[216:219], a[244:247], v[24:27], v[216:219]
    ds_read_b128 a[228:231], v7 offset:25600
    v_pk_max_i16 v194, v194, 0
    v_pk_max_i16 v195, v195, 0
    buffer_store_dwordx4 v[192:195], v15, s[4:7], s34 offen offset:1024 sc1
    s_waitcnt lgkmcnt(2)
    v_fma_f32 v184, -v242, v244, v184
    v_fma_f32 v185, -v242, v245, v185
    v_mfma_f32_16x16x32_bf16 v[228:231], a[244:247], v[28:31], v[228:231]
    v_fma_f32 v186, -v242, v246, v186
    v_fma_f32 v187, -v242, v247, v187
    v_fma_f32 v188, -v242, v248, v188
    v_fma_f32 v189, -v242, v249, v189
    v_fma_f32 v190, -v242, v250, v190
    v_fma_f32 v191, -v242, v251, v191
    s_waitcnt lgkmcnt(5)
    v_mfma_f32_16x16x32_bf16 v[208:211], a[248:251], v[32:35], v[208:211]
    ds_read_b128 a[232:235], v7 offset:26624
    v_fma_f32 v200, -v243, v244, v200
    v_fma_f32 v201, -v243, v245, v201
    v_fma_f32 v202, -v243, v246, v202
    v_fma_f32 v203, -v243, v247, v203
    v_fma_f32 v204, -v243, v248, v204
    v_mfma_f32_16x16x32_bf16 v[220:223], a[248:251], v[36:39], v[220:223]
    v_fma_f32 v205, -v243, v249, v205
    v_fma_f32 v206, -v243, v250, v206
    v_fma_f32 v207, -v243, v251, v207
    ds_read_b128 v[244:247], v10 offset:192
    ds_read_b128 v[248:251], v10 offset:256
    v_cvt_pk_bf16_f32 v184, v184, v185
    s_waitcnt lgkmcnt(7)
    v_mfma_f32_16x16x32_bf16 v[212:215], a[252:255], v[32:35], v[212:215]
    ds_read_b128 a[236:239], v7 offset:27648
    v_cvt_pk_bf16_f32 v185, v186, v187
    v_pk_max_i16 v184, v184, 0
    v_pk_max_i16 v185, v185, 0
    v_cvt_pk_bf16_f32 v186, v188, v189
    v_cvt_pk_bf16_f32 v187, v190, v191
    v_mfma_f32_16x16x32_bf16 v[224:227], a[252:255], v[36:39], v[224:227]
    v_pk_max_i16 v186, v186, 0
    v_pk_max_i16 v187, v187, 0
    buffer_store_dwordx4 v[184:187], v15, s[4:7], s38 offen offset:0 sc1
    v_cvt_pk_bf16_f32 v200, v200, v201
    v_cvt_pk_bf16_f32 v201, v202, v203
    v_pk_max_i16 v200, v200, 0
    s_waitcnt lgkmcnt(5)
    v_mfma_f32_16x16x32_bf16 v[216:219], a[224:227], v[32:35], v[216:219]
    ds_read_b128 a[240:243], v7 offset:28672
    v_pk_max_i16 v201, v201, 0
    v_cvt_pk_bf16_f32 v202, v204, v205
    v_cvt_pk_bf16_f32 v203, v206, v207
    v_pk_max_i16 v202, v202, 0
    v_pk_max_i16 v203, v203, 0
    v_mfma_f32_16x16x32_bf16 v[228:231], a[224:227], v[36:39], v[228:231]
    buffer_store_dwordx4 v[200:203], v15, s[4:7], s38 offen offset:1024 sc1
    ds_read_b128 v[180:183], v10 offset:320
    s_waitcnt lgkmcnt(6)
    v_mfma_f32_16x16x32_bf16 v[208:211], a[228:231], v[40:43], v[208:211]
    ds_read_b128 a[244:247], v7 offset:29696
    v_mfma_f32_16x16x32_bf16 v[220:223], a[228:231], v[44:47], v[220:223]
    buffer_load_dwordx4 v[16:19], v15, s[4:7], s27 offen offset:0 sc1
    s_waitcnt lgkmcnt(6)
    v_mfma_f32_16x16x32_bf16 v[212:215], a[232:235], v[40:43], v[212:215]
    ds_read_b128 a[248:251], v7 offset:30720
    v_mfma_f32_16x16x32_bf16 v[224:227], a[232:235], v[44:47], v[224:227]
    s_waitcnt lgkmcnt(4)
    v_mfma_f32_16x16x32_bf16 v[216:219], a[236:239], v[40:43], v[216:219]
    ds_read_b128 a[252:255], v7 offset:31744
    v_mfma_f32_16x16x32_bf16 v[228:231], a[236:239], v[44:47], v[228:231]
    s_waitcnt lgkmcnt(4)
    v_mfma_f32_16x16x32_bf16 v[208:211], a[240:243], v[48:51], v[208:211]
    ds_read_b128 a[224:227], v7 offset:32768
    v_mfma_f32_16x16x32_bf16 v[220:223], a[240:243], v[52:55], v[220:223]
    buffer_load_dwordx4 v[20:23], v15, s[4:7], s27 offen offset:1024 sc1
    s_waitcnt lgkmcnt(3)
    v_mfma_f32_16x16x32_bf16 v[212:215], a[244:247], v[48:51], v[212:215]
    ds_read_b128 a[228:231], v7 offset:33792
    v_mfma_f32_16x16x32_bf16 v[224:227], a[244:247], v[52:55], v[224:227]
    s_waitcnt lgkmcnt(3)
    v_mfma_f32_16x16x32_bf16 v[216:219], a[248:251], v[48:51], v[216:219]
    ds_read_b128 a[232:235], v7 offset:34816
    v_mfma_f32_16x16x32_bf16 v[228:231], a[248:251], v[52:55], v[228:231]
    s_waitcnt lgkmcnt(3)
    v_mfma_f32_16x16x32_bf16 v[208:211], a[252:255], v[56:59], v[208:211]
    ds_read_b128 a[236:239], v7 offset:35840
    v_mfma_f32_16x16x32_bf16 v[220:223], a[252:255], v[60:63], v[220:223]
    buffer_load_dwordx4 v[24:27], v15, s[4:7], s27 offen offset:2048 sc1
    s_waitcnt lgkmcnt(3)
    v_mfma_f32_16x16x32_bf16 v[212:215], a[224:227], v[56:59], v[212:215]
    ds_read_b128 a[240:243], v7 offset:36864
    v_mfma_f32_16x16x32_bf16 v[224:227], a[224:227], v[60:63], v[224:227]
    s_waitcnt lgkmcnt(3)
    v_mfma_f32_16x16x32_bf16 v[216:219], a[228:231], v[56:59], v[216:219]
    ds_read_b128 a[244:247], v7 offset:37888
    v_mfma_f32_16x16x32_bf16 v[228:231], a[228:231], v[60:63], v[228:231]
    s_waitcnt lgkmcnt(3)
    v_mfma_f32_16x16x32_bf16 v[208:211], a[232:235], v[64:67], v[208:211]
    ds_read_b128 a[248:251], v7 offset:38912
    v_mfma_f32_16x16x32_bf16 v[220:223], a[232:235], v[68:71], v[220:223]
    buffer_load_dwordx4 v[28:31], v15, s[4:7], s27 offen offset:3072 sc1
    s_add_u32 s27, s27, 4096
    s_waitcnt lgkmcnt(3)
    v_mfma_f32_16x16x32_bf16 v[212:215], a[236:239], v[64:67], v[212:215]
    ds_read_b128 a[252:255], v7 offset:39936
    v_mfma_f32_16x16x32_bf16 v[224:227], a[236:239], v[68:71], v[224:227]
    s_waitcnt lgkmcnt(3)
    v_mfma_f32_16x16x32_bf16 v[216:219], a[240:243], v[64:67], v[216:219]
    ds_read_b128 a[224:227], v7 offset:40960
    v_mfma_f32_16x16x32_bf16 v[228:231], a[240:243], v[68:71], v[228:231]
    s_waitcnt lgkmcnt(3)
    v_mfma_f32_16x16x32_bf16 v[208:211], a[244:247], v[72:75], v[208:211]
    ds_read_b128 a[228:231], v7 offset:41984
    s_barrier
    v_mfma_f32_16x16x32_bf16 v[220:223], a[244:247], v[76:79], v[220:223]
    buffer_load_dwordx4 v[32:35], v15, s[4:7], s27 offen offset:0 sc1
    s_waitcnt lgkmcnt(3)
    v_mfma_f32_16x16x32_bf16 v[212:215], a[248:251], v[72:75], v[212:215]
    ds_read_b128 a[232:235], v7 offset:43008
    v_mfma_f32_16x16x32_bf16 v[224:227], a[248:251], v[76:79], v[224:227]
    s_waitcnt lgkmcnt(3)
    v_mfma_f32_16x16x32_bf16 v[216:219], a[252:255], v[72:75], v[216:219]
    ds_read_b128 a[236:239], v7 offset:44032
    v_mfma_f32_16x16x32_bf16 v[228:231], a[252:255], v[76:79], v[228:231]
    s_waitcnt lgkmcnt(3)
    v_mfma_f32_16x16x32_bf16 v[208:211], a[224:227], v[80:83], v[208:211]
    ds_read_b128 a[240:243], v7 offset:45056
    v_mfma_f32_16x16x32_bf16 v[220:223], a[224:227], v[84:87], v[220:223]
    buffer_load_dwordx4 v[36:39], v15, s[4:7], s27 offen offset:1024 sc1
    s_waitcnt lgkmcnt(3)
    v_mfma_f32_16x16x32_bf16 v[212:215], a[228:231], v[80:83], v[212:215]
    ds_read_b128 a[244:247], v7 offset:46080
    v_mfma_f32_16x16x32_bf16 v[224:227], a[228:231], v[84:87], v[224:227]
    s_waitcnt lgkmcnt(3)
    v_mfma_f32_16x16x32_bf16 v[216:219], a[232:235], v[80:83], v[216:219]
    ds_read_b128 a[248:251], v7 offset:47104
    s_waitcnt lgkmcnt(15)
    v_fma_f32 v208, -v242, v244, v208
    v_fma_f32 v209, -v242, v245, v209
    v_fma_f32 v210, -v242, v246, v210
    v_fma_f32 v211, -v242, v247, v211
    v_mfma_f32_16x16x32_bf16 v[228:231], a[232:235], v[84:87], v[228:231]
    s_waitcnt lgkmcnt(3)
    v_mfma_f32_16x16x32_bf16 v[208:211], a[236:239], v[88:91], v[208:211]
    ds_read_b128 a[252:255], v7 offset:48128
    v_mfma_f32_16x16x32_bf16 v[220:223], a[236:239], v[92:95], v[220:223]
    buffer_load_dwordx4 v[40:43], v15, s[4:7], s27 offen offset:2048 sc1
    s_waitcnt lgkmcnt(3)
    v_mfma_f32_16x16x32_bf16 v[212:215], a[240:243], v[88:91], v[212:215]
    ds_read_b128 a[224:227], v7 offset:49152
    v_mfma_f32_16x16x32_bf16 v[224:227], a[240:243], v[92:95], v[224:227]
    s_waitcnt lgkmcnt(3)
    v_mfma_f32_16x16x32_bf16 v[216:219], a[244:247], v[88:91], v[216:219]
    ds_read_b128 a[228:231], v7 offset:50176
    v_mfma_f32_16x16x32_bf16 v[228:231], a[244:247], v[92:95], v[228:231]
    v_fma_f32 v220, -v243, v244, v220
    v_fma_f32 v221, -v243, v245, v221
    v_fma_f32 v222, -v243, v246, v222
    v_fma_f32 v223, -v243, v247, v223
    s_waitcnt lgkmcnt(3)
    v_mfma_f32_16x16x32_bf16 v[208:211], a[248:251], v[96:99], v[208:211]
    ds_read_b128 a[232:235], v7 offset:51200
    v_fma_f32 v212, -v242, v248, v212
    v_fma_f32 v213, -v242, v249, v213
    v_fma_f32 v214, -v242, v250, v214
    v_fma_f32 v215, -v242, v251, v215
    v_mfma_f32_16x16x32_bf16 v[220:223], a[248:251], v[100:103], v[220:223]
    buffer_load_dwordx4 v[44:47], v15, s[4:7], s27 offen offset:3072 sc1
    s_add_u32 s27, s27, 4096
    s_waitcnt lgkmcnt(3)
    v_mfma_f32_16x16x32_bf16 v[212:215], a[252:255], v[96:99], v[212:215]
    ds_read_b128 a[236:239], v7 offset:52224
    v_mul_u32_u24 v5, 16768, v4
    v_mfma_f32_16x16x32_bf16 v[224:227], a[252:255], v[100:103], v[224:227]
    v_lshl_add_u32 v5, v3, 4, v5
    s_waitcnt lgkmcnt(3)
    v_mfma_f32_16x16x32_bf16 v[216:219], a[224:227], v[96:99], v[216:219]
    ds_read_b128 a[240:243], v7 offset:53248
    s_add_u32 s18, s3, 0
    v_mfma_f32_16x16x32_bf16 v[228:231], a[224:227], v[100:103], v[228:231]
    s_and_b32 s18, s18, 3
    s_waitcnt lgkmcnt(3)
    v_mfma_f32_16x16x32_bf16 v[208:211], a[228:231], v[104:107], v[208:211]
    ds_read_b128 a[244:247], v7 offset:54272
    s_waitcnt vmcnt(8)
    s_mov_b64 exec, 0xffff
    buffer_store_dwordx2 v[252:253], v254, s[4:7], s36 offen offset:0 sc1
    s_mov_b64 exec, -1
    v_mfma_f32_16x16x32_bf16 v[220:223], a[228:231], v[108:111], v[220:223]
    v_fma_f32 v224, -v243, v248, v224
    v_fma_f32 v225, -v243, v249, v225
    v_fma_f32 v226, -v243, v250, v226
    v_fma_f32 v227, -v243, v251, v227
    s_waitcnt lgkmcnt(3)
    v_mfma_f32_16x16x32_bf16 v[212:215], a[232:235], v[104:107], v[212:215]
    ds_read_b128 a[248:251], v7 offset:55296
    s_lshl_b32 s19, s18, 10
    v_mfma_f32_16x16x32_bf16 v[224:227], a[232:235], v[108:111], v[224:227]
    v_add_u32 v90, s19, v15
    s_waitcnt lgkmcnt(3)
    v_mfma_f32_16x16x32_bf16 v[216:219], a[236:239], v[104:107], v[216:219]
    ds_read_b128 a[252:255], v7 offset:56320
    s_add_u32 s18, s3, 1
    v_mfma_f32_16x16x32_bf16 v[228:231], a[236:239], v[108:111], v[228:231]
    s_and_b32 s18, s18, 3
    s_waitcnt lgkmcnt(3)
    v_mfma_f32_16x16x32_bf16 v[208:211], a[240:243], v[112:115], v[208:211]
    ds_read_b128 a[224:227], v7 offset:57344
    s_lshl_b32 s19, s18, 10
    v_mfma_f32_16x16x32_bf16 v[220:223], a[240:243], v[116:119], v[220:223]
    buffer_load_dwordx4 v[48:51], v15, s[4:7], s27 offen offset:0 sc1
    s_waitcnt lgkmcnt(3)
    v_mfma_f32_16x16x32_bf16 v[212:215], a[244:247], v[112:115], v[212:215]
    ds_read_b128 a[228:231], v7 offset:58368
    v_fma_f32 v216, -v242, v180, v216
    v_fma_f32 v217, -v242, v181, v217
    v_fma_f32 v218, -v242, v182, v218
    v_fma_f32 v219, -v242, v183, v219
    v_mfma_f32_16x16x32_bf16 v[224:227], a[244:247], v[116:119], v[224:227]
    v_add_u32 v91, s19, v15
    s_waitcnt lgkmcnt(3)
    v_mfma_f32_16x16x32_bf16 v[216:219], a[248:251], v[112:115], v[216:219]
    ds_read_b128 a[232:235], v7 offset:59392
    s_add_u32 s18, s3, 2
    v_mfma_f32_16x16x32_bf16 v[228:231], a[248:251], v[116:119], v[228:231]
    s_and_b32 s18, s18, 3
    s_waitcnt lgkmcnt(3)
    v_mfma_f32_16x16x32_bf16 v[208:211], a[252:255], v[120:123], v[208:211]
    ds_read_b128 a[236:239], v7 offset:60416
    s_lshl_b32 s19, s18, 10
    v_mfma_f32_16x16x32_bf16 v[220:223], a[252:255], v[124:127], v[220:223]
    buffer_load_dwordx4 v[52:55], v15, s[4:7], s27 offen offset:1024 sc1
    s_waitcnt lgkmcnt(3)
    v_mfma_f32_16x16x32_bf16 v[212:215], a[224:227], v[120:123], v[212:215]
    ds_read_b128 a[240:243], v7 offset:61440
    v_add_u32 v92, s19, v15
    v_mfma_f32_16x16x32_bf16 v[224:227], a[224:227], v[124:127], v[224:227]
    v_fma_f32 v228, -v243, v180, v228
    v_fma_f32 v229, -v243, v181, v229
    v_fma_f32 v230, -v243, v182, v230
    v_fma_f32 v231, -v243, v183, v231
    s_waitcnt lgkmcnt(3)
    v_mfma_f32_16x16x32_bf16 v[216:219], a[228:231], v[120:123], v[216:219]
    ds_read_b128 a[244:247], v7 offset:62464
    s_add_u32 s18, s3, 3
    v_mfma_f32_16x16x32_bf16 v[228:231], a[228:231], v[124:127], v[228:231]
    s_and_b32 s18, s18, 3
    s_waitcnt lgkmcnt(3)
    v_mfma_f32_16x16x32_bf16 v[208:211], a[232:235], v[128:131], v[208:211]
    ds_read_b128 a[248:251], v7 offset:63488
    s_lshl_b32 s19, s18, 10
    v_mfma_f32_16x16x32_bf16 v[220:223], a[232:235], v[132:135], v[220:223]
    buffer_load_dwordx4 v[56:59], v15, s[4:7], s27 offen offset:2048 sc1
    s_waitcnt lgkmcnt(3)
    v_mfma_f32_16x16x32_bf16 v[212:215], a[236:239], v[128:131], v[212:215]
    ds_read_b128 a[252:255], v7 offset:64512
    v_add_u32 v93, s19, v15
    v_mfma_f32_16x16x32_bf16 v[224:227], a[236:239], v[132:135], v[224:227]
    s_waitcnt lgkmcnt(3)
    v_mfma_f32_16x16x32_bf16 v[216:219], a[240:243], v[128:131], v[216:219]
    ds_read_b128 a[224:227], v8 offset:0
    v_mfma_f32_16x16x32_bf16 v[228:231], a[240:243], v[132:135], v[228:231]
    s_waitcnt lgkmcnt(3)
    v_mfma_f32_16x16x32_bf16 v[208:211], a[244:247], v[136:139], v[208:211]
    ds_read_b128 a[228:231], v8 offset:1024
    v_mfma_f32_16x16x32_bf16 v[220:223], a[244:247], v[140:143], v[220:223]
    buffer_load_dwordx4 v[60:63], v15, s[4:7], s27 offen offset:3072 sc1
    s_add_u32 s27, s27, 4096
    s_waitcnt lgkmcnt(3)
    v_mfma_f32_16x16x32_bf16 v[212:215], a[248:251], v[136:139], v[212:215]
    ds_read_b128 a[232:235], v8 offset:2048
    v_mfma_f32_16x16x32_bf16 v[224:227], a[248:251], v[140:143], v[224:227]
    s_waitcnt lgkmcnt(3)
    v_mfma_f32_16x16x32_bf16 v[216:219], a[252:255], v[136:139], v[216:219]
    ds_read_b128 a[236:239], v8 offset:3072
    v_mfma_f32_16x16x32_bf16 v[228:231], a[252:255], v[140:143], v[228:231]
    s_waitcnt lgkmcnt(3)
    v_mfma_f32_16x16x32_bf16 v[208:211], a[224:227], v[144:147], v[208:211]
    ds_read_b128 a[240:243], v8 offset:4096
    v_mfma_f32_16x16x32_bf16 v[220:223], a[224:227], v[148:151], v[220:223]
    buffer_load_dwordx4 v[64:67], v15, s[4:7], s27 offen offset:0 sc1
    s_waitcnt lgkmcnt(3)
    v_mfma_f32_16x16x32_bf16 v[212:215], a[228:231], v[144:147], v[212:215]
    ds_read_b128 a[244:247], v8 offset:5120
    v_mfma_f32_16x16x32_bf16 v[224:227], a[228:231], v[148:151], v[224:227]
    s_waitcnt lgkmcnt(3)
    v_mfma_f32_16x16x32_bf16 v[216:219], a[232:235], v[144:147], v[216:219]
    ds_read_b128 a[248:251], v8 offset:6144
    v_mfma_f32_16x16x32_bf16 v[228:231], a[232:235], v[148:151], v[228:231]
    s_waitcnt lgkmcnt(3)
    v_mfma_f32_16x16x32_bf16 v[208:211], a[236:239], v[152:155], v[208:211]
    ds_read_b128 a[252:255], v8 offset:7168
    v_mfma_f32_16x16x32_bf16 v[220:223], a[236:239], v[156:159], v[220:223]
    buffer_load_dwordx4 v[68:71], v15, s[4:7], s27 offen offset:1024 sc1
    s_waitcnt lgkmcnt(3)
    v_mfma_f32_16x16x32_bf16 v[212:215], a[240:243], v[152:155], v[212:215]
    ds_read_b128 a[224:227], v8 offset:8192
    v_mfma_f32_16x16x32_bf16 v[224:227], a[240:243], v[156:159], v[224:227]
    s_waitcnt lgkmcnt(3)
    v_mfma_f32_16x16x32_bf16 v[216:219], a[244:247], v[152:155], v[216:219]
    ds_read_b128 a[228:231], v8 offset:9216
    v_mfma_f32_16x16x32_bf16 v[228:231], a[244:247], v[156:159], v[228:231]
    s_waitcnt lgkmcnt(3)
    v_mfma_f32_16x16x32_bf16 v[208:211], a[248:251], v[160:163], v[208:211]
    ds_read_b128 a[232:235], v8 offset:10240
    buffer_load_dwordx2 v[86:87], v11, s[4:7], s39 offen sc1
    v_mfma_f32_16x16x32_bf16 v[220:223], a[248:251], v[164:167], v[220:223]
    s_waitcnt lgkmcnt(3)
    v_mfma_f32_16x16x32_bf16 v[212:215], a[252:255], v[160:163], v[212:215]
    ds_read_b128 a[236:239], v8 offset:11264
    v_mfma_f32_16x16x32_bf16 v[224:227], a[252:255], v[164:167], v[224:227]
    s_waitcnt lgkmcnt(3)
    v_mfma_f32_16x16x32_bf16 v[216:219], a[224:227], v[160:163], v[216:219]
    v_mfma_f32_16x16x32_bf16 v[228:231], a[224:227], v[164:167], v[228:231]
    s_waitcnt lgkmcnt(2)
    v_mfma_f32_16x16x32_bf16 v[208:211], a[228:231], v[168:171], v[208:211]
    v_mfma_f32_16x16x32_bf16 v[220:223], a[228:231], v[172:175], v[220:223]
    s_waitcnt lgkmcnt(1)
    v_mfma_f32_16x16x32_bf16 v[212:215], a[232:235], v[168:171], v[212:215]
    v_mfma_f32_16x16x32_bf16 v[224:227], a[232:235], v[172:175], v[224:227]
    s_waitcnt lgkmcnt(0)
    v_mfma_f32_16x16x32_bf16 v[216:219], a[236:239], v[168:171], v[216:219]
    v_mfma_f32_16x16x32_bf16 v[228:231], a[236:239], v[172:175], v[228:231]
    s_nop 0
    v_cvt_pk_bf16_f32 v208, v208, v209
    v_cvt_pk_bf16_f32 v209, v210, v211
    v_pk_max_i16 v208, v208, 0
    v_pk_max_i16 v209, v209, 0
    v_cvt_pk_bf16_f32 v210, v212, v213
    v_cvt_pk_bf16_f32 v211, v214, v215
    v_pk_max_i16 v210, v210, 0
    v_pk_max_i16 v211, v211, 0
    v_cvt_pk_bf16_f32 v216, v216, v217
    v_cvt_pk_bf16_f32 v217, v218, v219
    v_pk_max_i16 v216, v216, 0
    v_pk_max_i16 v217, v217, 0
    buffer_store_dwordx4 v[208:211], v15, s[4:7], s35 offen offset:0 sc1
    buffer_store_dwordx2 v[216:217], v254, s[4:7], s37 offen offset:0 sc1
    v_cvt_pk_bf16_f32 v220, v220, v221
    v_cvt_pk_bf16_f32 v221, v222, v223
    v_pk_max_i16 v220, v220, 0
    v_pk_max_i16 v221, v221, 0
    v_cvt_pk_bf16_f32 v222, v224, v225
    v_cvt_pk_bf16_f32 v223, v226, v227
    v_pk_max_i16 v222, v222, 0
    v_pk_max_i16 v223, v223, 0
    v_cvt_pk_bf16_f32 v228, v228, v229
    v_cvt_pk_bf16_f32 v229, v230, v231
    v_pk_max_i16 v228, v228, 0
    v_pk_max_i16 v229, v229, 0
    buffer_store_dwordx4 v[220:223], v15, s[4:7], s35 offen offset:1024 sc1
    buffer_store_dwordx2 v[228:229], v254, s[4:7], s37 offen offset:1024 sc1
    s_waitcnt vmcnt(4)
    v_cmp_eq_u64 vcc, s[48:49], v[86:87]
    s_cmp_eq_u64 vcc, exec
    s_cbranch_scc1 L_sp3ai_out
    s_waitcnt vmcnt(0)
    s_mov_b64 exec, 0xffff
    buffer_store_dwordx2 v[252:253], v254, s[4:7], s36 offen offset:128 sc1
    s_mov_b64 exec, -1
    s_mov_b32 s58, 0
L_sp3ai:
    buffer_load_dwordx2 v[86:87], v11, s[4:7], s39 offen sc1
    s_add_u32 s58, s58, 1
    s_waitcnt vmcnt(0)
    v_cmp_eq_u64 vcc, s[48:49], v[86:87]
    s_cmp_eq_u64 vcc, exec
    s_cbranch_scc1 L_sp3ai_out
    s_sleep 1
    s_cmp_le_u32 s58, 200000
    s_cbranch_scc1 L_sp3ai
L_sp3ai_out:
    buffer_load_dwordx4 v[176:179], v91, s[4:7], s40 offen sc1
    buffer_load_dwordx4 v[180:183], v92, s[4:7], s40 offen sc1
    buffer_load_dwordx4 v[184:187], v93, s[4:7], s40 offen sc1
    buffer_load_dwordx4 v[188:191], v90, s[4:7], s40 offen sc1
    s_add_u32 s40, s45, 4096
    buffer_load_dwordx4 v[192:195], v91, s[4:7], s40 offen sc1
    buffer_load_dwordx4 v[196:199], v92, s[4:7], s40 offen sc1
    buffer_load_dwordx4 v[200:203], v93, s[4:7], s40 offen sc1
    buffer_load_dwordx4 v[204:207], v90, s[4:7], s40 offen sc1
    s_add_u32 s40, s45, 8192
    buffer_load_dwordx4 v[208:211], v91, s[4:7], s40 offen sc1
    buffer_load_dwordx4 v[212:215], v92, s[4:7], s40 offen sc1
    buffer_load_dwordx4 v[216:219], v93, s[4:7], s40 offen sc1
    buffer_load_dwordx4 v[220:223], v90, s[4:7], s40 offen sc1
    buffer_load_dwordx2 v[76:77], v5, s[4:7], s42 offen sc1
    s_add_u32 s42, s42, 67072
    buffer_load_dwordx2 v[78:79], v5, s[4:7], s42 offen sc1
    s_add_u32 s42, s42, 67072
    buffer_load_dwordx2 v[80:81], v5, s[4:7], s42 offen sc1
    s_add_u32 s42, s42, 67072
    buffer_load_dwordx2 v[82:83], v5, s[4:7], s42 offen sc1
    s_add_u32 s42, s42, 67072
    buffer_load_dwordx2 v[84:85], v5, s[4:7], s42 offen sc1
    v_and_b32 v12, 3, v3
    v_lshrrev_b32 v13, 2, v3
    v_cmp_eq_u32 vcc, 1, v12
    s_nop 1
    v_cndmask_b32 v232, v232, v233, vcc
    v_cndmask_b32 v236, v236, v237, vcc
    v_cmp_eq_u32 vcc, 2, v12
    s_nop 1
    v_cndmask_b32 v232, v232, v234, vcc
    v_cndmask_b32 v236, v236, v238, vcc
    v_cmp_eq_u32 vcc, 3, v12
    s_nop 1
    v_cndmask_b32 v232, v232, v235, vcc
    v_cndmask_b32 v236, v236, v239, vcc
    v_mul_f32 v234, 0x3acccccd, v240
    v_mul_f32 v238, 0x3acccccd, v241
    v_mul_f32 v233, 0x3acccccd, v232
    v_mul_f32 v237, 0x3acccccd, v236
    v_fma_f32 v233, -v234, v234, v233
    v_fma_f32 v237, -v238, v238, v237
    v_max_f32 v233, 0, v233
    v_max_f32 v237, 0, v237
    v_cvt_pk_bf16_f32 v234, v234, v233
    v_cvt_pk_bf16_f32 v238, v238, v237
    v_and_b32 v233, 0xffff0000, v234
    v_and_b32 v237, 0xffff0000, v238
    v_add_f32 v233, 0x3727c5ac, v233
    v_add_f32 v237, 0x3727c5ac, v237
    v_cvt_pk_bf16_f32 v233, v233, v233
    v_cvt_pk_bf16_f32 v237, v237, v237
    v_lshlrev_b32 v233, 16, v233
    v_lshlrev_b32 v237, 16, v237
    v_sqrt_f32 v233, v233
    v_sqrt_f32 v237, v237
    v_cvt_pk_bf16_f32 v233, v233, v233
    v_cvt_pk_bf16_f32 v237, v237, v237
    v_lshlrev_b32 v233, 16, v233
    v_lshlrev_b32 v237, 16, v237
    v_rcp_f32 v233, v233
    v_rcp_f32 v237, v237
    v_cmp_eq_u32 vcc, v13, v4
    s_lshl_b32 s18, s3, 7
    s_add_u32 s18, s18, 143872
    v_lshl_add_u32 v12, v3, 2, s18
    v_mov_b32 v13, 144384
    v_cndmask_b32 v12, v13, v12, vcc
    ds_write_b32 v12, v233 offset:0
    ds_write_b32 v12, v237 offset:64
    s_waitcnt vmcnt(16)
    s_mov_b64 exec, 0xffff
    buffer_store_dwordx2 v[252:253], v254, s[4:7], s36 offen offset:128 sc1
    s_mov_b64 exec, -1
    v_mfma_f32_16x16x32_bf16 v[116:119], a[0:3], v[176:179], 0
    s_add_u32 s18, s3, 1
    s_and_b32 s18, s18, 3
    v_mfma_f32_16x16x32_bf16 v[120:123], a[4:7], v[176:179], 0
    s_add_u32 s40, s45, 12288
    buffer_load_dwordx4 v[224:227], v91, s[4:7], s40 offen sc1
    v_mfma_f32_16x16x32_bf16 v[124:127], a[8:11], v[176:179], 0
    s_mul_i32 s19, s18, 15360
    s_add_u32 s19, s19, 0
    v_mfma_f32_16x16x32_bf16 v[128:131], a[12:15], v[176:179], 0
    v_add_u32 v73, s19, v15
    s_add_u32 s18, s3, 2
    v_mfma_f32_16x16x32_bf16 v[132:135], a[16:19], v[176:179], 0
    s_and_b32 s18, s18, 3
    s_mul_i32 s19, s18, 15360
    s_waitcnt vmcnt(17)
    v_mfma_f32_16x16x32_bf16 v[136:139], a[0:3], v[180:183], 0
    s_add_u32 s19, s19, 5120
    v_add_u32 v74, s19, v15
    v_mfma_f32_16x16x32_bf16 v[140:143], a[4:7], v[180:183], 0
    buffer_load_dwordx4 v[228:231], v92, s[4:7], s40 offen sc1
    v_mfma_f32_16x16x32_bf16 v[144:147], a[8:11], v[180:183], 0
    s_add_u32 s18, s3, 3
    s_and_b32 s18, s18, 3
    v_mfma_f32_16x16x32_bf16 v[148:151], a[12:15], v[180:183], 0
    s_mul_i32 s19, s18, 15360
    s_add_u32 s19, s19, 10240
    v_mfma_f32_16x16x32_bf16 v[152:155], a[16:19], v[180:183], 0
    v_add_u32 v75, s19, v15
    v_mul_u32_u24 v6, 1280, v3
    s_waitcnt vmcnt(17)
    v_mfma_f32_16x16x32_bf16 v[156:159], a[0:3], v[184:187], 0
    v_lshl_add_u32 v6, v4, 3, v6
    s_mul_i32 s18, s3, 15360
    v_mfma_f32_16x16x32_bf16 v[160:163], a[4:7], v[184:187], 0
    buffer_load_dwordx4 v[232:235], v93, s[4:7], s40 offen sc1
    v_mfma_f32_16x16x32_bf16 v[164:167], a[8:11], v[184:187], 0
    v_add_u32 v72, s18, v15
    s_and_b32 s18, s22, 1
    v_mfma_f32_16x16x32_bf16 v[168:171], a[12:15], v[184:187], 0
    s_lshl_b32 s18, s18, 8
    s_lshl_b32 s19, s3, 6
    v_mfma_f32_16x16x32_bf16 v[172:175], a[16:19], v[184:187], 0
    s_add_u32 s18, s18, s19
    s_add_u32 s18, s18, 143872
    s_waitcnt vmcnt(17)
    v_mfma_f32_16x16x32_bf16 v[96:99], a[0:3], v[188:191], 0
    v_lshl_add_u32 v94, v3, 2, s18
    v_mfma_f32_16x16x32_bf16 v[100:103], a[4:7], v[188:191], 0
    buffer_load_dwordx4 v[236:239], v90, s[4:7], s40 offen sc1
    v_mfma_f32_16x16x32_bf16 v[104:107], a[8:11], v[188:191], 0
    v_mfma_f32_16x16x32_bf16 v[108:111], a[12:15], v[188:191], 0
    v_mfma_f32_16x16x32_bf16 v[112:115], a[16:19], v[188:191], 0
    s_waitcnt vmcnt(17)
    v_mfma_f32_16x16x32_bf16 v[116:119], a[20:23], v[192:195], v[116:119]
    v_mfma_f32_16x16x32_bf16 v[120:123], a[24:27], v[192:195], v[120:123]
    s_add_u32 s40, s45, 16384
    buffer_load_dwordx4 v[176:179], v91, s[4:7], s40 offen sc1
    v_mfma_f32_16x16x32_bf16 v[124:127], a[28:31], v[192:195], v[124:127]
    v_mfma_f32_16x16x32_bf16 v[128:131], a[32:35], v[192:195], v[128:131]
    v_mfma_f32_16x16x32_bf16 v[132:135], a[36:39], v[192:195], v[132:135]
    s_waitcnt vmcnt(17)
    v_mfma_f32_16x16x32_bf16 v[136:139], a[20:23], v[196:199], v[136:139]
    v_mfma_f32_16x16x32_bf16 v[140:143], a[24:27], v[196:199], v[140:143]
    buffer_load_dwordx4 v[180:183], v92, s[4:7], s40 offen sc1
    v_mfma_f32_16x16x32_bf16 v[144:147], a[28:31], v[196:199], v[144:147]
    v_mfma_f32_16x16x32_bf16 v[148:151], a[32:35], v[196:199], v[148:151]
    v_mfma_f32_16x16x32_bf16 v[152:155], a[36:39], v[196:199], v[152:155]
    s_waitcnt vmcnt(17)
    v_mfma_f32_16x16x32_bf16 v[156:159], a[20:23], v[200:203], v[156:159]
    v_mfma_f32_16x16x32_bf16 v[160:163], a[24:27], v[200:203], v[160:163]
    buffer_load_dwordx4 v[184:187], v93, s[4:7], s40 offen sc1
    v_mfma_f32_16x16x32_bf16 v[164:167], a[28:31], v[200:203], v[164:167]
    v_mfma_f32_16x16x32_bf16 v[168:171], a[32:35], v[200:203], v[168:171]
    v_mfma_f32_16x16x32_bf16 v[172:175], a[36:39], v[200:203], v[172:175]
    s_waitcnt vmcnt(17)
    v_mfma_f32_16x16x32_bf16 v[96:99], a[20:23], v[204:207], v[96:99]
    v_mfma_f32_16x16x32_bf16 v[100:103], a[24:27], v[204:207], v[100:103]
    buffer_load_dwordx4 v[188:191], v90, s[4:7], s40 offen sc1
    v_mfma_f32_16x16x32_bf16 v[104:107], a[28:31], v[204:207], v[104:107]
    v_mfma_f32_16x16x32_bf16 v[108:111], a[32:35], v[204:207], v[108:111]
    v_mfma_f32_16x16x32_bf16 v[112:115], a[36:39], v[204:207], v[112:115]
    s_waitcnt vmcnt(17)
    v_mfma_f32_16x16x32_bf16 v[116:119], a[40:43], v[208:211], v[116:119]
    v_mfma_f32_16x16x32_bf16 v[120:123], a[44:47], v[208:211], v[120:123]
    s_add_u32 s40, s45, 20480
    buffer_load_dwordx4 v[192:195], v91, s[4:7], s40 offen sc1
    v_mfma_f32_16x16x32_bf16 v[124:127], a[48:51], v[208:211], v[124:127]
    v_mfma_f32_16x16x32_bf16 v[128:131], a[52:55], v[208:211], v[128:131]
    v_mfma_f32_16x16x32_bf16 v[132:135], a[56:59], v[208:211], v[132:135]
    s_waitcnt vmcnt(17)
    v_mfma_f32_16x16x32_bf16 v[136:139], a[40:43], v[212:215], v[136:139]
    v_mfma_f32_16x16x32_bf16 v[140:143], a[44:47], v[212:215], v[140:143]
    buffer_load_dwordx4 v[196:199], v92, s[4:7], s40 offen sc1
    v_mfma_f32_16x16x32_bf16 v[144:147], a[48:51], v[212:215], v[144:147]
    v_mfma_f32_16x16x32_bf16 v[148:151], a[52:55], v[212:215], v[148:151]
    v_mfma_f32_16x16x32_bf16 v[152:155], a[56:59], v[212:215], v[152:155]
    s_waitcnt vmcnt(17)
    v_mfma_f32_16x16x32_bf16 v[156:159], a[40:43], v[216:219], v[156:159]
    v_mfma_f32_16x16x32_bf16 v[160:163], a[44:47], v[216:219], v[160:163]
    buffer_load_dwordx4 v[200:203], v93, s[4:7], s40 offen sc1
    v_mfma_f32_16x16x32_bf16 v[164:167], a[48:51], v[216:219], v[164:167]
    v_mfma_f32_16x16x32_bf16 v[168:171], a[52:55], v[216:219], v[168:171]
    v_mfma_f32_16x16x32_bf16 v[172:175], a[56:59], v[216:219], v[172:175]
    s_waitcnt vmcnt(17)
    v_mfma_f32_16x16x32_bf16 v[96:99], a[40:43], v[220:223], v[96:99]
    v_mfma_f32_16x16x32_bf16 v[100:103], a[44:47], v[220:223], v[100:103]
    buffer_load_dwordx4 v[204:207], v90, s[4:7], s40 offen sc1
    v_mfma_f32_16x16x32_bf16 v[104:107], a[48:51], v[220:223], v[104:107]
    v_mfma_f32_16x16x32_bf16 v[108:111], a[52:55], v[220:223], v[108:111]
    v_mfma_f32_16x16x32_bf16 v[112:115], a[56:59], v[220:223], v[112:115]
    s_waitcnt vmcnt(11)
    v_mfma_f32_16x16x32_bf16 v[116:119], a[60:63], v[224:227], v[116:119]
    v_mfma_f32_16x16x32_bf16 v[120:123], a[64:67], v[224:227], v[120:123]
    s_add_u32 s40, s45, 24576
    buffer_load_dwordx4 v[208:211], v91, s[4:7], s40 offen sc1
    v_mfma_f32_16x16x32_bf16 v[124:127], a[68:71], v[224:227], v[124:127]
    v_mfma_f32_16x16x32_bf16 v[128:131], a[72:75], v[224:227], v[128:131]
    v_mfma_f32_16x16x32_bf16 v[132:135], a[76:79], v[224:227], v[132:135]
    s_waitcnt vmcnt(11)
    v_mfma_f32_16x16x32_bf16 v[136:139], a[60:63], v[228:231], v[136:139]
    v_mfma_f32_16x16x32_bf16 v[140:143], a[64:67], v[228:231], v[140:143]
    buffer_load_dwordx4 v[212:215], v92, s[4:7], s40 offen sc1
    buffer_load_dwordx2 v[86:87], v11, s[4:7], s39 offen offset:128 sc1
    v_mfma_f32_16x16x32_bf16 v[144:147], a[68:71], v[228:231], v[144:147]
    v_mfma_f32_16x16x32_bf16 v[148:151], a[72:75], v[228:231], v[148:151]
    v_mfma_f32_16x16x32_bf16 v[152:155], a[76:79], v[228:231], v[152:155]
    s_waitcnt vmcnt(12)
    v_mfma_f32_16x16x32_bf16 v[156:159], a[60:63], v[232:235], v[156:159]
    v_mfma_f32_16x16x32_bf16 v[160:163], a[64:67], v[232:235], v[160:163]
    buffer_load_dwordx4 v[216:219], v93, s[4:7], s40 offen sc1
    v_mfma_f32_16x16x32_bf16 v[164:167], a[68:71], v[232:235], v[164:167]
    v_mfma_f32_16x16x32_bf16 v[168:171], a[72:75], v[232:235], v[168:171]
    v_mfma_f32_16x16x32_bf16 v[172:175], a[76:79], v[232:235], v[172:175]
    s_waitcnt vmcnt(12)
    v_mfma_f32_16x16x32_bf16 v[96:99], a[60:63], v[236:239], v[96:99]
    v_mfma_f32_16x16x32_bf16 v[100:103], a[64:67], v[236:239], v[100:103]
    buffer_load_dwordx4 v[220:223], v90, s[4:7], s40 offen sc1
    v_mfma_f32_16x16x32_bf16 v[104:107], a[68:71], v[236:239], v[104:107]
    v_mfma_f32_16x16x32_bf16 v[108:111], a[72:75], v[236:239], v[108:111]
    v_mfma_f32_16x16x32_bf16 v[112:115], a[76:79], v[236:239], v[112:115]
    s_waitcnt vmcnt(12)
    v_mfma_f32_16x16x32_bf16 v[116:119], a[80:83], v[176:179], v[116:119]
    v_mfma_f32_16x16x32_bf16 v[120:123], a[84:87], v[176:179], v[120:123]
    s_add_u32 s40, s45, 28672
    buffer_load_dwordx4 v[224:227], v91, s[4:7], s40 offen sc1
    v_mfma_f32_16x16x32_bf16 v[124:127], a[88:91], v[176:179], v[124:127]
    v_mfma_f32_16x16x32_bf16 v[128:131], a[92:95], v[176:179], v[128:131]
    v_mfma_f32_16x16x32_bf16 v[132:135], a[96:99], v[176:179], v[132:135]
    s_waitcnt vmcnt(12)
    v_mfma_f32_16x16x32_bf16 v[136:139], a[80:83], v[180:183], v[136:139]
    v_mfma_f32_16x16x32_bf16 v[140:143], a[84:87], v[180:183], v[140:143]
    buffer_load_dwordx4 v[228:231], v92, s[4:7], s40 offen sc1
    v_mfma_f32_16x16x32_bf16 v[144:147], a[88:91], v[180:183], v[144:147]
    v_mfma_f32_16x16x32_bf16 v[148:151], a[92:95], v[180:183], v[148:151]
    v_mfma_f32_16x16x32_bf16 v[152:155], a[96:99], v[180:183], v[152:155]
    s_waitcnt vmcnt(12)
    v_mfma_f32_16x16x32_bf16 v[156:159], a[80:83], v[184:187], v[156:159]
    v_mfma_f32_16x16x32_bf16 v[160:163], a[84:87], v[184:187], v[160:163]
    buffer_load_dwordx4 v[232:235], v93, s[4:7], s40 offen sc1
    v_mfma_f32_16x16x32_bf16 v[164:167], a[88:91], v[184:187], v[164:167]
    v_mfma_f32_16x16x32_bf16 v[168:171], a[92:95], v[184:187], v[168:171]
    v_mfma_f32_16x16x32_bf16 v[172:175], a[96:99], v[184:187], v[172:175]
    s_waitcnt vmcnt(12)
    v_mfma_f32_16x16x32_bf16 v[96:99], a[80:83], v[188:191], v[96:99]
    v_mfma_f32_16x16x32_bf16 v[100:103], a[84:87], v[188:191], v[100:103]
    buffer_load_dwordx4 v[236:239], v90, s[4:7], s40 offen sc1
    v_mfma_f32_16x16x32_bf16 v[104:107], a[88:91], v[188:191], v[104:107]
    v_mfma_f32_16x16x32_bf16 v[108:111], a[92:95], v[188:191], v[108:111]
    v_mfma_f32_16x16x32_bf16 v[112:115], a[96:99], v[188:191], v[112:115]
    s_waitcnt vmcnt(12)
    v_mfma_f32_16x16x32_bf16 v[116:119], a[100:103], v[192:195], v[116:119]
    v_mfma_f32_16x16x32_bf16 v[120:123], a[104:107], v[192:195], v[120:123]
    s_waitcnt vmcnt(6)
    v_cmp_eq_u64 vcc, s[48:49], v[86:87]
    s_cmp_eq_u64 vcc, exec
    s_cbranch_scc1 L_sp3bi_out
    s_mov_b32 s58, 0
L_sp3bi:
    buffer_load_dwordx2 v[86:87], v11, s[4:7], s39 offen offset:128 sc1
    s_add_u32 s58, s58, 1
    s_waitcnt vmcnt(0)
    v_cmp_eq_u64 vcc, s[48:49], v[86:87]
    s_cmp_eq_u64 vcc, exec
    s_cbranch_scc1 L_sp3bi_out
    s_sleep 1
    s_cmp_le_u32 s58, 200000
    s_cbranch_scc1 L_sp3bi
L_sp3bi_out:
    s_add_u32 s40, s45, 32768
    buffer_load_dwordx4 v[176:179], v91, s[4:7], s40 offen sc1
    v_mfma_f32_16x16x32_bf16 v[124:127], a[108:111], v[192:195], v[124:127]
    v_mfma_f32_16x16x32_bf16 v[128:131], a[112:115], v[192:195], v[128:131]
    v_mfma_f32_16x16x32_bf16 v[132:135], a[116:119], v[192:195], v[132:135]
    s_waitcnt vmcnt(12)
    v_mfma_f32_16x16x32_bf16 v[136:139], a[100:103], v[196:199], v[136:139]
    v_mfma_f32_16x16x32_bf16 v[140:143], a[104:107], v[196:199], v[140:143]
    s_add_u32 s40, s45, 36864
    buffer_load_dwordx4 v[180:183], v91, s[4:7], s40 offen sc1
    v_mfma_f32_16x16x32_bf16 v[144:147], a[108:111], v[196:199], v[144:147]
    v_mfma_f32_16x16x32_bf16 v[148:151], a[112:115], v[196:199], v[148:151]
    v_mfma_f32_16x16x32_bf16 v[152:155], a[116:119], v[196:199], v[152:155]
    s_waitcnt vmcnt(12)
    v_mfma_f32_16x16x32_bf16 v[156:159], a[100:103], v[200:203], v[156:159]
    v_mfma_f32_16x16x32_bf16 v[160:163], a[104:107], v[200:203], v[160:163]
    s_add_u32 s40, s45, 40960
    buffer_load_dwordx4 v[184:187], v91, s[4:7], s40 offen sc1
    v_mfma_f32_16x16x32_bf16 v[164:167], a[108:111], v[200:203], v[164:167]
    v_mfma_f32_16x16x32_bf16 v[168:171], a[112:115], v[200:203], v[168:171]
    v_mfma_f32_16x16x32_bf16 v[172:175], a[116:119], v[200:203], v[172:175]
    s_waitcnt vmcnt(12)
    v_mfma_f32_16x16x32_bf16 v[96:99], a[100:103], v[204:207], v[96:99]
    v_mfma_f32_16x16x32_bf16 v[100:103], a[104:107], v[204:207], v[100:103]
    s_add_u32 s40, s45, 45056
    buffer_load_dwordx4 v[188:191], v91, s[4:7], s40 offen sc1
    v_mfma_f32_16x16x32_bf16 v[104:107], a[108:111], v[204:207], v[104:107]
    v_mfma_f32_16x16x32_bf16 v[108:111], a[112:115], v[204:207], v[108:111]
    v_mfma_f32_16x16x32_bf16 v[112:115], a[116:119], v[204:207], v[112:115]
    s_waitcnt vmcnt(12)
    v_mfma_f32_16x16x32_bf16 v[116:119], a[120:123], v[208:211], v[116:119]
    v_mfma_f32_16x16x32_bf16 v[120:123], a[124:127], v[208:211], v[120:123]
    s_add_u32 s40, s45, 49152
    v_sub_u32 v91, v91, v254
    buffer_load_dwordx2 v[192:193], v91, s[4:7], s40 offen offset:0 sc1
    buffer_load_dwordx2 v[194:195], v91, s[4:7], s40 offen offset:512 sc1
    v_mfma_f32_16x16x32_bf16 v[124:127], a[128:131], v[208:211], v[124:127]
    v_mfma_f32_16x16x32_bf16 v[128:131], a[132:135], v[208:211], v[128:131]
    v_mfma_f32_16x16x32_bf16 v[132:135], a[136:139], v[208:211], v[132:135]
    s_waitcnt vmcnt(13)
    v_mfma_f32_16x16x32_bf16 v[136:139], a[120:123], v[212:215], v[136:139]
    v_mfma_f32_16x16x32_bf16 v[140:143], a[124:127], v[212:215], v[140:143]
    s_add_u32 s40, s45, 53248
    buffer_load_dwordx2 v[196:197], v91, s[4:7], s40 offen offset:0 sc1
    buffer_load_dwordx2 v[198:199], v91, s[4:7], s40 offen offset:512 sc1
    v_mfma_f32_16x16x32_bf16 v[144:147], a[128:131], v[212:215], v[144:147]
    v_mfma_f32_16x16x32_bf16 v[148:151], a[132:135], v[212:215], v[148:151]
    v_mfma_f32_16x16x32_bf16 v[152:155], a[136:139], v[212:215], v[152:155]
    s_waitcnt vmcnt(13)
    v_mfma_f32_16x16x32_bf16 v[156:159], a[120:123], v[216:219], v[156:159]
    v_mfma_f32_16x16x32_bf16 v[160:163], a[124:127], v[216:219], v[160:163]
    s_add_u32 s40, s45, 32768
    buffer_load_dwordx4 v[200:203], v92, s[4:7], s40 offen sc1
    v_mfma_f32_16x16x32_bf16 v[164:167], a[128:131], v[216:219], v[164:167]
    v_mfma_f32_16x16x32_bf16 v[168:171], a[132:135], v[216:219], v[168:171]
    v_mfma_f32_16x16x32_bf16 v[172:175], a[136:139], v[216:219], v[172:175]
    s_waitcnt vmcnt(13)
    v_mfma_f32_16x16x32_bf16 v[96:99], a[120:123], v[220:223], v[96:99]
    v_mfma_f32_16x16x32_bf16 v[100:103], a[124:127], v[220:223], v[100:103]
    s_add_u32 s40, s45, 36864
    buffer_load_dwordx4 v[204:207], v92, s[4:7], s40 offen sc1
    v_mfma_f32_16x16x32_bf16 v[104:107], a[128:131], v[220:223], v[104:107]
    v_mfma_f32_16x16x32_bf16 v[108:111], a[132:135], v[220:223], v[108:111]
    v_mfma_f32_16x16x32_bf16 v[112:115], a[136:139], v[220:223], v[112:115]
    s_waitcnt vmcnt(13)
    v_mfma_f32_16x16x32_bf16 v[116:119], a[140:143], v[224:227], v[116:119]
    v_mfma_f32_16x16x32_bf16 v[120:123], a[144:147], v[224:227], v[120:123]
    s_add_u32 s40, s45, 40960
    buffer_load_dwordx4 v[208:211], v92, s[4:7], s40 offen sc1
    v_mfma_f32_16x16x32_bf16 v[124:127], a[148:151], v[224:227], v[124:127]
    v_mfma_f32_16x16x32_bf16 v[128:131], a[152:155], v[224:227], v[128:131]
    v_mfma_f32_16x16x32_bf16 v[132:135], a[156:159], v[224:227], v[132:135]
    s_waitcnt vmcnt(13)
    v_mfma_f32_16x16x32_bf16 v[136:139], a[140:143], v[228:231], v[136:139]
    v_mfma_f32_16x16x32_bf16 v[140:143], a[144:147], v[228:231], v[140:143]
    s_add_u32 s40, s45, 45056
    buffer_load_dwordx4 v[212:215], v92, s[4:7], s40 offen sc1
    v_mfma_f32_16x16x32_bf16 v[144:147], a[148:151], v[228:231], v[144:147]
    v_mfma_f32_16x16x32_bf16 v[148:151], a[152:155], v[228:231], v[148:151]
    v_mfma_f32_16x16x32_bf16 v[152:155], a[156:159], v[228:231], v[152:155]
    s_waitcnt vmcnt(13)
    v_mfma_f32_16x16x32_bf16 v[156:159], a[140:143], v[232:235], v[156:159]
    v_mfma_f32_16x16x32_bf16 v[160:163], a[144:147], v[232:235], v[160:163]
    s_add_u32 s40, s45, 49152
    v_sub_u32 v92, v92, v254
    buffer_load_dwordx2 v[216:217], v92, s[4:7], s40 offen offset:0 sc1
    buffer_load_dwordx2 v[218:219], v92, s[4:7], s40 offen offset:512 sc1
    v_mfma_f32_16x16x32_bf16 v[164:167], a[148:151], v[232:235], v[164:167]
    v_mfma_f32_16x16x32_bf16 v[168:171], a[152:155], v[232:235], v[168:171]
    v_mfma_f32_16x16x32_bf16 v[172:175], a[156:159], v[232:235], v[172:175]
    s_waitcnt vmcnt(14)
    v_mfma_f32_16x16x32_bf16 v[96:99], a[140:143], v[236:239], v[96:99]
    v_mfma_f32_16x16x32_bf16 v[100:103], a[144:147], v[236:239], v[100:103]
    s_add_u32 s40, s45, 53248
    buffer_load_dwordx2 v[220:221], v92, s[4:7], s40 offen offset:0 sc1
    buffer_load_dwordx2 v[222:223], v92, s[4:7], s40 offen offset:512 sc1
    v_mfma_f32_16x16x32_bf16 v[104:107], a[148:151], v[236:239], v[104:107]
    v_mfma_f32_16x16x32_bf16 v[108:111], a[152:155], v[236:239], v[108:111]
    v_mfma_f32_16x16x32_bf16 v[112:115], a[156:159], v[236:239], v[112:115]
    s_waitcnt vmcnt(15)
    v_mfma_f32_16x16x32_bf16 v[116:119], a[160:163], v[176:179], v[116:119]
    v_lshlrev_b32 v240, 16, v76
    v_and_b32 v241, 0xffff0000, v76
    v_mfma_f32_16x16x32_bf16 v[120:123], a[164:167], v[176:179], v[120:123]
    s_add_u32 s40, s45, 32768
    buffer_load_dwordx4 v[224:227], v93, s[4:7], s40 offen sc1
    v_mfma_f32_16x16x32_bf16 v[124:127], a[168:171], v[176:179], v[124:127]
    v_lshlrev_b32 v242, 16, v77
    v_and_b32 v243, 0xffff0000, v77
    v_mfma_f32_16x16x32_bf16 v[128:131], a[172:175], v[176:179], v[128:131]
    v_lshlrev_b32 v244, 16, v78
    v_and_b32 v245, 0xffff0000, v78
    v_mfma_f32_16x16x32_bf16 v[132:135], a[176:179], v[176:179], v[132:135]
    v_lshlrev_b32 v246, 16, v79
    v_and_b32 v247, 0xffff0000, v79
    s_waitcnt vmcnt(15)
    v_mfma_f32_16x16x32_bf16 v[116:119], a[180:183], v[180:183], v[116:119]
    v_lshlrev_b32 v248, 16, v80
    v_and_b32 v249, 0xffff0000, v80
    v_mfma_f32_16x16x32_bf16 v[120:123], a[184:187], v[180:183], v[120:123]
    s_add_u32 s40, s45, 36864
    buffer_load_dwordx4 v[228:231], v93, s[4:7], s40 offen sc1
    v_mfma_f32_16x16x32_bf16 v[124:127], a[188:191], v[180:183], v[124:127]
    v_lshlrev_b32 v250, 16, v81
    v_and_b32 v251, 0xffff0000, v81
    v_mfma_f32_16x16x32_bf16 v[128:131], a[192:195], v[180:183], v[128:131]
    v_lshlrev_b32 v5, 16, v82
    v_and_b32 v7, 0xffff0000, v82
    v_mfma_f32_16x16x32_bf16 v[132:135], a[196:199], v[180:183], v[132:135]
    v_lshlrev_b32 v8, 16, v83
    v_and_b32 v9, 0xffff0000, v83
    s_waitcnt vmcnt(15)
    v_mfma_f32_16x16x32_bf16 v[116:119], a[200:203], v[184:187], v[116:119]
    v_lshlrev_b32 v10, 16, v84
    v_and_b32 v12, 0xffff0000, v84
    v_mfma_f32_16x16x32_bf16 v[120:123], a[204:207], v[184:187], v[120:123]
    s_add_u32 s40, s45, 40960
    buffer_load_dwordx4 v[232:235], v93, s[4:7], s40 offen sc1
    v_mfma_f32_16x16x32_bf16 v[124:127], a[208:211], v[184:187], v[124:127]
    v_lshlrev_b32 v13, 16, v85
    v_and_b32 v14, 0xffff0000, v85
    v_mfma_f32_16x16x32_bf16 v[128:131], a[212:215], v[184:187], v[128:131]
    v_mfma_f32_16x16x32_bf16 v[132:135], a[216:219], v[184:187], v[132:135]
    s_waitcnt vmcnt(15)
    v_mfma_f32_16x16x32_bf16 v[116:119], a[220:223], v[188:191], v[116:119]
    v_mfma_f32_16x16x32_bf16 v[120:123], v[16:19], v[188:191], v[120:123]
    s_add_u32 s40, s45, 45056
    buffer_load_dwordx4 v[236:239], v93, s[4:7], s40 offen sc1
    v_mfma_f32_16x16x32_bf16 v[124:127], v[20:23], v[188:191], v[124:127]
    v_mfma_f32_16x16x32_bf16 v[128:131], v[24:27], v[188:191], v[128:131]
    v_mfma_f32_16x16x32_bf16 v[132:135], v[28:31], v[188:191], v[132:135]
    s_waitcnt vmcnt(14)
    v_mfma_f32_16x16x32_bf16 v[116:119], v[32:35], v[192:195], v[116:119]
    v_mfma_f32_16x16x32_bf16 v[120:123], v[36:39], v[192:195], v[120:123]
    s_add_u32 s40, s45, 49152
    v_sub_u32 v93, v93, v254
    buffer_load_dwordx2 v[176:177], v93, s[4:7], s40 offen offset:0 sc1
    buffer_load_dwordx2 v[178:179], v93, s[4:7], s40 offen offset:512 sc1
    v_mfma_f32_16x16x32_bf16 v[124:127], v[40:43], v[192:195], v[124:127]
    v_mfma_f32_16x16x32_bf16 v[128:131], v[44:47], v[192:195], v[128:131]
    v_mfma_f32_16x16x32_bf16 v[132:135], v[48:51], v[192:195], v[132:135]
    s_waitcnt vmcnt(14)
    v_mfma_f32_16x16x32_bf16 v[116:119], v[52:55], v[196:199], v[116:119]
    v_mfma_f32_16x16x32_bf16 v[120:123], v[56:59], v[196:199], v[120:123]
    s_add_u32 s40, s45, 53248
    buffer_load_dwordx2 v[180:181], v93, s[4:7], s40 offen offset:0 sc1
    buffer_load_dwordx2 v[182:183], v93, s[4:7], s40 offen offset:512 sc1
    v_mfma_f32_16x16x32_bf16 v[124:127], v[60:63], v[196:199], v[124:127]
    v_mfma_f32_16x16x32_bf16 v[128:131], v[64:67], v[196:199], v[128:131]
    v_mfma_f32_16x16x32_bf16 v[132:135], v[68:71], v[196:199], v[132:135]
    s_waitcnt vmcnt(15)
    v_mfma_f32_16x16x32_bf16 v[136:139], a[160:163], v[200:203], v[136:139]
    v_mfma_f32_16x16x32_bf16 v[140:143], a[164:167], v[200:203], v[140:143]
    s_add_u32 s40, s45, 32768
    buffer_load_dwordx4 v[184:187], v90, s[4:7], s40 offen sc1
    v_mfma_f32_16x16x32_bf16 v[144:147], a[168:171], v[200:203], v[144:147]
    v_mfma_f32_16x16x32_bf16 v[148:151], a[172:175], v[200:203], v[148:151]
    v_mfma_f32_16x16x32_bf16 v[152:155], a[176:179], v[200:203], v[152:155]
    s_waitcnt vmcnt(15)
    v_mfma_f32_16x16x32_bf16 v[136:139], a[180:183], v[204:207], v[136:139]
    ds_write_b128 v73, v[116:119] offset:0
    v_mfma_f32_16x16x32_bf16 v[140:143], a[184:187], v[204:207], v[140:143]
    s_add_u32 s40, s45, 36864
    buffer_load_dwordx4 v[188:191], v90, s[4:7], s40 offen sc1
    v_mfma_f32_16x16x32_bf16 v[144:147], a[188:191], v[204:207], v[144:147]
    v_mfma_f32_16x16x32_bf16 v[148:151], a[192:195], v[204:207], v[148:151]
    ds_write_b128 v73, v[120:123] offset:1024
    v_mfma_f32_16x16x32_bf16 v[152:155], a[196:199], v[204:207], v[152:155]
    s_waitcnt vmcnt(15)
    v_mfma_f32_16x16x32_bf16 v[136:139], a[200:203], v[208:211], v[136:139]
    ds_write_b128 v73, v[124:127] offset:2048
    v_mfma_f32_16x16x32_bf16 v[140:143], a[204:207], v[208:211], v[140:143]
    s_add_u32 s40, s45, 40960
    buffer_load_dwordx4 v[192:195], v90, s[4:7], s40 offen sc1
    v_mfma_f32_16x16x32_bf16 v[144:147], a[208:211], v[208:211], v[144:147]
    v_mfma_f32_16x16x32_bf16 v[148:151], a[212:215], v[208:211], v[148:151]
    ds_write_b128 v73, v[128:131] offset:3072
    v_mfma_f32_16x16x32_bf16 v[152:155], a[216:219], v[208:211], v[152:155]
    s_waitcnt vmcnt(15)
    v_mfma_f32_16x16x32_bf16 v[136:139], a[220:223], v[212:215], v[136:139]
    ds_write_b128 v73, v[132:135] offset:4096
    v_mfma_f32_16x16x32_bf16 v[140:143], v[16:19], v[212:215], v[140:143]
    s_add_u32 s40, s45, 45056
    buffer_load_dwordx4 v[196:199], v90, s[4:7], s40 offen sc1
    v_mfma_f32_16x16x32_bf16 v[144:147], v[20:23], v[212:215], v[144:147]
    v_mfma_f32_16x16x32_bf16 v[148:151], v[24:27], v[212:215], v[148:151]
    v_mfma_f32_16x16x32_bf16 v[152:155], v[28:31], v[212:215], v[152:155]
    s_waitcnt vmcnt(14)
    v_mfma_f32_16x16x32_bf16 v[136:139], v[32:35], v[216:219], v[136:139]
    v_mfma_f32_16x16x32_bf16 v[140:143], v[36:39], v[216:219], v[140:143]
    s_add_u32 s40, s45, 49152
    v_sub_u32 v90, v90, v254
    buffer_load_dwordx2 v[200:201], v90, s[4:7], s40 offen offset:0 sc1
    buffer_load_dwordx2 v[202:203], v90, s[4:7], s40 offen offset:512 sc1
    v_mfma_f32_16x16x32_bf16 v[144:147], v[40:43], v[216:219], v[144:147]
    v_mfma_f32_16x16x32_bf16 v[148:151], v[44:47], v[216:219], v[148:151]
    v_mfma_f32_16x16x32_bf16 v[152:155], v[48:51], v[216:219], v[152:155]
    s_waitcnt vmcnt(14)
    v_mfma_f32_16x16x32_bf16 v[136:139], v[52:55], v[220:223], v[136:139]
    v_mfma_f32_16x16x32_bf16 v[140:143], v[56:59], v[220:223], v[140:143]
    s_add_u32 s40, s45, 53248
    buffer_load_dwordx2 v[204:205], v90, s[4:7], s40 offen offset:0 sc1
    buffer_load_dwordx2 v[206:207], v90, s[4:7], s40 offen offset:512 sc1
    v_mfma_f32_16x16x32_bf16 v[144:147], v[60:63], v[220:223], v[144:147]
    v_mfma_f32_16x16x32_bf16 v[148:151], v[64:67], v[220:223], v[148:151]
    v_mfma_f32_16x16x32_bf16 v[152:155], v[68:71], v[220:223], v[152:155]
    s_waitcnt vmcnt(15)
    v_mfma_f32_16x16x32_bf16 v[156:159], a[160:163], v[224:227], v[156:159]
    v_mfma_f32_16x16x32_bf16 v[160:163], a[164:167], v[224:227], v[160:163]
    v_mfma_f32_16x16x32_bf16 v[164:167], a[168:171], v[224:227], v[164:167]
    v_mfma_f32_16x16x32_bf16 v[168:171], a[172:175], v[224:227], v[168:171]
    v_mfma_f32_16x16x32_bf16 v[172:175], a[176:179], v[224:227], v[172:175]
    s_waitcnt vmcnt(14)
    v_mfma_f32_16x16x32_bf16 v[156:159], a[180:183], v[228:231], v[156:159]
    ds_write_b128 v74, v[136:139] offset:0
    v_mfma_f32_16x16x32_bf16 v[160:163], a[184:187], v[228:231], v[160:163]
    v_mfma_f32_16x16x32_bf16 v[164:167], a[188:191], v[228:231], v[164:167]
    v_mfma_f32_16x16x32_bf16 v[168:171], a[192:195], v[228:231], v[168:171]
    ds_write_b128 v74, v[140:143] offset:1024
    v_mfma_f32_16x16x32_bf16 v[172:175], a[196:199], v[228:231], v[172:175]
    s_waitcnt vmcnt(13)
    v_mfma_f32_16x16x32_bf16 v[156:159], a[200:203], v[232:235], v[156:159]
    ds_write_b128 v74, v[144:147] offset:2048
    v_mfma_f32_16x16x32_bf16 v[160:163], a[204:207], v[232:235], v[160:163]
    v_mfma_f32_16x16x32_bf16 v[164:167], a[208:211], v[232:235], v[164:167]
    v_mfma_f32_16x16x32_bf16 v[168:171], a[212:215], v[232:235], v[168:171]
    ds_write_b128 v74, v[148:151] offset:3072
    v_mfma_f32_16x16x32_bf16 v[172:175], a[216:219], v[232:235], v[172:175]
    s_waitcnt vmcnt(12)
    v_mfma_f32_16x16x32_bf16 v[156:159], a[220:223], v[236:239], v[156:159]
    ds_write_b128 v74, v[152:155] offset:4096
    v_mfma_f32_16x16x32_bf16 v[160:163], v[16:19], v[236:239], v[160:163]
    v_mfma_f32_16x16x32_bf16 v[164:167], v[20:23], v[236:239], v[164:167]
    v_mfma_f32_16x16x32_bf16 v[168:171], v[24:27], v[236:239], v[168:171]
    v_mfma_f32_16x16x32_bf16 v[172:175], v[28:31], v[236:239], v[172:175]
    s_waitcnt vmcnt(10)
    v_mfma_f32_16x16x32_bf16 v[156:159], v[32:35], v[176:179], v[156:159]
    v_mfma_f32_16x16x32_bf16 v[160:163], v[36:39], v[176:179], v[160:163]
    v_mfma_f32_16x16x32_bf16 v[164:167], v[40:43], v[176:179], v[164:167]
    v_mfma_f32_16x16x32_bf16 v[168:171], v[44:47], v[176:179], v[168:171]
    v_mfma_f32_16x16x32_bf16 v[172:175], v[48:51], v[176:179], v[172:175]
    s_waitcnt vmcnt(8)
    v_mfma_f32_16x16x32_bf16 v[156:159], v[52:55], v[180:183], v[156:159]
    v_mfma_f32_16x16x32_bf16 v[160:163], v[56:59], v[180:183], v[160:163]
    v_mfma_f32_16x16x32_bf16 v[164:167], v[60:63], v[180:183], v[164:167]
    v_mfma_f32_16x16x32_bf16 v[168:171], v[64:67], v[180:183], v[168:171]
    v_mfma_f32_16x16x32_bf16 v[172:175], v[68:71], v[180:183], v[172:175]
    s_waitcnt vmcnt(7)
    v_mfma_f32_16x16x32_bf16 v[96:99], a[160:163], v[184:187], v[96:99]
    v_mfma_f32_16x16x32_bf16 v[100:103], a[164:167], v[184:187], v[100:103]
    v_mfma_f32_16x16x32_bf16 v[104:107], a[168:171], v[184:187], v[104:107]
    v_mfma_f32_16x16x32_bf16 v[108:111], a[172:175], v[184:187], v[108:111]
    v_mfma_f32_16x16x32_bf16 v[112:115], a[176:179], v[184:187], v[112:115]
    s_waitcnt vmcnt(6)
    v_mfma_f32_16x16x32_bf16 v[96:99], a[180:183], v[188:191], v[96:99]
    ds_write_b128 v75, v[156:159] offset:0
    v_mfma_f32_16x16x32_bf16 v[100:103], a[184:187], v[188:191], v[100:103]
    v_mfma_f32_16x16x32_bf16 v[104:107], a[188:191], v[188:191], v[104:107]
    v_mfma_f32_16x16x32_bf16 v[108:111], a[192:195], v[188:191], v[108:111]
    ds_write_b128 v75, v[160:163] offset:1024
    v_mfma_f32_16x16x32_bf16 v[112:115], a[196:199], v[188:191], v[112:115]
    s_waitcnt vmcnt(5)
    v_mfma_f32_16x16x32_bf16 v[96:99], a[200:203], v[192:195], v[96:99]
    ds_write_b128 v75, v[164:167] offset:2048
    v_mfma_f32_16x16x32_bf16 v[100:103], a[204:207], v[192:195], v[100:103]
    v_mfma_f32_16x16x32_bf16 v[104:107], a[208:211], v[192:195], v[104:107]
    v_mfma_f32_16x16x32_bf16 v[108:111], a[212:215], v[192:195], v[108:111]
    ds_write_b128 v75, v[168:171] offset:3072
    v_mfma_f32_16x16x32_bf16 v[112:115], a[216:219], v[192:195], v[112:115]
    s_waitcnt vmcnt(4)
    v_mfma_f32_16x16x32_bf16 v[96:99], a[220:223], v[196:199], v[96:99]
    ds_write_b128 v75, v[172:175] offset:4096
    v_mfma_f32_16x16x32_bf16 v[100:103], v[16:19], v[196:199], v[100:103]
    v_mfma_f32_16x16x32_bf16 v[104:107], v[20:23], v[196:199], v[104:107]
    v_mfma_f32_16x16x32_bf16 v[108:111], v[24:27], v[196:199], v[108:111]
    v_mfma_f32_16x16x32_bf16 v[112:115], v[28:31], v[196:199], v[112:115]
    s_waitcnt vmcnt(2)
    s_waitcnt lgkmcnt(0)
    s_barrier
    ds_read_b32 v88, v94
    v_mfma_f32_16x16x32_bf16 v[96:99], v[32:35], v[200:203], v[96:99]
    ds_read_b128 v[116:119], v72 offset:0
    ds_read_b128 v[120:123], v72 offset:5120
    v_mfma_f32_16x16x32_bf16 v[100:103], v[36:39], v[200:203], v[100:103]
    ds_read_b128 v[124:127], v72 offset:10240
    ds_read_b128 v[128:131], v72 offset:1024
    v_mfma_f32_16x16x32_bf16 v[104:107], v[40:43], v[200:203], v[104:107]
    ds_read_b128 v[132:135], v72 offset:6144
    ds_read_b128 v[136:139], v72 offset:11264
    v_mfma_f32_16x16x32_bf16 v[108:111], v[44:47], v[200:203], v[108:111]
    ds_read_b128 v[140:143], v72 offset:2048
    ds_read_b128 v[144:147], v72 offset:7168
    v_mfma_f32_16x16x32_bf16 v[112:115], v[48:51], v[200:203], v[112:115]
    ds_read_b128 v[148:151], v72 offset:12288
    ds_read_b128 v[152:155], v72 offset:3072
    s_waitcnt vmcnt(0)
    v_mfma_f32_16x16x32_bf16 v[96:99], v[52:55], v[204:207], v[96:99]
    ds_read_b128 v[156:159], v72 offset:8192
    ds_read_b128 v[160:163], v72 offset:13312
    v_mfma_f32_16x16x32_bf16 v[100:103], v[56:59], v[204:207], v[100:103]
    ds_read_b128 v[164:167], v72 offset:4096
    ds_read_b128 v[168:171], v72 offset:9216
    v_mfma_f32_16x16x32_bf16 v[104:107], v[60:63], v[204:207], v[104:107]
    ds_read_b128 v[172:175], v72 offset:14336
    s_waitcnt lgkmcnt(12)
    v_mfma_f32_16x16x32_bf16 v[108:111], v[64:67], v[204:207], v[108:111]
    v_add_f32 v116, v116, v120
    v_add_f32 v117, v117, v121
    v_mfma_f32_16x16x32_bf16 v[112:115], v[68:71], v[204:207], v[112:115]
    v_add_f32 v118, v118, v122
    v_add_f32 v119, v119, v123
    v_add_f32 v116, v116, v124
    v_add_f32 v117, v117, v125
    v_add_f32 v118, v118, v126
    v_add_f32 v119, v119, v127
    v_fma_f32 v116, v116, v88, v240
    v_fma_f32 v117, v117, v88, v241
    v_fma_f32 v118, v118, v88, v242
    v_fma_f32 v119, v119, v88, v243
    s_waitcnt lgkmcnt(9)
    v_add_f32 v128, v128, v132
    v_add_f32 v129, v129, v133
    v_add_f32 v130, v130, v134
    v_add_f32 v131, v131, v135
    v_add_f32 v128, v128, v136
    v_add_f32 v129, v129, v137
    v_add_f32 v130, v130, v138
    v_add_f32 v131, v131, v139
    v_fma_f32 v128, v128, v88, v244
    v_fma_f32 v129, v129, v88, v245
    v_fma_f32 v130, v130, v88, v246
    v_fma_f32 v131, v131, v88, v247
    s_waitcnt lgkmcnt(6)
    v_add_f32 v140, v140, v144
    v_add_f32 v141, v141, v145
    v_add_f32 v142, v142, v146
    v_add_f32 v143, v143, v147
    v_add_f32 v140, v140, v148
    v_add_f32 v141, v141, v149
    v_add_f32 v142, v142, v150
    v_add_f32 v143, v143, v151
    v_fma_f32 v140, v140, v88, v248
    v_fma_f32 v141, v141, v88, v249
    v_fma_f32 v142, v142, v88, v250
    v_fma_f32 v143, v143, v88, v251
    s_waitcnt lgkmcnt(3)
    v_add_f32 v152, v152, v156
    v_add_f32 v153, v153, v157
    v_add_f32 v154, v154, v158
    v_add_f32 v155, v155, v159
    v_add_f32 v152, v152, v160
    v_add_f32 v153, v153, v161
    v_add_f32 v154, v154, v162
    v_add_f32 v155, v155, v163
    v_fma_f32 v152, v152, v88, v5
    v_fma_f32 v153, v153, v88, v7
    v_fma_f32 v154, v154, v88, v8
    v_fma_f32 v155, v155, v88, v9
    s_waitcnt lgkmcnt(0)
    v_add_f32 v164, v164, v168
    v_add_f32 v165, v165, v169
    v_add_f32 v166, v166, v170
    v_add_f32 v167, v167, v171
    v_add_f32 v164, v164, v172
    v_add_f32 v165, v165, v173
    v_add_f32 v166, v166, v174
    v_add_f32 v167, v167, v175
    v_fma_f32 v164, v164, v88, v10
    v_fma_f32 v165, v165, v88, v12
    v_fma_f32 v166, v166, v88, v13
    v_fma_f32 v167, v167, v88, v14
    v_fma_f32 v96, v96, v88, v116
    v_fma_f32 v97, v97, v88, v117
    v_fma_f32 v98, v98, v88, v118
    v_fma_f32 v99, v99, v88, v119
    v_cvt_pk_bf16_f32 v76, v96, v97
    v_cvt_pk_bf16_f32 v77, v98, v99
    buffer_store_dwordx2 v[76:77], v6, s[8:11], s44 offen offset:0
    v_fma_f32 v100, v100, v88, v128
    v_fma_f32 v101, v101, v88, v129
    v_fma_f32 v102, v102, v88, v130
    v_fma_f32 v103, v103, v88, v131
    v_cvt_pk_bf16_f32 v78, v100, v101
    v_cvt_pk_bf16_f32 v79, v102, v103
    buffer_store_dwordx2 v[78:79], v6, s[8:11], s44 offen offset:32
    v_fma_f32 v104, v104, v88, v140
    v_fma_f32 v105, v105, v88, v141
    v_fma_f32 v106, v106, v88, v142
    v_fma_f32 v107, v107, v88, v143
    v_cvt_pk_bf16_f32 v80, v104, v105
    v_cvt_pk_bf16_f32 v81, v106, v107
    buffer_store_dwordx2 v[80:81], v6, s[8:11], s44 offen offset:64
    v_fma_f32 v108, v108, v88, v152
    v_fma_f32 v109, v109, v88, v153
    v_fma_f32 v110, v110, v88, v154
    v_fma_f32 v111, v111, v88, v155
    v_cvt_pk_bf16_f32 v82, v108, v109
    v_cvt_pk_bf16_f32 v83, v110, v111
    buffer_store_dwordx2 v[82:83], v6, s[8:11], s44 offen offset:96
    v_fma_f32 v112, v112, v88, v164
    v_fma_f32 v113, v113, v88, v165
    v_fma_f32 v114, v114, v88, v166
    v_fma_f32 v115, v115, v88, v167
    v_cvt_pk_bf16_f32 v84, v112, v113
    v_cvt_pk_bf16_f32 v85, v114, v115
    buffer_store_dwordx2 v[84:85], v6, s[8:11], s44 offen offset:128
L_m_end:
    s_endpgm
.section .rodata,"a"
.p2align 6
.amdhsa_kernel sequential_preLN__ssm_conv_s4__dense_activation_relu__prompt_kernel
  .amdhsa_next_free_vgpr 512
  .amdhsa_next_free_sgpr 102
  .amdhsa_accum_offset 256
  .amdhsa_group_segment_fixed_size 0
  .amdhsa_kernarg_size 120
  .amdhsa_user_sgpr_count 2
  .amdhsa_user_sgpr_kernarg_segment_ptr 1
  .amdhsa_system_sgpr_workgroup_id_x 1
.end_amdhsa_kernel
```
